```python
import torch

def _softmax(x, axis=-1):
    return torch.softmax(x, dim=axis)

def _gelu(x):
    return torch.nn.functional.gelu(x, approximate='tanh')

def _silu(x):
    return torch.nn.functional.silu(x)

def _sigmoid(x):
    return torch.sigmoid(x)

def _layernorm(x, axis=-1, eps=1e-05):
    m = x.mean(dim=axis, keepdim=True)
    v = x.var(dim=axis, keepdim=True, unbiased=False)
    return (x - m) / torch.sqrt(v + eps)

def _scatter_add(tgt, idx, src, axis=0):
    return tgt.clone().index_add_(axis, idx, src)

def _segment_sum(src, seg, n):
    out = torch.zeros((n,) + src.shape[1:], dtype=src.dtype)
    return out.index_add_(0, seg, src)

def _pad(x, pw):
    flat = tuple((v for pair in reversed(pw) for v in pair))
    return torch.nn.functional.pad(x, flat)
kernel_name = 'sequential_preLN__sliding_local_dilated__mixer_gmlp__prompt'

def setup_inputs():

    _w = lambda a: (lambda t: t.to(torch.bfloat16) if t.is_floating_point() else t)(torch.as_tensor(a))

    def _A_setup():
        B, S, D = (1, 2048, 1024)
        return {'x': _w((lambda *s: torch.randn(*s, dtype=torch.bfloat16) * 0.05)(B, S, D)), 'wqkv': _w((lambda *s: torch.randn(*s, dtype=torch.bfloat16) * 0.05)(D, 3 * D)), 'wo': _w((lambda *s: torch.randn(*s, dtype=torch.bfloat16) * 0.05)(D, D))}
    _A_in = _A_setup()

    def _B_setup():
        B, S, D, F = (1, 2048, 1024, 3584)
        Fh = F // 2
        return {'x': _w((lambda *s: torch.randn(*s, dtype=torch.bfloat16) * 0.05)(B, S, D)), 'w_in': _w((lambda *s: torch.randn(*s, dtype=torch.bfloat16) * 0.4)(D, 2 * Fh)), 'w_sp': _w(0.01 * (lambda *s: torch.randn(*s, dtype=torch.bfloat16) * 0.4)(S, S)), 'b_sp': _w(1.0 + 0.01 * (lambda *s: torch.randn(*s, dtype=torch.bfloat16) * 0.05)(S)), 'w_out': _w((lambda *s: torch.randn(*s, dtype=torch.bfloat16) * 0.05)(Fh, D))}
    _B_in = _B_setup()
    return {'A_x': _A_in['x'], 'A_wqkv': _A_in['wqkv'], 'A_wo': _A_in['wo'], 'B_x': _B_in['x'], 'B_w_in': _B_in['w_in'], 'B_w_sp': _B_in['w_sp'], 'B_b_sp': _B_in['b_sp'], 'B_w_out': _B_in['w_out']}

def reference(A_x, A_wqkv, A_wo, B_x, B_w_in, B_w_sp, B_b_sp, B_w_out):

    def _A_ref(x, wqkv, wo):
        B, S, D = x.shape
        H = 32
        Dh = D // H
        W, dil = (8, 2)
        qkv = (lambda x, *d: x.permute(*d))((x @ wqkv).reshape(B, S, 3, H, Dh), 2, 0, 3, 1, 4)
        q, k, v = (qkv[0], qkv[1], qkv[2])
        scale = Dh ** (-0.5)
        pos = torch.arange(S)
        off = torch.arange(W) * dil
        idx = pos[:, None] - off[None, :]
        mask = idx >= 0
        idx_c = torch.where(mask, idx, 0).reshape(-1)
        kg = k[:, :, idx_c, :].reshape(B, H, S, W, Dh)
        vg = v[:, :, idx_c, :].reshape(B, H, S, W, Dh)
        logits = torch.einsum('bhsd,bhswd->bhsw', q, kg) * scale
        logits = torch.where(mask[None, None, :, :], logits, -1000000000.0)
        attn = _softmax(logits, axis=-1)
        o = torch.einsum('bhsw,bhswd->bhsd', attn, vg)
        return (lambda x, *d: x.permute(*d))(o, 0, 2, 1, 3).reshape(B, S, D) @ wo

    def _B_ref(x, w_in, w_sp, b_sp, w_out):
        B, S, D = x.shape
        F = w_in.shape[-1]
        Fh = F // 2
        z = _gelu(torch.einsum('bsd,df->bsf', x, w_in))
        z1 = z[..., :Fh].clone()
        z2 = _layernorm(z[..., Fh:], axis=-1)
        g = torch.einsum('ts,bsf->btf', w_sp, z2) + b_sp[None, :, None]
        return torch.einsum('bsf,fd->bsd', z1 * g, w_out)
    x = A_x
    h = x + _A_ref(_layernorm(x, axis=-1), A_wqkv, A_wo)
    h2 = h + _B_ref(_layernorm(h, axis=-1), B_w_in, B_w_sp, B_b_sp, B_w_out)
    return h2
```

```asm
; @launch kernel=mega_kernel grid=(256,1,1) block=(512,1,1) lds=163840
.amdgcn_target "amdgcn-amd-amdhsa--gfx950"
.text
.globl mega_kernel
.p2align 8
.type mega_kernel,@function
mega_kernel:
    s_cmp_ge_u32 s2, 256
    s_cbranch_scc1 mega_done
    s_load_dwordx16 s[4:19], s[0:1], 0
    s_load_dwordx4 s[20:23], s[0:1], 64
    s_load_dwordx2 s[24:25], s[0:1], 80
    s_and_b32 s50, s2, 7
    s_lshr_b32 s51, s2, 3
    s_and_b32 s52, s50, 3
    s_lshl_b32 s52, s52, 2
    s_and_b32 s53, s51, 3
    s_add_u32 s26, s52, s53
    s_lshr_b32 s29, s51, 2
    s_lshr_b32 s28, s50, 2
    s_lshl_b32 s52, s28, 3
    s_add_u32 s27, s52, s29
    s_mov_b32 s3, s27
    s_cmp_eq_u32 s27, 7
    s_cselect_b32 s3, 11, s3
    s_cmp_eq_u32 s27, 11
    s_cselect_b32 s3, 7, s3
    s_mul_i32 s52, s28, 7
    s_add_u32 s49, s52, s29
    s_add_u32 s101, s29, s26
    s_and_b32 s101, s101, 3
    v_lshrrev_b32 v1, 6, v0
    s_nop 0
    v_readfirstlane_b32 s30, v1
    v_and_b32 v1, 63, v0
    s_waitcnt lgkmcnt(0)
    s_mov_b32 s32, s24
    s_and_b32 s33, s25, 0xffff
    s_mov_b32 s34, 134217728
    s_mov_b32 s35, 0x20000
    s_cmp_ge_u32 s30, 4
    s_cbranch_scc1 mega_prod
    v_lshrrev_b32 v2, 4, v1
    v_and_b32 v3, 15, v1
    s_and_b32 s50, s30, 1
    s_cmp_eq_u32 s50, 1
    s_cbranch_scc1 g1_c1
    v_lshrrev_b32 v4, 1, v3
    v_xor_b32 v4, v2, v4
    v_lshlrev_b32 v4, 4, v4
    v_lshlrev_b32 v5, 7, v3
    v_add_u32 v8, v4, v5
    v_add_u32 v8, 8192, v8
    v_xor_b32 v9, 64, v8
    s_lshr_b32 s50, s30, 1
    s_lshl_b32 s50, s50, 1
    s_add_u32 s51, s50, 1
    v_lshrrev_b32 v4, 2, v3
    v_and_b32 v5, 3, v3
    v_lshrrev_b32 v6, 1, v4
    v_and_b32 v7, 1, v2
    v_lshlrev_b32 v7, 1, v7
    v_or_b32 v6, v6, v7
    v_lshlrev_b32 v7, 3, v2
    v_add_u32 v7, v7, v4
    v_lshlrev_b32 v7, 7, v7
    v_lshlrev_b32 v12, 3, v5
    v_add_u32 v7, v7, v12
    v_add_u32 v7, 63488, v7
    v_xor_b32 v12, s50, v6
    v_lshlrev_b32 v12, 5, v12
    v_add_u32 v10, v12, v7
    v_xor_b32 v12, s51, v6
    v_lshlrev_b32 v12, 5, v12
    v_add_u32 v11, v12, v7
    v_mov_b32 v16, 0
    v_mov_b32 v17, 0
    v_mov_b32 v18, 0
    v_mov_b32 v19, 0
    v_mov_b32 v20, 0
    v_mov_b32 v21, 0
    v_mov_b32 v22, 0
    v_mov_b32 v23, 0
    v_mov_b32 v24, 0
    v_mov_b32 v25, 0
    v_mov_b32 v26, 0
    v_mov_b32 v27, 0
    v_mov_b32 v28, 0
    v_mov_b32 v29, 0
    v_mov_b32 v30, 0
    v_mov_b32 v31, 0
    v_mov_b32 v32, 0
    v_mov_b32 v33, 0
    v_mov_b32 v34, 0
    v_mov_b32 v35, 0
    v_mov_b32 v36, 0
    v_mov_b32 v37, 0
    v_mov_b32 v38, 0
    v_mov_b32 v39, 0
    v_mov_b32 v40, 0
    v_mov_b32 v41, 0
    v_mov_b32 v42, 0
    v_mov_b32 v43, 0
    v_mov_b32 v44, 0
    v_mov_b32 v45, 0
    v_mov_b32 v46, 0
    v_mov_b32 v47, 0
    v_mov_b32 v48, 0
    v_mov_b32 v49, 0
    v_mov_b32 v50, 0
    v_mov_b32 v51, 0
    v_mov_b32 v52, 0
    v_mov_b32 v53, 0
    v_mov_b32 v54, 0
    v_mov_b32 v55, 0
    v_mov_b32 v56, 0
    v_mov_b32 v57, 0
    v_mov_b32 v58, 0
    v_mov_b32 v59, 0
    v_mov_b32 v60, 0
    v_mov_b32 v61, 0
    v_mov_b32 v62, 0
    v_mov_b32 v63, 0
    v_mov_b32 v64, 0
    v_mov_b32 v65, 0
    v_mov_b32 v66, 0
    v_mov_b32 v67, 0
    v_mov_b32 v68, 0
    v_mov_b32 v69, 0
    v_mov_b32 v70, 0
    v_mov_b32 v71, 0
    v_mov_b32 v72, 0
    v_mov_b32 v73, 0
    v_mov_b32 v74, 0
    v_mov_b32 v75, 0
    v_mov_b32 v76, 0
    v_mov_b32 v77, 0
    v_mov_b32 v78, 0
    v_mov_b32 v79, 0
    v_mov_b32 v80, 0
    v_mov_b32 v81, 0
    v_mov_b32 v82, 0
    v_mov_b32 v83, 0
    v_mov_b32 v84, 0
    v_mov_b32 v85, 0
    v_mov_b32 v86, 0
    v_mov_b32 v87, 0
    v_mov_b32 v88, 0
    v_mov_b32 v89, 0
    v_mov_b32 v90, 0
    v_mov_b32 v91, 0
    v_mov_b32 v92, 0
    v_mov_b32 v93, 0
    v_mov_b32 v94, 0
    v_mov_b32 v95, 0
    v_mov_b32 v96, 0
    v_mov_b32 v97, 0
    v_mov_b32 v98, 0
    v_mov_b32 v99, 0
    v_mov_b32 v100, 0
    v_mov_b32 v101, 0
    v_mov_b32 v102, 0
    v_mov_b32 v103, 0
    v_mov_b32 v104, 0
    v_mov_b32 v105, 0
    v_mov_b32 v106, 0
    v_mov_b32 v107, 0
    v_mov_b32 v108, 0
    v_mov_b32 v109, 0
    v_mov_b32 v110, 0
    v_mov_b32 v111, 0
    v_mov_b32 v112, 0
    v_mov_b32 v113, 0
    v_mov_b32 v114, 0
    v_mov_b32 v115, 0
    v_mov_b32 v116, 0
    v_mov_b32 v117, 0
    v_mov_b32 v118, 0
    v_mov_b32 v119, 0
    s_cmp_eq_u32 s30, 0
    s_cselect_b32 s36, s8, s12
    s_cselect_b32 s37, s9, s13
    s_mov_b32 s52, 7340032
    s_cselect_b32 s38, 2097152, s52
    s_mov_b32 s39, 0x20000
    s_mul_i32 s53, s2, 28672
    s_lshl_b32 s54, s30, 13
    s_add_u32 s53, s53, s54
    s_sub_u32 s53, s53, 8192
    s_lshl_b32 s54, s2, 13
    s_cmp_eq_u32 s30, 0
    s_cselect_b32 s56, s54, s53
    s_and_b32 s37, s37, 0xffff
    s_cmp_eq_u32 s30, 0
    s_cselect_b32 s40, s12, s14
    s_cselect_b32 s41, s13, s15
    s_mov_b32 s52, 8388608
    s_cselect_b32 s42, 7340032, s52
    s_mov_b32 s43, 0x20000
    s_mul_i32 s53, s2, 28672
    s_add_u32 s53, s53, 24576
    s_lshl_b32 s54, s2, 15
    s_lshl_b32 s55, s30, 13
    s_add_u32 s54, s54, s55
    s_sub_u32 s54, s54, 8192
    s_cmp_eq_u32 s30, 0
    s_cselect_b32 s57, s53, s54
    s_and_b32 s41, s41, 0xffff
    s_cmp_eq_u32 s30, 0
    s_cselect_b32 s44, s14, s18
    s_cselect_b32 s45, s15, s19
    s_mov_b32 s52, 3670016
    s_cselect_b32 s46, 8388608, s52
    s_mov_b32 s47, 0x20000
    s_lshl_b32 s53, s2, 15
    s_add_u32 s53, s53, 24576
    s_mul_i32 s54, s2, 14336
    s_min_u32 s55, s30, 2
    s_lshl_b32 s55, s55, 13
    s_add_u32 s54, s54, s55
    s_sub_u32 s54, s54, 8192
    s_cmp_eq_u32 s30, 0
    s_cselect_b32 s58, s53, s54
    s_and_b32 s45, s45, 0xffff
    v_lshlrev_b32 v149, 7, v1
    s_add_u32 s59, s30, 3
    s_mov_b32 s65, 0
    s_mov_b32 s67, 0
    s_barrier
    ds_read_b128 a[0:3], v8 offset:2048
    ds_read_b64_tr_b16 a[20:21], v10 offset:0
    ds_read_b64_tr_b16 a[22:23], v10 offset:512
    ds_read_b128 a[4:7], v8 offset:4096
    ds_read_b64_tr_b16 a[24:25], v11 offset:0
    ds_read_b64_tr_b16 a[26:27], v11 offset:512
    ds_read_b128 a[8:11], v8 offset:6144
    ds_read_b128 a[12:15], v8 offset:8192
    ds_read_b64_tr_b16 a[28:29], v10 offset:8192
    ds_read_b64_tr_b16 a[30:31], v10 offset:8704
    ds_read_b64_tr_b16 a[32:33], v11 offset:8192
    ds_read_b64_tr_b16 a[34:35], v11 offset:8704
    ds_read_b128 a[16:19], v8 offset:0
    ds_read_b64_tr_b16 a[36:37], v10 offset:16384
    ds_read_b64_tr_b16 a[38:39], v10 offset:16896
    ds_read_b64_tr_b16 a[40:41], v11 offset:16384
    ds_read_b64_tr_b16 a[42:43], v11 offset:16896
    s_waitcnt lgkmcnt(0)
    s_mov_b32 s64, 0
g1_loop0:
    v_mfma_f32_16x16x32_bf16 v[16:19], a[20:23], a[0:3], v[16:19]
    ds_read_b128 a[44:47], v9 offset:2048
    s_add_u32 s65, s65, 1
    v_mfma_f32_16x16x32_bf16 v[20:23], a[20:23], a[4:7], v[20:23]
    ds_read_b64_tr_b16 a[64:65], v10 offset:4096
    s_cmp_eq_u32 s65, 3
    v_mfma_f32_16x16x32_bf16 v[24:27], a[20:23], a[8:11], v[24:27]
    ds_read_b64_tr_b16 a[66:67], v10 offset:4608
    s_mov_b32 s66, 18432
    v_mfma_f32_16x16x32_bf16 v[28:31], a[20:23], a[12:15], v[28:31]
    ds_read_b128 a[48:51], v9 offset:4096
    s_cselect_b32 s66, 4294930432, s66
    v_mfma_f32_16x16x32_bf16 v[32:35], a[24:27], a[0:3], v[32:35]
    ds_read_b64_tr_b16 a[68:69], v11 offset:4096
    s_cselect_b32 s65, 0, s65
    v_mfma_f32_16x16x32_bf16 v[36:39], a[24:27], a[4:7], v[36:39]
    ds_read_b64_tr_b16 a[70:71], v11 offset:4608
    s_add_u32 s67, s67, 1
    v_mfma_f32_16x16x32_bf16 v[40:43], a[24:27], a[8:11], v[40:43]
    s_cmp_eq_u32 s67, 3
    v_mfma_f32_16x16x32_bf16 v[44:47], a[24:27], a[12:15], v[44:47]
    ds_read_b128 a[52:55], v9 offset:6144
    s_mov_b32 s62, 24576
    v_mfma_f32_16x16x32_bf16 v[48:51], a[28:31], a[0:3], v[48:51]
    ds_read_b128 a[56:59], v9 offset:8192
    s_cselect_b32 s62, 4294918144, s62
    v_mfma_f32_16x16x32_bf16 v[52:55], a[28:31], a[4:7], v[52:55]
    ds_read_b64_tr_b16 a[72:73], v10 offset:12288
    s_cselect_b32 s67, 0, s67
    v_mfma_f32_16x16x32_bf16 v[56:59], a[28:31], a[8:11], v[56:59]
    ds_read_b64_tr_b16 a[74:75], v10 offset:12800
    s_add_u32 s64, s64, 1
    v_mfma_f32_16x16x32_bf16 v[60:63], a[28:31], a[12:15], v[60:63]
    ds_read_b64_tr_b16 a[76:77], v11 offset:12288
    v_mfma_f32_16x16x32_bf16 v[64:67], a[32:35], a[0:3], v[64:67]
    ds_read_b64_tr_b16 a[78:79], v11 offset:12800
    v_mfma_f32_16x16x32_bf16 v[68:71], a[32:35], a[4:7], v[68:71]
    v_mfma_f32_16x16x32_bf16 v[72:75], a[32:35], a[8:11], v[72:75]
    ds_read_b128 a[60:63], v9 offset:0
    v_mfma_f32_16x16x32_bf16 v[76:79], a[32:35], a[12:15], v[76:79]
    ds_read_b64_tr_b16 a[80:81], v10 offset:20480
    v_mfma_f32_16x16x32_bf16 v[112:115], a[28:31], a[16:19], v[112:115]
    ds_read_b64_tr_b16 a[82:83], v10 offset:20992
    v_mfma_f32_16x16x32_bf16 v[116:119], a[32:35], a[16:19], v[116:119]
    ds_read_b64_tr_b16 a[84:85], v11 offset:20480
    v_mfma_f32_16x16x32_bf16 v[80:83], a[0:3], a[36:39], v[80:83]
    ds_read_b64_tr_b16 a[86:87], v11 offset:20992
    v_add_u32 v8, s66, v8
    v_mfma_f32_16x16x32_bf16 v[84:87], a[4:7], a[36:39], v[84:87]
    v_add_u32 v9, s66, v9
    v_add_u32 v10, s62, v10
    v_mfma_f32_16x16x32_bf16 v[88:91], a[8:11], a[36:39], v[88:91]
    v_add_u32 v11, s62, v11
    v_mfma_f32_16x16x32_bf16 v[92:95], a[12:15], a[36:39], v[92:95]
    v_mfma_f32_16x16x32_bf16 v[96:99], a[0:3], a[40:43], v[96:99]
    v_mfma_f32_16x16x32_bf16 v[100:103], a[4:7], a[40:43], v[100:103]
    v_mfma_f32_16x16x32_bf16 v[104:107], a[8:11], a[40:43], v[104:107]
    v_mfma_f32_16x16x32_bf16 v[108:111], a[12:15], a[40:43], v[108:111]
    s_waitcnt lgkmcnt(0)
    s_barrier
    v_mfma_f32_16x16x32_bf16 v[16:19], a[64:67], a[44:47], v[16:19]
    ds_read_b128 a[0:3], v8 offset:2048
    v_mfma_f32_16x16x32_bf16 v[20:23], a[64:67], a[48:51], v[20:23]
    ds_read_b64_tr_b16 a[20:21], v10 offset:0
    v_mfma_f32_16x16x32_bf16 v[24:27], a[64:67], a[52:55], v[24:27]
    ds_read_b64_tr_b16 a[22:23], v10 offset:512
    v_mfma_f32_16x16x32_bf16 v[28:31], a[64:67], a[56:59], v[28:31]
    ds_read_b128 a[4:7], v8 offset:4096
    v_mfma_f32_16x16x32_bf16 v[32:35], a[68:71], a[44:47], v[32:35]
    ds_read_b64_tr_b16 a[24:25], v11 offset:0
    v_mfma_f32_16x16x32_bf16 v[36:39], a[68:71], a[48:51], v[36:39]
    ds_read_b64_tr_b16 a[26:27], v11 offset:512
    v_mfma_f32_16x16x32_bf16 v[40:43], a[68:71], a[52:55], v[40:43]
    v_mfma_f32_16x16x32_bf16 v[44:47], a[68:71], a[56:59], v[44:47]
    ds_read_b128 a[8:11], v8 offset:6144
    v_mfma_f32_16x16x32_bf16 v[48:51], a[72:75], a[44:47], v[48:51]
    ds_read_b128 a[12:15], v8 offset:8192
    v_mfma_f32_16x16x32_bf16 v[52:55], a[72:75], a[48:51], v[52:55]
    ds_read_b64_tr_b16 a[28:29], v10 offset:8192
    v_mfma_f32_16x16x32_bf16 v[56:59], a[72:75], a[52:55], v[56:59]
    ds_read_b64_tr_b16 a[30:31], v10 offset:8704
    v_mfma_f32_16x16x32_bf16 v[60:63], a[72:75], a[56:59], v[60:63]
    ds_read_b64_tr_b16 a[32:33], v11 offset:8192
    v_mfma_f32_16x16x32_bf16 v[64:67], a[76:79], a[44:47], v[64:67]
    ds_read_b64_tr_b16 a[34:35], v11 offset:8704
    v_mfma_f32_16x16x32_bf16 v[68:71], a[76:79], a[48:51], v[68:71]
    v_mfma_f32_16x16x32_bf16 v[72:75], a[76:79], a[52:55], v[72:75]
    ds_read_b128 a[16:19], v8 offset:0
    v_mfma_f32_16x16x32_bf16 v[76:79], a[76:79], a[56:59], v[76:79]
    ds_read_b64_tr_b16 a[36:37], v10 offset:16384
    v_mfma_f32_16x16x32_bf16 v[112:115], a[72:75], a[60:63], v[112:115]
    ds_read_b64_tr_b16 a[38:39], v10 offset:16896
    v_mfma_f32_16x16x32_bf16 v[116:119], a[76:79], a[60:63], v[116:119]
    ds_read_b64_tr_b16 a[40:41], v11 offset:16384
    v_mfma_f32_16x16x32_bf16 v[80:83], a[44:47], a[80:83], v[80:83]
    ds_read_b64_tr_b16 a[42:43], v11 offset:16896
    v_mfma_f32_16x16x32_bf16 v[84:87], a[48:51], a[80:83], v[84:87]
    v_mfma_f32_16x16x32_bf16 v[88:91], a[52:55], a[80:83], v[88:91]
    v_mfma_f32_16x16x32_bf16 v[92:95], a[56:59], a[80:83], v[92:95]
    v_mfma_f32_16x16x32_bf16 v[96:99], a[44:47], a[84:87], v[96:99]
    v_mfma_f32_16x16x32_bf16 v[100:103], a[48:51], a[84:87], v[100:103]
    v_mfma_f32_16x16x32_bf16 v[104:107], a[52:55], a[84:87], v[104:107]
    v_mfma_f32_16x16x32_bf16 v[108:111], a[56:59], a[84:87], v[108:111]
    s_cmp_lt_u32 s64, 16
    s_waitcnt lgkmcnt(0)
    s_cbranch_scc1 g1_loop0
    s_barrier
    v_lshlrev_b32 v4, 2, v3
    v_lshlrev_b32 v5, 4, v2
    s_lshr_b32 s50, s30, 1
    s_lshl_b32 s51, s50, 7
    v_add_u32 v6, s51, v5
    v_add_u32 v7, s51, v4
    ds_read_b128 v[140:143], v6 offset:1152
    ds_read_b128 v[144:147], v6 offset:1216
    ds_read_b128 v[148:151], v6 offset:1408
    ds_read_b128 v[152:155], v6 offset:1472
    ds_read_b32 v156, v7 offset:1664
    ds_read_b32 v157, v7 offset:1728
    ds_read_b32 a0, v4 offset:64
    ds_read_b32 a1, v4 offset:640
    ds_read_b32 a2, v4 offset:128
    ds_read_b32 a3, v4 offset:704
    ds_read_b32 a4, v4 offset:192
    ds_read_b32 a5, v4 offset:768
    ds_read_b32 a6, v4 offset:256
    ds_read_b32 a7, v4 offset:832
    ds_read_b32 a8, v4 offset:0
    ds_read_b32 a9, v4 offset:576
    ds_read_b128 a[16:19], v5 offset:64
    ds_read_b128 a[20:23], v5 offset:640
    ds_read_b128 a[24:27], v5 offset:128
    ds_read_b128 a[28:31], v5 offset:704
    ds_read_b128 a[32:35], v5 offset:192
    ds_read_b128 a[36:39], v5 offset:768
    ds_read_b128 a[40:43], v5 offset:256
    ds_read_b128 a[44:47], v5 offset:832
    s_mov_b32 s52, 1048744942
    s_waitcnt lgkmcnt(0)
    v_accvgpr_read_b32 v12, a0
    v_accvgpr_read_b32 v14, a1
    v_mul_f32 v158, s52, v12
    v_mul_f32 v120, s52, v14
    v_pk_mul_f32 v[122:123], v[140:141], v[120:121] op_sel_hi:[1,0]
    v_pk_mul_f32 v[124:125], v[142:143], v[120:121] op_sel_hi:[1,0]
    v_pk_mul_f32 v[126:127], v[144:145], v[120:121] op_sel_hi:[1,0]
    v_pk_mul_f32 v[128:129], v[146:147], v[120:121] op_sel_hi:[1,0]
    v_pk_fma_f32 v[16:17], v[16:17], v[158:159], v[122:123] op_sel_hi:[1,0,1]
    v_pk_fma_f32 v[18:19], v[18:19], v[158:159], v[124:125] op_sel_hi:[1,0,1]
    v_pk_fma_f32 v[32:33], v[32:33], v[158:159], v[126:127] op_sel_hi:[1,0,1]
    v_pk_fma_f32 v[34:35], v[34:35], v[158:159], v[128:129] op_sel_hi:[1,0,1]
    v_cvt_pk_bf16_f32 v16, v16, v17
    v_cvt_pk_bf16_f32 v17, v18, v19
    v_cvt_pk_bf16_f32 v18, v32, v33
    v_cvt_pk_bf16_f32 v19, v34, v35
    v_pk_mul_f32 v[122:123], v[148:149], v[14:15] op_sel_hi:[1,0]
    v_pk_mul_f32 v[124:125], v[150:151], v[14:15] op_sel_hi:[1,0]
    v_pk_mul_f32 v[126:127], v[152:153], v[14:15] op_sel_hi:[1,0]
    v_pk_mul_f32 v[128:129], v[154:155], v[14:15] op_sel_hi:[1,0]
    v_pk_fma_f32 v[48:49], v[48:49], v[12:13], v[122:123] op_sel_hi:[1,0,1]
    v_pk_fma_f32 v[50:51], v[50:51], v[12:13], v[124:125] op_sel_hi:[1,0,1]
    v_pk_fma_f32 v[64:65], v[64:65], v[12:13], v[126:127] op_sel_hi:[1,0,1]
    v_pk_fma_f32 v[66:67], v[66:67], v[12:13], v[128:129] op_sel_hi:[1,0,1]
    v_cvt_pk_bf16_f32 v48, v48, v49
    v_cvt_pk_bf16_f32 v49, v50, v51
    v_cvt_pk_bf16_f32 v50, v64, v65
    v_cvt_pk_bf16_f32 v51, v66, v67
    v_accvgpr_read_b32 v12, a2
    v_accvgpr_read_b32 v14, a3
    v_mul_f32 v158, s52, v12
    v_mul_f32 v120, s52, v14
    v_pk_mul_f32 v[122:123], v[140:141], v[120:121] op_sel_hi:[1,0]
    v_pk_mul_f32 v[124:125], v[142:143], v[120:121] op_sel_hi:[1,0]
    v_pk_mul_f32 v[126:127], v[144:145], v[120:121] op_sel_hi:[1,0]
    v_pk_mul_f32 v[128:129], v[146:147], v[120:121] op_sel_hi:[1,0]
    v_pk_fma_f32 v[20:21], v[20:21], v[158:159], v[122:123] op_sel_hi:[1,0,1]
    v_pk_fma_f32 v[22:23], v[22:23], v[158:159], v[124:125] op_sel_hi:[1,0,1]
    v_pk_fma_f32 v[36:37], v[36:37], v[158:159], v[126:127] op_sel_hi:[1,0,1]
    v_pk_fma_f32 v[38:39], v[38:39], v[158:159], v[128:129] op_sel_hi:[1,0,1]
    v_cvt_pk_bf16_f32 v20, v20, v21
    v_cvt_pk_bf16_f32 v21, v22, v23
    v_cvt_pk_bf16_f32 v22, v36, v37
    v_cvt_pk_bf16_f32 v23, v38, v39
    v_pk_mul_f32 v[122:123], v[148:149], v[14:15] op_sel_hi:[1,0]
    v_pk_mul_f32 v[124:125], v[150:151], v[14:15] op_sel_hi:[1,0]
    v_pk_mul_f32 v[126:127], v[152:153], v[14:15] op_sel_hi:[1,0]
    v_pk_mul_f32 v[128:129], v[154:155], v[14:15] op_sel_hi:[1,0]
    v_pk_fma_f32 v[52:53], v[52:53], v[12:13], v[122:123] op_sel_hi:[1,0,1]
    v_pk_fma_f32 v[54:55], v[54:55], v[12:13], v[124:125] op_sel_hi:[1,0,1]
    v_pk_fma_f32 v[68:69], v[68:69], v[12:13], v[126:127] op_sel_hi:[1,0,1]
    v_pk_fma_f32 v[70:71], v[70:71], v[12:13], v[128:129] op_sel_hi:[1,0,1]
    v_cvt_pk_bf16_f32 v52, v52, v53
    v_cvt_pk_bf16_f32 v53, v54, v55
    v_cvt_pk_bf16_f32 v54, v68, v69
    v_cvt_pk_bf16_f32 v55, v70, v71
    v_accvgpr_read_b32 v12, a4
    v_accvgpr_read_b32 v14, a5
    v_mul_f32 v158, s52, v12
    v_mul_f32 v120, s52, v14
    v_pk_mul_f32 v[122:123], v[140:141], v[120:121] op_sel_hi:[1,0]
    v_pk_mul_f32 v[124:125], v[142:143], v[120:121] op_sel_hi:[1,0]
    v_pk_mul_f32 v[126:127], v[144:145], v[120:121] op_sel_hi:[1,0]
    v_pk_mul_f32 v[128:129], v[146:147], v[120:121] op_sel_hi:[1,0]
    v_pk_fma_f32 v[24:25], v[24:25], v[158:159], v[122:123] op_sel_hi:[1,0,1]
    v_pk_fma_f32 v[26:27], v[26:27], v[158:159], v[124:125] op_sel_hi:[1,0,1]
    v_pk_fma_f32 v[40:41], v[40:41], v[158:159], v[126:127] op_sel_hi:[1,0,1]
    v_pk_fma_f32 v[42:43], v[42:43], v[158:159], v[128:129] op_sel_hi:[1,0,1]
    v_cvt_pk_bf16_f32 v24, v24, v25
    v_cvt_pk_bf16_f32 v25, v26, v27
    v_cvt_pk_bf16_f32 v26, v40, v41
    v_cvt_pk_bf16_f32 v27, v42, v43
    v_pk_mul_f32 v[122:123], v[148:149], v[14:15] op_sel_hi:[1,0]
    v_pk_mul_f32 v[124:125], v[150:151], v[14:15] op_sel_hi:[1,0]
    v_pk_mul_f32 v[126:127], v[152:153], v[14:15] op_sel_hi:[1,0]
    v_pk_mul_f32 v[128:129], v[154:155], v[14:15] op_sel_hi:[1,0]
    v_pk_fma_f32 v[56:57], v[56:57], v[12:13], v[122:123] op_sel_hi:[1,0,1]
    v_pk_fma_f32 v[58:59], v[58:59], v[12:13], v[124:125] op_sel_hi:[1,0,1]
    v_pk_fma_f32 v[72:73], v[72:73], v[12:13], v[126:127] op_sel_hi:[1,0,1]
    v_pk_fma_f32 v[74:75], v[74:75], v[12:13], v[128:129] op_sel_hi:[1,0,1]
    v_cvt_pk_bf16_f32 v56, v56, v57
    v_cvt_pk_bf16_f32 v57, v58, v59
    v_cvt_pk_bf16_f32 v58, v72, v73
    v_cvt_pk_bf16_f32 v59, v74, v75
    v_accvgpr_read_b32 v12, a6
    v_accvgpr_read_b32 v14, a7
    v_mul_f32 v158, s52, v12
    v_mul_f32 v120, s52, v14
    v_pk_mul_f32 v[122:123], v[140:141], v[120:121] op_sel_hi:[1,0]
    v_pk_mul_f32 v[124:125], v[142:143], v[120:121] op_sel_hi:[1,0]
    v_pk_mul_f32 v[126:127], v[144:145], v[120:121] op_sel_hi:[1,0]
    v_pk_mul_f32 v[128:129], v[146:147], v[120:121] op_sel_hi:[1,0]
    v_pk_fma_f32 v[28:29], v[28:29], v[158:159], v[122:123] op_sel_hi:[1,0,1]
    v_pk_fma_f32 v[30:31], v[30:31], v[158:159], v[124:125] op_sel_hi:[1,0,1]
    v_pk_fma_f32 v[44:45], v[44:45], v[158:159], v[126:127] op_sel_hi:[1,0,1]
    v_pk_fma_f32 v[46:47], v[46:47], v[158:159], v[128:129] op_sel_hi:[1,0,1]
    v_cvt_pk_bf16_f32 v28, v28, v29
    v_cvt_pk_bf16_f32 v29, v30, v31
    v_cvt_pk_bf16_f32 v30, v44, v45
    v_cvt_pk_bf16_f32 v31, v46, v47
    v_pk_mul_f32 v[122:123], v[148:149], v[14:15] op_sel_hi:[1,0]
    v_pk_mul_f32 v[124:125], v[150:151], v[14:15] op_sel_hi:[1,0]
    v_pk_mul_f32 v[126:127], v[152:153], v[14:15] op_sel_hi:[1,0]
    v_pk_mul_f32 v[128:129], v[154:155], v[14:15] op_sel_hi:[1,0]
    v_pk_fma_f32 v[60:61], v[60:61], v[12:13], v[122:123] op_sel_hi:[1,0,1]
    v_pk_fma_f32 v[62:63], v[62:63], v[12:13], v[124:125] op_sel_hi:[1,0,1]
    v_pk_fma_f32 v[76:77], v[76:77], v[12:13], v[126:127] op_sel_hi:[1,0,1]
    v_pk_fma_f32 v[78:79], v[78:79], v[12:13], v[128:129] op_sel_hi:[1,0,1]
    v_cvt_pk_bf16_f32 v60, v60, v61
    v_cvt_pk_bf16_f32 v61, v62, v63
    v_cvt_pk_bf16_f32 v62, v76, v77
    v_cvt_pk_bf16_f32 v63, v78, v79
    v_accvgpr_read_b32 v12, a8
    v_accvgpr_read_b32 v14, a9
    v_pk_mul_f32 v[122:123], v[148:149], v[14:15] op_sel_hi:[1,0]
    v_pk_mul_f32 v[124:125], v[150:151], v[14:15] op_sel_hi:[1,0]
    v_pk_mul_f32 v[126:127], v[152:153], v[14:15] op_sel_hi:[1,0]
    v_pk_mul_f32 v[128:129], v[154:155], v[14:15] op_sel_hi:[1,0]
    v_pk_fma_f32 v[112:113], v[112:113], v[12:13], v[122:123] op_sel_hi:[1,0,1]
    v_pk_fma_f32 v[114:115], v[114:115], v[12:13], v[124:125] op_sel_hi:[1,0,1]
    v_pk_fma_f32 v[116:117], v[116:117], v[12:13], v[126:127] op_sel_hi:[1,0,1]
    v_pk_fma_f32 v[118:119], v[118:119], v[12:13], v[128:129] op_sel_hi:[1,0,1]
    v_cvt_pk_bf16_f32 v112, v112, v113
    v_cvt_pk_bf16_f32 v113, v114, v115
    v_cvt_pk_bf16_f32 v114, v116, v117
    v_cvt_pk_bf16_f32 v115, v118, v119
    v_mov_b32 v40, v156
    v_mov_b32 v42, v157
    s_mul_i32 s51, s50, 3072
    v_lshlrev_b32 v6, 4, v1
    v_add_u32 v6, s51, v6
    v_accvgpr_read_b32 v32, a40
    v_accvgpr_read_b32 v33, a41
    v_accvgpr_read_b32 v34, a42
    v_accvgpr_read_b32 v35, a43
    v_accvgpr_read_b32 v36, a44
    v_accvgpr_read_b32 v37, a45
    v_accvgpr_read_b32 v38, a46
    v_accvgpr_read_b32 v39, a47
    v_pk_mul_f32 v[64:65], v[36:37], v[40:41] op_sel_hi:[1,0]
    v_pk_mul_f32 v[66:67], v[38:39], v[40:41] op_sel_hi:[1,0]
    v_pk_mul_f32 v[68:69], v[36:37], v[42:43] op_sel_hi:[1,0]
    v_pk_mul_f32 v[70:71], v[38:39], v[42:43] op_sel_hi:[1,0]
    v_pk_fma_f32 v[92:93], v[92:93], v[32:33], v[64:65]
    v_pk_fma_f32 v[94:95], v[94:95], v[34:35], v[66:67]
    v_pk_fma_f32 v[108:109], v[108:109], v[32:33], v[68:69]
    v_pk_fma_f32 v[110:111], v[110:111], v[34:35], v[70:71]
    v_cvt_pk_bf16_f32 v128, v92, v93
    v_cvt_pk_bf16_f32 v129, v94, v95
    v_cvt_pk_bf16_f32 v138, v108, v109
    v_cvt_pk_bf16_f32 v139, v110, v111
    ds_write_b128 v6, v[60:63] offset:3072
    ds_write_b64 v6, v[128:129] offset:4096
    ds_write_b64 v6, v[138:139] offset:4104
    v_accvgpr_read_b32 v32, a16
    v_accvgpr_read_b32 v33, a17
    v_accvgpr_read_b32 v34, a18
    v_accvgpr_read_b32 v35, a19
    v_accvgpr_read_b32 v36, a20
    v_accvgpr_read_b32 v37, a21
    v_accvgpr_read_b32 v38, a22
    v_accvgpr_read_b32 v39, a23
    v_pk_mul_f32 v[64:65], v[36:37], v[40:41] op_sel_hi:[1,0]
    v_pk_mul_f32 v[66:67], v[38:39], v[40:41] op_sel_hi:[1,0]
    v_pk_mul_f32 v[68:69], v[36:37], v[42:43] op_sel_hi:[1,0]
    v_pk_mul_f32 v[70:71], v[38:39], v[42:43] op_sel_hi:[1,0]
    v_pk_fma_f32 v[80:81], v[80:81], v[32:33], v[64:65]
    v_pk_fma_f32 v[82:83], v[82:83], v[34:35], v[66:67]
    v_pk_fma_f32 v[96:97], v[96:97], v[32:33], v[68:69]
    v_pk_fma_f32 v[98:99], v[98:99], v[34:35], v[70:71]
    v_cvt_pk_bf16_f32 v122, v80, v81
    v_cvt_pk_bf16_f32 v123, v82, v83
    v_cvt_pk_bf16_f32 v132, v96, v97
    v_cvt_pk_bf16_f32 v133, v98, v99
    v_accvgpr_read_b32 v32, a24
    v_accvgpr_read_b32 v33, a25
    v_accvgpr_read_b32 v34, a26
    v_accvgpr_read_b32 v35, a27
    v_accvgpr_read_b32 v36, a28
    v_accvgpr_read_b32 v37, a29
    v_accvgpr_read_b32 v38, a30
    v_accvgpr_read_b32 v39, a31
    v_pk_mul_f32 v[64:65], v[36:37], v[40:41] op_sel_hi:[1,0]
    v_pk_mul_f32 v[66:67], v[38:39], v[40:41] op_sel_hi:[1,0]
    v_pk_mul_f32 v[68:69], v[36:37], v[42:43] op_sel_hi:[1,0]
    v_pk_mul_f32 v[70:71], v[38:39], v[42:43] op_sel_hi:[1,0]
    v_pk_fma_f32 v[84:85], v[84:85], v[32:33], v[64:65]
    v_pk_fma_f32 v[86:87], v[86:87], v[34:35], v[66:67]
    v_pk_fma_f32 v[100:101], v[100:101], v[32:33], v[68:69]
    v_pk_fma_f32 v[102:103], v[102:103], v[34:35], v[70:71]
    v_cvt_pk_bf16_f32 v124, v84, v85
    v_cvt_pk_bf16_f32 v125, v86, v87
    v_cvt_pk_bf16_f32 v134, v100, v101
    v_cvt_pk_bf16_f32 v135, v102, v103
    v_accvgpr_read_b32 v32, a32
    v_accvgpr_read_b32 v33, a33
    v_accvgpr_read_b32 v34, a34
    v_accvgpr_read_b32 v35, a35
    v_accvgpr_read_b32 v36, a36
    v_accvgpr_read_b32 v37, a37
    v_accvgpr_read_b32 v38, a38
    v_accvgpr_read_b32 v39, a39
    v_pk_mul_f32 v[64:65], v[36:37], v[40:41] op_sel_hi:[1,0]
    v_pk_mul_f32 v[66:67], v[38:39], v[40:41] op_sel_hi:[1,0]
    v_pk_mul_f32 v[68:69], v[36:37], v[42:43] op_sel_hi:[1,0]
    v_pk_mul_f32 v[70:71], v[38:39], v[42:43] op_sel_hi:[1,0]
    v_pk_fma_f32 v[88:89], v[88:89], v[32:33], v[64:65]
    v_pk_fma_f32 v[90:91], v[90:91], v[34:35], v[66:67]
    v_pk_fma_f32 v[104:105], v[104:105], v[32:33], v[68:69]
    v_pk_fma_f32 v[106:107], v[106:107], v[34:35], v[70:71]
    v_cvt_pk_bf16_f32 v126, v88, v89
    v_cvt_pk_bf16_f32 v127, v90, v91
    v_cvt_pk_bf16_f32 v136, v104, v105
    v_cvt_pk_bf16_f32 v137, v106, v107
    s_waitcnt lgkmcnt(0)
    s_barrier
    ds_read_b64 v[120:121], v6 offset:2048
    ds_read_b64 v[130:131], v6 offset:2056
    s_mov_b32 s53, 4048155338
    v_lshlrev_b32 v12, 2, v2
    v_sub_u32 v12, v12, v3
    v_mov_b32 v15, s53
    v_mov_b32 v158, 0
    v_add_u32 v13, 0, v12
    v_and_b32 v14, 1, v13
    v_cmp_le_i32 vcc, 2, v13
    v_cmp_eq_u32 s[54:55], 0, v14
    s_nop 3
    s_and_b64 vcc, vcc, s[54:55]
    v_cndmask_b32 v140, v15, v158, vcc
    v_cmp_ge_i32 vcc, 0, v13
    s_nop 3
    s_and_b64 vcc, vcc, s[54:55]
    v_cndmask_b32 v144, v15, v158, vcc
    v_add_u32 v13, 1, v12
    v_and_b32 v14, 1, v13
    v_cmp_le_i32 vcc, 2, v13
    v_cmp_eq_u32 s[54:55], 0, v14
    s_nop 3
    s_and_b64 vcc, vcc, s[54:55]
    v_cndmask_b32 v141, v15, v158, vcc
    v_cmp_ge_i32 vcc, 0, v13
    s_nop 3
    s_and_b64 vcc, vcc, s[54:55]
    v_cndmask_b32 v145, v15, v158, vcc
    v_add_u32 v13, 2, v12
    v_and_b32 v14, 1, v13
    v_cmp_le_i32 vcc, 2, v13
    v_cmp_eq_u32 s[54:55], 0, v14
    s_nop 3
    s_and_b64 vcc, vcc, s[54:55]
    v_cndmask_b32 v142, v15, v158, vcc
    v_cmp_ge_i32 vcc, 0, v13
    s_nop 3
    s_and_b64 vcc, vcc, s[54:55]
    v_cndmask_b32 v146, v15, v158, vcc
    v_add_u32 v13, 3, v12
    v_and_b32 v14, 1, v13
    v_cmp_le_i32 vcc, 2, v13
    v_cmp_eq_u32 s[54:55], 0, v14
    s_nop 3
    s_and_b64 vcc, vcc, s[54:55]
    v_cndmask_b32 v143, v15, v158, vcc
    v_cmp_ge_i32 vcc, 0, v13
    s_nop 3
    s_and_b64 vcc, vcc, s[54:55]
    v_cndmask_b32 v147, v15, v158, vcc
    v_mfma_f32_16x16x32_bf16 v[92:95], v[52:55], v[20:23], 0
    v_mfma_f32_16x16x32_bf16 v[88:91], v[48:51], v[20:23], 0
    v_mfma_f32_16x16x32_bf16 v[100:103], v[56:59], v[24:27], 0
    v_mfma_f32_16x16x32_bf16 v[96:99], v[52:55], v[24:27], 0
    v_mfma_f32_16x16x32_bf16 v[108:111], v[60:63], v[28:31], 0
    v_mfma_f32_16x16x32_bf16 v[104:107], v[56:59], v[28:31], 0
    s_waitcnt lgkmcnt(0)
    v_mfma_f32_16x16x32_bf16 v[84:87], v[48:51], v[16:19], 0
    v_mfma_f32_16x16x32_bf16 v[80:83], v[112:115], v[16:19], 0
    s_cmp_eq_u32 s26, 0
    s_cselect_b32 s54, s53, 0
    v_pk_add_f32 v[88:89], v[88:89], v[140:141]
    v_pk_add_f32 v[92:93], v[92:93], v[144:145]
    v_pk_add_f32 v[90:91], v[90:91], v[142:143]
    v_pk_add_f32 v[94:95], v[94:95], v[146:147]
    v_pk_add_f32 v[96:97], v[96:97], v[140:141]
    v_pk_add_f32 v[100:101], v[100:101], v[144:145]
    v_pk_add_f32 v[98:99], v[98:99], v[142:143]
    v_pk_add_f32 v[102:103], v[102:103], v[146:147]
    v_pk_add_f32 v[104:105], v[104:105], v[140:141]
    v_pk_add_f32 v[108:109], v[108:109], v[144:145]
    v_pk_add_f32 v[106:107], v[106:107], v[142:143]
    v_pk_add_f32 v[110:111], v[110:111], v[146:147]
    v_pk_add_f32 v[80:81], v[80:81], v[140:141]
    v_pk_add_f32 v[84:85], v[84:85], v[144:145]
    v_pk_add_f32 v[82:83], v[82:83], v[142:143]
    v_pk_add_f32 v[86:87], v[86:87], v[146:147]
    v_add_f32 v80, s54, v80
    v_add_f32 v81, s54, v81
    v_add_f32 v82, s54, v82
    v_add_f32 v83, s54, v83
    v_max3_f32 v33, v88, v89, v90
    v_max3_f32 v37, v91, v92, v93
    v_max3_f32 v34, v96, v97, v98
    v_max3_f32 v38, v99, v100, v101
    v_max3_f32 v35, v104, v105, v106
    v_max3_f32 v39, v107, v108, v109
    v_max3_f32 v32, v80, v81, v82
    v_max3_f32 v36, v83, v84, v85
    v_max3_f32 v33, v33, v94, v95
    v_max3_f32 v34, v34, v102, v103
    v_max3_f32 v35, v35, v110, v111
    v_max3_f32 v32, v32, v86, v87
    v_max_f32 v33, v33, v37
    v_max_f32 v34, v34, v38
    v_max_f32 v35, v35, v39
    v_max_f32 v32, v32, v36
    v_mov_b32 v37, v33
    v_mov_b32 v38, v34
    v_mov_b32 v39, v35
    v_mov_b32 v36, v32
    v_permlane32_swap_b32 v33, v37
    v_permlane32_swap_b32 v34, v38
    v_permlane32_swap_b32 v35, v39
    v_permlane32_swap_b32 v32, v36
    v_max_f32 v33, v33, v37
    v_max_f32 v34, v34, v38
    v_max_f32 v35, v35, v39
    v_max_f32 v32, v32, v36
    v_mov_b32 v37, v33
    v_mov_b32 v38, v34
    v_mov_b32 v39, v35
    v_mov_b32 v36, v32
    v_permlane16_swap_b32 v33, v37
    v_permlane16_swap_b32 v34, v38
    v_permlane16_swap_b32 v35, v39
    v_permlane16_swap_b32 v32, v36
    v_max_f32 v33, v33, v37
    v_max_f32 v34, v34, v38
    v_max_f32 v35, v35, v39
    v_max_f32 v32, v32, v36
    v_sub_f32 v88, v88, v33
    v_sub_f32 v89, v89, v33
    v_sub_f32 v90, v90, v33
    v_sub_f32 v91, v91, v33
    v_sub_f32 v92, v92, v33
    v_sub_f32 v93, v93, v33
    v_sub_f32 v94, v94, v33
    v_sub_f32 v95, v95, v33
    v_sub_f32 v96, v96, v34
    v_sub_f32 v97, v97, v34
    v_sub_f32 v98, v98, v34
    v_sub_f32 v99, v99, v34
    v_sub_f32 v100, v100, v34
    v_sub_f32 v101, v101, v34
    v_sub_f32 v102, v102, v34
    v_sub_f32 v103, v103, v34
    v_sub_f32 v104, v104, v35
    v_sub_f32 v105, v105, v35
    v_sub_f32 v106, v106, v35
    v_sub_f32 v107, v107, v35
    v_sub_f32 v108, v108, v35
    v_sub_f32 v109, v109, v35
    v_sub_f32 v110, v110, v35
    v_sub_f32 v111, v111, v35
    v_sub_f32 v80, v80, v32
    v_sub_f32 v81, v81, v32
    v_sub_f32 v82, v82, v32
    v_sub_f32 v83, v83, v32
    v_sub_f32 v84, v84, v32
    v_sub_f32 v85, v85, v32
    v_sub_f32 v86, v86, v32
    v_sub_f32 v87, v87, v32
    v_exp_f32 v88, v88
    v_exp_f32 v89, v89
    v_exp_f32 v90, v90
    v_exp_f32 v91, v91
    v_exp_f32 v92, v92
    v_exp_f32 v93, v93
    v_exp_f32 v94, v94
    v_exp_f32 v95, v95
    v_exp_f32 v96, v96
    v_exp_f32 v97, v97
    v_exp_f32 v98, v98
    v_exp_f32 v99, v99
    v_exp_f32 v100, v100
    v_exp_f32 v101, v101
    v_exp_f32 v102, v102
    v_exp_f32 v103, v103
    v_exp_f32 v104, v104
    v_exp_f32 v105, v105
    v_exp_f32 v106, v106
    v_exp_f32 v107, v107
    v_exp_f32 v108, v108
    v_exp_f32 v109, v109
    v_exp_f32 v110, v110
    v_exp_f32 v111, v111
    v_exp_f32 v80, v80
    v_exp_f32 v81, v81
    v_exp_f32 v82, v82
    v_exp_f32 v83, v83
    v_exp_f32 v84, v84
    v_exp_f32 v85, v85
    v_exp_f32 v86, v86
    v_exp_f32 v87, v87
    v_cvt_pk_bf16_f32 v68, v88, v89
    v_cvt_pk_bf16_f32 v69, v90, v91
    v_cvt_pk_bf16_f32 v70, v92, v93
    v_cvt_pk_bf16_f32 v71, v94, v95
    v_cvt_pk_bf16_f32 v72, v96, v97
    v_cvt_pk_bf16_f32 v73, v98, v99
    v_cvt_pk_bf16_f32 v74, v100, v101
    v_cvt_pk_bf16_f32 v75, v102, v103
    v_cvt_pk_bf16_f32 v76, v104, v105
    v_cvt_pk_bf16_f32 v77, v106, v107
    v_cvt_pk_bf16_f32 v78, v108, v109
    v_cvt_pk_bf16_f32 v79, v110, v111
    v_cvt_pk_bf16_f32 v64, v80, v81
    v_cvt_pk_bf16_f32 v65, v82, v83
    v_cvt_pk_bf16_f32 v66, v84, v85
    v_cvt_pk_bf16_f32 v67, v86, v87
    v_pk_add_f32 v[88:89], v[88:89], v[90:91]
    v_pk_add_f32 v[92:93], v[92:93], v[94:95]
    v_pk_add_f32 v[96:97], v[96:97], v[98:99]
    v_pk_add_f32 v[100:101], v[100:101], v[102:103]
    v_pk_add_f32 v[104:105], v[104:105], v[106:107]
    v_pk_add_f32 v[108:109], v[108:109], v[110:111]
    v_pk_add_f32 v[80:81], v[80:81], v[82:83]
    v_pk_add_f32 v[84:85], v[84:85], v[86:87]
    v_pk_add_f32 v[88:89], v[88:89], v[92:93]
    v_pk_add_f32 v[96:97], v[96:97], v[100:101]
    v_pk_add_f32 v[104:105], v[104:105], v[108:109]
    v_pk_add_f32 v[80:81], v[80:81], v[84:85]
    v_add_f32 v41, v88, v89
    v_add_f32 v42, v96, v97
    v_add_f32 v43, v104, v105
    v_add_f32 v40, v80, v81
    v_mfma_f32_16x16x32_bf16 v[88:91], v[122:125], v[68:71], 0
    v_mfma_f32_16x16x32_bf16 v[92:95], v[132:135], v[68:71], 0
    v_mfma_f32_16x16x32_bf16 v[96:99], v[124:127], v[72:75], 0
    v_mfma_f32_16x16x32_bf16 v[100:103], v[134:137], v[72:75], 0
    v_mfma_f32_16x16x32_bf16 v[104:107], v[126:129], v[76:79], 0
    v_mfma_f32_16x16x32_bf16 v[108:111], v[136:139], v[76:79], 0
    v_mfma_f32_16x16x32_bf16 v[80:83], v[120:123], v[64:67], 0
    v_mfma_f32_16x16x32_bf16 v[84:87], v[130:133], v[64:67], 0
    v_mov_b32 v37, v41
    v_mov_b32 v38, v42
    v_mov_b32 v39, v43
    v_mov_b32 v36, v40
    v_permlane32_swap_b32 v41, v37
    v_permlane32_swap_b32 v42, v38
    v_permlane32_swap_b32 v43, v39
    v_permlane32_swap_b32 v40, v36
    v_add_f32 v41, v41, v37
    v_add_f32 v42, v42, v38
    v_add_f32 v43, v43, v39
    v_add_f32 v40, v40, v36
    v_mov_b32 v37, v41
    v_mov_b32 v38, v42
    v_mov_b32 v39, v43
    v_mov_b32 v36, v40
    v_permlane16_swap_b32 v41, v37
    v_permlane16_swap_b32 v42, v38
    v_permlane16_swap_b32 v43, v39
    v_permlane16_swap_b32 v40, v36
    v_add_f32 v41, v41, v37
    v_add_f32 v42, v42, v38
    v_add_f32 v43, v43, v39
    v_add_f32 v40, v40, v36
    v_rcp_f32 v41, v41
    v_rcp_f32 v42, v42
    v_rcp_f32 v43, v43
    v_rcp_f32 v40, v40
    s_lshl_b32 s51, s26, 7
    s_add_u32 s51, s51, 0
    v_add_u32 v12, s51, v3
    v_lshlrev_b32 v12, 11, v12
    v_and_b32 v13, 1, v2
    v_lshlrev_b32 v13, 5, v13
    v_lshrrev_b32 v14, 1, v2
    v_lshlrev_b32 v14, 4, v14
    v_add3_u32 v12, v12, v13, v14
    s_lshl_b32 s51, s3, 7
    s_lshl_b32 s52, s50, 6
    s_add_u32 s51, s51, s52
    s_add_u32 s51, s51, 0
    v_pk_mul_f32 v[88:89], v[88:89], v[40:41] op_sel:[0,1] op_sel_hi:[1,1]
    v_pk_mul_f32 v[90:91], v[90:91], v[40:41] op_sel:[0,1] op_sel_hi:[1,1]
    v_pk_mul_f32 v[92:93], v[92:93], v[40:41] op_sel:[0,1] op_sel_hi:[1,1]
    v_pk_mul_f32 v[94:95], v[94:95], v[40:41] op_sel:[0,1] op_sel_hi:[1,1]
    v_cvt_pk_bf16_f32 v68, v88, v89
    v_cvt_pk_bf16_f32 v69, v90, v91
    v_cvt_pk_bf16_f32 v70, v92, v93
    v_cvt_pk_bf16_f32 v71, v94, v95
    s_nop 0
    v_permlane16_swap_b32 v68, v70
    v_permlane16_swap_b32 v69, v71
    s_add_u32 s52, s51, 32768
    buffer_store_dwordx4 v[68:71], v12, s[32:35], s52 offen sc1
    v_pk_mul_f32 v[96:97], v[96:97], v[42:43] op_sel:[0,0] op_sel_hi:[1,0]
    v_pk_mul_f32 v[98:99], v[98:99], v[42:43] op_sel:[0,0] op_sel_hi:[1,0]
    v_pk_mul_f32 v[100:101], v[100:101], v[42:43] op_sel:[0,0] op_sel_hi:[1,0]
    v_pk_mul_f32 v[102:103], v[102:103], v[42:43] op_sel:[0,0] op_sel_hi:[1,0]
    v_cvt_pk_bf16_f32 v72, v96, v97
    v_cvt_pk_bf16_f32 v73, v98, v99
    v_cvt_pk_bf16_f32 v74, v100, v101
    v_cvt_pk_bf16_f32 v75, v102, v103
    s_nop 0
    v_permlane16_swap_b32 v72, v74
    v_permlane16_swap_b32 v73, v75
    s_add_u32 s52, s51, 65536
    buffer_store_dwordx4 v[72:75], v12, s[32:35], s52 offen sc1
    v_pk_mul_f32 v[104:105], v[104:105], v[42:43] op_sel:[0,1] op_sel_hi:[1,1]
    v_pk_mul_f32 v[106:107], v[106:107], v[42:43] op_sel:[0,1] op_sel_hi:[1,1]
    v_pk_mul_f32 v[108:109], v[108:109], v[42:43] op_sel:[0,1] op_sel_hi:[1,1]
    v_pk_mul_f32 v[110:111], v[110:111], v[42:43] op_sel:[0,1] op_sel_hi:[1,1]
    v_cvt_pk_bf16_f32 v76, v104, v105
    v_cvt_pk_bf16_f32 v77, v106, v107
    v_cvt_pk_bf16_f32 v78, v108, v109
    v_cvt_pk_bf16_f32 v79, v110, v111
    s_nop 0
    v_permlane16_swap_b32 v76, v78
    v_permlane16_swap_b32 v77, v79
    s_add_u32 s52, s51, 98304
    buffer_store_dwordx4 v[76:79], v12, s[32:35], s52 offen sc1
    v_pk_mul_f32 v[80:81], v[80:81], v[40:41] op_sel:[0,0] op_sel_hi:[1,0]
    v_pk_mul_f32 v[82:83], v[82:83], v[40:41] op_sel:[0,0] op_sel_hi:[1,0]
    v_pk_mul_f32 v[84:85], v[84:85], v[40:41] op_sel:[0,0] op_sel_hi:[1,0]
    v_pk_mul_f32 v[86:87], v[86:87], v[40:41] op_sel:[0,0] op_sel_hi:[1,0]
    v_cvt_pk_bf16_f32 v64, v80, v81
    v_cvt_pk_bf16_f32 v65, v82, v83
    v_cvt_pk_bf16_f32 v66, v84, v85
    v_cvt_pk_bf16_f32 v67, v86, v87
    s_nop 0
    v_permlane16_swap_b32 v64, v66
    v_permlane16_swap_b32 v65, v67
    s_add_u32 s52, s51, 0
    buffer_store_dwordx4 v[64:67], v12, s[32:35], s52 offen sc1
    s_barrier
    s_waitcnt vmcnt(0)
    s_barrier
    s_branch g1_cend
g1_c1:
    v_lshrrev_b32 v4, 1, v3
    v_xor_b32 v4, v2, v4
    v_lshlrev_b32 v4, 4, v4
    v_lshlrev_b32 v5, 7, v3
    v_add_u32 v8, v4, v5
    v_add_u32 v8, 8192, v8
    v_xor_b32 v9, 64, v8
    s_lshr_b32 s50, s30, 1
    s_lshl_b32 s50, s50, 1
    s_add_u32 s51, s50, 1
    v_lshrrev_b32 v4, 2, v3
    v_and_b32 v5, 3, v3
    v_lshrrev_b32 v6, 1, v4
    v_and_b32 v7, 1, v2
    v_lshlrev_b32 v7, 1, v7
    v_or_b32 v6, v6, v7
    v_lshlrev_b32 v7, 3, v2
    v_add_u32 v7, v7, v4
    v_lshlrev_b32 v7, 7, v7
    v_lshlrev_b32 v12, 3, v5
    v_add_u32 v7, v7, v12
    v_add_u32 v7, 63488, v7
    v_xor_b32 v12, s50, v6
    v_lshlrev_b32 v12, 5, v12
    v_add_u32 v10, v12, v7
    v_xor_b32 v12, s51, v6
    v_lshlrev_b32 v12, 5, v12
    v_add_u32 v11, v12, v7
    v_mov_b32 v16, 0
    v_mov_b32 v17, 0
    v_mov_b32 v18, 0
    v_mov_b32 v19, 0
    v_mov_b32 v20, 0
    v_mov_b32 v21, 0
    v_mov_b32 v22, 0
    v_mov_b32 v23, 0
    v_mov_b32 v24, 0
    v_mov_b32 v25, 0
    v_mov_b32 v26, 0
    v_mov_b32 v27, 0
    v_mov_b32 v28, 0
    v_mov_b32 v29, 0
    v_mov_b32 v30, 0
    v_mov_b32 v31, 0
    v_mov_b32 v32, 0
    v_mov_b32 v33, 0
    v_mov_b32 v34, 0
    v_mov_b32 v35, 0
    v_mov_b32 v36, 0
    v_mov_b32 v37, 0
    v_mov_b32 v38, 0
    v_mov_b32 v39, 0
    v_mov_b32 v40, 0
    v_mov_b32 v41, 0
    v_mov_b32 v42, 0
    v_mov_b32 v43, 0
    v_mov_b32 v44, 0
    v_mov_b32 v45, 0
    v_mov_b32 v46, 0
    v_mov_b32 v47, 0
    v_mov_b32 v48, 0
    v_mov_b32 v49, 0
    v_mov_b32 v50, 0
    v_mov_b32 v51, 0
    v_mov_b32 v52, 0
    v_mov_b32 v53, 0
    v_mov_b32 v54, 0
    v_mov_b32 v55, 0
    v_mov_b32 v56, 0
    v_mov_b32 v57, 0
    v_mov_b32 v58, 0
    v_mov_b32 v59, 0
    v_mov_b32 v60, 0
    v_mov_b32 v61, 0
    v_mov_b32 v62, 0
    v_mov_b32 v63, 0
    v_mov_b32 v64, 0
    v_mov_b32 v65, 0
    v_mov_b32 v66, 0
    v_mov_b32 v67, 0
    v_mov_b32 v68, 0
    v_mov_b32 v69, 0
    v_mov_b32 v70, 0
    v_mov_b32 v71, 0
    v_mov_b32 v72, 0
    v_mov_b32 v73, 0
    v_mov_b32 v74, 0
    v_mov_b32 v75, 0
    v_mov_b32 v76, 0
    v_mov_b32 v77, 0
    v_mov_b32 v78, 0
    v_mov_b32 v79, 0
    v_mov_b32 v80, 0
    v_mov_b32 v81, 0
    v_mov_b32 v82, 0
    v_mov_b32 v83, 0
    v_mov_b32 v84, 0
    v_mov_b32 v85, 0
    v_mov_b32 v86, 0
    v_mov_b32 v87, 0
    v_mov_b32 v88, 0
    v_mov_b32 v89, 0
    v_mov_b32 v90, 0
    v_mov_b32 v91, 0
    v_mov_b32 v92, 0
    v_mov_b32 v93, 0
    v_mov_b32 v94, 0
    v_mov_b32 v95, 0
    v_mov_b32 v96, 0
    v_mov_b32 v97, 0
    v_mov_b32 v98, 0
    v_mov_b32 v99, 0
    v_mov_b32 v100, 0
    v_mov_b32 v101, 0
    v_mov_b32 v102, 0
    v_mov_b32 v103, 0
    v_mov_b32 v104, 0
    v_mov_b32 v105, 0
    v_mov_b32 v106, 0
    v_mov_b32 v107, 0
    v_mov_b32 v108, 0
    v_mov_b32 v109, 0
    v_mov_b32 v110, 0
    v_mov_b32 v111, 0
    v_mov_b32 v112, 0
    v_mov_b32 v113, 0
    v_mov_b32 v114, 0
    v_mov_b32 v115, 0
    v_mov_b32 v116, 0
    v_mov_b32 v117, 0
    v_mov_b32 v118, 0
    v_mov_b32 v119, 0
    s_cmp_eq_u32 s30, 0
    s_cselect_b32 s36, s8, s12
    s_cselect_b32 s37, s9, s13
    s_mov_b32 s52, 7340032
    s_cselect_b32 s38, 2097152, s52
    s_mov_b32 s39, 0x20000
    s_mul_i32 s53, s2, 28672
    s_lshl_b32 s54, s30, 13
    s_add_u32 s53, s53, s54
    s_sub_u32 s53, s53, 8192
    s_lshl_b32 s54, s2, 13
    s_cmp_eq_u32 s30, 0
    s_cselect_b32 s56, s54, s53
    s_and_b32 s37, s37, 0xffff
    s_cmp_eq_u32 s30, 0
    s_cselect_b32 s40, s12, s14
    s_cselect_b32 s41, s13, s15
    s_mov_b32 s52, 8388608
    s_cselect_b32 s42, 7340032, s52
    s_mov_b32 s43, 0x20000
    s_mul_i32 s53, s2, 28672
    s_add_u32 s53, s53, 24576
    s_lshl_b32 s54, s2, 15
    s_lshl_b32 s55, s30, 13
    s_add_u32 s54, s54, s55
    s_sub_u32 s54, s54, 8192
    s_cmp_eq_u32 s30, 0
    s_cselect_b32 s57, s53, s54
    s_and_b32 s41, s41, 0xffff
    s_cmp_eq_u32 s30, 0
    s_cselect_b32 s44, s14, s18
    s_cselect_b32 s45, s15, s19
    s_mov_b32 s52, 3670016
    s_cselect_b32 s46, 8388608, s52
    s_mov_b32 s47, 0x20000
    s_lshl_b32 s53, s2, 15
    s_add_u32 s53, s53, 24576
    s_mul_i32 s54, s2, 14336
    s_min_u32 s55, s30, 2
    s_lshl_b32 s55, s55, 13
    s_add_u32 s54, s54, s55
    s_sub_u32 s54, s54, 8192
    s_cmp_eq_u32 s30, 0
    s_cselect_b32 s58, s53, s54
    s_and_b32 s45, s45, 0xffff
    v_lshlrev_b32 v149, 7, v1
    s_add_u32 s59, s30, 3
    s_mov_b32 s65, 0
    s_mov_b32 s67, 0
    s_barrier
    ds_read_b128 a[0:3], v8 offset:10240
    ds_read_b64_tr_b16 a[20:21], v10 offset:0
    ds_read_b64_tr_b16 a[22:23], v10 offset:512
    ds_read_b128 a[4:7], v8 offset:12288
    ds_read_b64_tr_b16 a[24:25], v11 offset:0
    ds_read_b64_tr_b16 a[26:27], v11 offset:512
    ds_read_b128 a[8:11], v8 offset:14336
    ds_read_b128 a[12:15], v8 offset:16384
    ds_read_b64_tr_b16 a[28:29], v10 offset:8192
    ds_read_b64_tr_b16 a[30:31], v10 offset:8704
    ds_read_b64_tr_b16 a[32:33], v11 offset:8192
    ds_read_b64_tr_b16 a[34:35], v11 offset:8704
    ds_read_b128 a[16:19], v8 offset:0
    ds_read_b64_tr_b16 a[36:37], v10 offset:16384
    ds_read_b64_tr_b16 a[38:39], v10 offset:16896
    ds_read_b64_tr_b16 a[40:41], v11 offset:16384
    ds_read_b64_tr_b16 a[42:43], v11 offset:16896
    s_waitcnt lgkmcnt(0)
    s_mov_b32 s64, 0
g1_loop1:
    v_mfma_f32_16x16x32_bf16 v[16:19], a[20:23], a[0:3], v[16:19]
    ds_read_b128 a[44:47], v9 offset:10240
    s_add_u32 s65, s65, 1
    v_mfma_f32_16x16x32_bf16 v[20:23], a[20:23], a[4:7], v[20:23]
    ds_read_b64_tr_b16 a[64:65], v10 offset:4096
    s_cmp_eq_u32 s65, 3
    v_mfma_f32_16x16x32_bf16 v[24:27], a[20:23], a[8:11], v[24:27]
    ds_read_b64_tr_b16 a[66:67], v10 offset:4608
    s_mov_b32 s66, 18432
    v_mfma_f32_16x16x32_bf16 v[28:31], a[20:23], a[12:15], v[28:31]
    ds_read_b128 a[48:51], v9 offset:12288
    s_cselect_b32 s66, 4294930432, s66
    v_mfma_f32_16x16x32_bf16 v[32:35], a[24:27], a[0:3], v[32:35]
    ds_read_b64_tr_b16 a[68:69], v11 offset:4096
    s_cselect_b32 s65, 0, s65
    v_mfma_f32_16x16x32_bf16 v[36:39], a[24:27], a[4:7], v[36:39]
    ds_read_b64_tr_b16 a[70:71], v11 offset:4608
    s_add_u32 s67, s67, 1
    v_mfma_f32_16x16x32_bf16 v[40:43], a[24:27], a[8:11], v[40:43]
    s_cmp_eq_u32 s67, 3
    v_mfma_f32_16x16x32_bf16 v[44:47], a[24:27], a[12:15], v[44:47]
    ds_read_b128 a[52:55], v9 offset:14336
    s_mov_b32 s62, 24576
    v_mfma_f32_16x16x32_bf16 v[48:51], a[28:31], a[0:3], v[48:51]
    ds_read_b128 a[56:59], v9 offset:16384
    s_cselect_b32 s62, 4294918144, s62
    v_mfma_f32_16x16x32_bf16 v[52:55], a[28:31], a[4:7], v[52:55]
    ds_read_b64_tr_b16 a[72:73], v10 offset:12288
    s_cselect_b32 s67, 0, s67
    v_mfma_f32_16x16x32_bf16 v[56:59], a[28:31], a[8:11], v[56:59]
    ds_read_b64_tr_b16 a[74:75], v10 offset:12800
    s_add_u32 s64, s64, 1
    v_mfma_f32_16x16x32_bf16 v[60:63], a[28:31], a[12:15], v[60:63]
    ds_read_b64_tr_b16 a[76:77], v11 offset:12288
    v_mfma_f32_16x16x32_bf16 v[64:67], a[32:35], a[0:3], v[64:67]
    ds_read_b64_tr_b16 a[78:79], v11 offset:12800
    v_mfma_f32_16x16x32_bf16 v[68:71], a[32:35], a[4:7], v[68:71]
    v_mfma_f32_16x16x32_bf16 v[72:75], a[32:35], a[8:11], v[72:75]
    ds_read_b128 a[60:63], v9 offset:0
    v_mfma_f32_16x16x32_bf16 v[76:79], a[32:35], a[12:15], v[76:79]
    ds_read_b64_tr_b16 a[80:81], v10 offset:20480
    v_mfma_f32_16x16x32_bf16 v[80:83], a[0:3], a[36:39], v[80:83]
    ds_read_b64_tr_b16 a[82:83], v10 offset:20992
    v_mfma_f32_16x16x32_bf16 v[84:87], a[4:7], a[36:39], v[84:87]
    ds_read_b64_tr_b16 a[84:85], v11 offset:20480
    v_mfma_f32_16x16x32_bf16 v[88:91], a[8:11], a[36:39], v[88:91]
    ds_read_b64_tr_b16 a[86:87], v11 offset:20992
    v_add_u32 v8, s66, v8
    v_mfma_f32_16x16x32_bf16 v[92:95], a[12:15], a[36:39], v[92:95]
    v_add_u32 v9, s66, v9
    v_add_u32 v10, s62, v10
    v_mfma_f32_16x16x32_bf16 v[96:99], a[0:3], a[40:43], v[96:99]
    v_add_u32 v11, s62, v11
    v_mfma_f32_16x16x32_bf16 v[100:103], a[4:7], a[40:43], v[100:103]
    v_mfma_f32_16x16x32_bf16 v[104:107], a[8:11], a[40:43], v[104:107]
    v_mfma_f32_16x16x32_bf16 v[108:111], a[12:15], a[40:43], v[108:111]
    v_mfma_f32_16x16x32_bf16 v[112:115], a[16:19], a[36:39], v[112:115]
    v_mfma_f32_16x16x32_bf16 v[116:119], a[16:19], a[40:43], v[116:119]
    s_waitcnt lgkmcnt(0)
    s_barrier
    v_mfma_f32_16x16x32_bf16 v[16:19], a[64:67], a[44:47], v[16:19]
    ds_read_b128 a[0:3], v8 offset:10240
    v_mfma_f32_16x16x32_bf16 v[20:23], a[64:67], a[48:51], v[20:23]
    ds_read_b64_tr_b16 a[20:21], v10 offset:0
    v_mfma_f32_16x16x32_bf16 v[24:27], a[64:67], a[52:55], v[24:27]
    ds_read_b64_tr_b16 a[22:23], v10 offset:512
    v_mfma_f32_16x16x32_bf16 v[28:31], a[64:67], a[56:59], v[28:31]
    ds_read_b128 a[4:7], v8 offset:12288
    v_mfma_f32_16x16x32_bf16 v[32:35], a[68:71], a[44:47], v[32:35]
    ds_read_b64_tr_b16 a[24:25], v11 offset:0
    v_mfma_f32_16x16x32_bf16 v[36:39], a[68:71], a[48:51], v[36:39]
    ds_read_b64_tr_b16 a[26:27], v11 offset:512
    v_mfma_f32_16x16x32_bf16 v[40:43], a[68:71], a[52:55], v[40:43]
    v_mfma_f32_16x16x32_bf16 v[44:47], a[68:71], a[56:59], v[44:47]
    ds_read_b128 a[8:11], v8 offset:14336
    v_mfma_f32_16x16x32_bf16 v[48:51], a[72:75], a[44:47], v[48:51]
    ds_read_b128 a[12:15], v8 offset:16384
    v_mfma_f32_16x16x32_bf16 v[52:55], a[72:75], a[48:51], v[52:55]
    ds_read_b64_tr_b16 a[28:29], v10 offset:8192
    v_mfma_f32_16x16x32_bf16 v[56:59], a[72:75], a[52:55], v[56:59]
    ds_read_b64_tr_b16 a[30:31], v10 offset:8704
    v_mfma_f32_16x16x32_bf16 v[60:63], a[72:75], a[56:59], v[60:63]
    ds_read_b64_tr_b16 a[32:33], v11 offset:8192
    v_mfma_f32_16x16x32_bf16 v[64:67], a[76:79], a[44:47], v[64:67]
    ds_read_b64_tr_b16 a[34:35], v11 offset:8704
    v_mfma_f32_16x16x32_bf16 v[68:71], a[76:79], a[48:51], v[68:71]
    v_mfma_f32_16x16x32_bf16 v[72:75], a[76:79], a[52:55], v[72:75]
    ds_read_b128 a[16:19], v8 offset:0
    v_mfma_f32_16x16x32_bf16 v[76:79], a[76:79], a[56:59], v[76:79]
    ds_read_b64_tr_b16 a[36:37], v10 offset:16384
    v_mfma_f32_16x16x32_bf16 v[80:83], a[44:47], a[80:83], v[80:83]
    ds_read_b64_tr_b16 a[38:39], v10 offset:16896
    v_mfma_f32_16x16x32_bf16 v[84:87], a[48:51], a[80:83], v[84:87]
    ds_read_b64_tr_b16 a[40:41], v11 offset:16384
    v_mfma_f32_16x16x32_bf16 v[88:91], a[52:55], a[80:83], v[88:91]
    ds_read_b64_tr_b16 a[42:43], v11 offset:16896
    v_mfma_f32_16x16x32_bf16 v[92:95], a[56:59], a[80:83], v[92:95]
    v_mfma_f32_16x16x32_bf16 v[96:99], a[44:47], a[84:87], v[96:99]
    v_mfma_f32_16x16x32_bf16 v[100:103], a[48:51], a[84:87], v[100:103]
    v_mfma_f32_16x16x32_bf16 v[104:107], a[52:55], a[84:87], v[104:107]
    v_mfma_f32_16x16x32_bf16 v[108:111], a[56:59], a[84:87], v[108:111]
    v_mfma_f32_16x16x32_bf16 v[112:115], a[60:63], a[80:83], v[112:115]
    v_mfma_f32_16x16x32_bf16 v[116:119], a[60:63], a[84:87], v[116:119]
    s_cmp_lt_u32 s64, 16
    s_waitcnt lgkmcnt(0)
    s_cbranch_scc1 g1_loop1
    s_barrier
    v_lshlrev_b32 v4, 2, v3
    v_lshlrev_b32 v5, 4, v2
    s_lshr_b32 s50, s30, 1
    s_lshl_b32 s51, s50, 7
    v_add_u32 v6, s51, v5
    v_add_u32 v7, s51, v4
    ds_read_b128 v[140:143], v6 offset:1152
    ds_read_b128 v[144:147], v6 offset:1216
    ds_read_b128 v[148:151], v6 offset:1408
    ds_read_b128 v[152:155], v6 offset:1472
    ds_read_b32 v156, v7 offset:1664
    ds_read_b32 v157, v7 offset:1728
    ds_read_b32 a0, v4 offset:320
    ds_read_b32 a1, v4 offset:896
    ds_read_b32 a2, v4 offset:384
    ds_read_b32 a3, v4 offset:960
    ds_read_b32 a4, v4 offset:448
    ds_read_b32 a5, v4 offset:1024
    ds_read_b32 a6, v4 offset:512
    ds_read_b32 a7, v4 offset:1088
    ds_read_b128 a[16:19], v5 offset:320
    ds_read_b128 a[20:23], v5 offset:896
    ds_read_b128 a[24:27], v5 offset:384
    ds_read_b128 a[28:31], v5 offset:960
    ds_read_b128 a[32:35], v5 offset:448
    ds_read_b128 a[36:39], v5 offset:1024
    ds_read_b128 a[40:43], v5 offset:512
    ds_read_b128 a[44:47], v5 offset:1088
    ds_read_b128 a[48:51], v5 offset:0
    ds_read_b128 a[52:55], v5 offset:576
    s_mov_b32 s52, 1048744942
    s_waitcnt lgkmcnt(0)
    v_accvgpr_read_b32 v12, a0
    v_accvgpr_read_b32 v14, a1
    v_mul_f32 v158, s52, v12
    v_mul_f32 v120, s52, v14
    v_pk_mul_f32 v[122:123], v[140:141], v[120:121] op_sel_hi:[1,0]
    v_pk_mul_f32 v[124:125], v[142:143], v[120:121] op_sel_hi:[1,0]
    v_pk_mul_f32 v[126:127], v[144:145], v[120:121] op_sel_hi:[1,0]
    v_pk_mul_f32 v[128:129], v[146:147], v[120:121] op_sel_hi:[1,0]
    v_pk_fma_f32 v[16:17], v[16:17], v[158:159], v[122:123] op_sel_hi:[1,0,1]
    v_pk_fma_f32 v[18:19], v[18:19], v[158:159], v[124:125] op_sel_hi:[1,0,1]
    v_pk_fma_f32 v[32:33], v[32:33], v[158:159], v[126:127] op_sel_hi:[1,0,1]
    v_pk_fma_f32 v[34:35], v[34:35], v[158:159], v[128:129] op_sel_hi:[1,0,1]
    v_cvt_pk_bf16_f32 v16, v16, v17
    v_cvt_pk_bf16_f32 v17, v18, v19
    v_cvt_pk_bf16_f32 v18, v32, v33
    v_cvt_pk_bf16_f32 v19, v34, v35
    v_pk_mul_f32 v[122:123], v[148:149], v[14:15] op_sel_hi:[1,0]
    v_pk_mul_f32 v[124:125], v[150:151], v[14:15] op_sel_hi:[1,0]
    v_pk_mul_f32 v[126:127], v[152:153], v[14:15] op_sel_hi:[1,0]
    v_pk_mul_f32 v[128:129], v[154:155], v[14:15] op_sel_hi:[1,0]
    v_pk_fma_f32 v[48:49], v[48:49], v[12:13], v[122:123] op_sel_hi:[1,0,1]
    v_pk_fma_f32 v[50:51], v[50:51], v[12:13], v[124:125] op_sel_hi:[1,0,1]
    v_pk_fma_f32 v[64:65], v[64:65], v[12:13], v[126:127] op_sel_hi:[1,0,1]
    v_pk_fma_f32 v[66:67], v[66:67], v[12:13], v[128:129] op_sel_hi:[1,0,1]
    v_cvt_pk_bf16_f32 v48, v48, v49
    v_cvt_pk_bf16_f32 v49, v50, v51
    v_cvt_pk_bf16_f32 v50, v64, v65
    v_cvt_pk_bf16_f32 v51, v66, v67
    v_accvgpr_read_b32 v12, a2
    v_accvgpr_read_b32 v14, a3
    v_mul_f32 v158, s52, v12
    v_mul_f32 v120, s52, v14
    v_pk_mul_f32 v[122:123], v[140:141], v[120:121] op_sel_hi:[1,0]
    v_pk_mul_f32 v[124:125], v[142:143], v[120:121] op_sel_hi:[1,0]
    v_pk_mul_f32 v[126:127], v[144:145], v[120:121] op_sel_hi:[1,0]
    v_pk_mul_f32 v[128:129], v[146:147], v[120:121] op_sel_hi:[1,0]
    v_pk_fma_f32 v[20:21], v[20:21], v[158:159], v[122:123] op_sel_hi:[1,0,1]
    v_pk_fma_f32 v[22:23], v[22:23], v[158:159], v[124:125] op_sel_hi:[1,0,1]
    v_pk_fma_f32 v[36:37], v[36:37], v[158:159], v[126:127] op_sel_hi:[1,0,1]
    v_pk_fma_f32 v[38:39], v[38:39], v[158:159], v[128:129] op_sel_hi:[1,0,1]
    v_cvt_pk_bf16_f32 v20, v20, v21
    v_cvt_pk_bf16_f32 v21, v22, v23
    v_cvt_pk_bf16_f32 v22, v36, v37
    v_cvt_pk_bf16_f32 v23, v38, v39
    v_pk_mul_f32 v[122:123], v[148:149], v[14:15] op_sel_hi:[1,0]
    v_pk_mul_f32 v[124:125], v[150:151], v[14:15] op_sel_hi:[1,0]
    v_pk_mul_f32 v[126:127], v[152:153], v[14:15] op_sel_hi:[1,0]
    v_pk_mul_f32 v[128:129], v[154:155], v[14:15] op_sel_hi:[1,0]
    v_pk_fma_f32 v[52:53], v[52:53], v[12:13], v[122:123] op_sel_hi:[1,0,1]
    v_pk_fma_f32 v[54:55], v[54:55], v[12:13], v[124:125] op_sel_hi:[1,0,1]
    v_pk_fma_f32 v[68:69], v[68:69], v[12:13], v[126:127] op_sel_hi:[1,0,1]
    v_pk_fma_f32 v[70:71], v[70:71], v[12:13], v[128:129] op_sel_hi:[1,0,1]
    v_cvt_pk_bf16_f32 v52, v52, v53
    v_cvt_pk_bf16_f32 v53, v54, v55
    v_cvt_pk_bf16_f32 v54, v68, v69
    v_cvt_pk_bf16_f32 v55, v70, v71
    v_accvgpr_read_b32 v12, a4
    v_accvgpr_read_b32 v14, a5
    v_mul_f32 v158, s52, v12
    v_mul_f32 v120, s52, v14
    v_pk_mul_f32 v[122:123], v[140:141], v[120:121] op_sel_hi:[1,0]
    v_pk_mul_f32 v[124:125], v[142:143], v[120:121] op_sel_hi:[1,0]
    v_pk_mul_f32 v[126:127], v[144:145], v[120:121] op_sel_hi:[1,0]
    v_pk_mul_f32 v[128:129], v[146:147], v[120:121] op_sel_hi:[1,0]
    v_pk_fma_f32 v[24:25], v[24:25], v[158:159], v[122:123] op_sel_hi:[1,0,1]
    v_pk_fma_f32 v[26:27], v[26:27], v[158:159], v[124:125] op_sel_hi:[1,0,1]
    v_pk_fma_f32 v[40:41], v[40:41], v[158:159], v[126:127] op_sel_hi:[1,0,1]
    v_pk_fma_f32 v[42:43], v[42:43], v[158:159], v[128:129] op_sel_hi:[1,0,1]
    v_cvt_pk_bf16_f32 v24, v24, v25
    v_cvt_pk_bf16_f32 v25, v26, v27
    v_cvt_pk_bf16_f32 v26, v40, v41
    v_cvt_pk_bf16_f32 v27, v42, v43
    v_pk_mul_f32 v[122:123], v[148:149], v[14:15] op_sel_hi:[1,0]
    v_pk_mul_f32 v[124:125], v[150:151], v[14:15] op_sel_hi:[1,0]
    v_pk_mul_f32 v[126:127], v[152:153], v[14:15] op_sel_hi:[1,0]
    v_pk_mul_f32 v[128:129], v[154:155], v[14:15] op_sel_hi:[1,0]
    v_pk_fma_f32 v[56:57], v[56:57], v[12:13], v[122:123] op_sel_hi:[1,0,1]
    v_pk_fma_f32 v[58:59], v[58:59], v[12:13], v[124:125] op_sel_hi:[1,0,1]
    v_pk_fma_f32 v[72:73], v[72:73], v[12:13], v[126:127] op_sel_hi:[1,0,1]
    v_pk_fma_f32 v[74:75], v[74:75], v[12:13], v[128:129] op_sel_hi:[1,0,1]
    v_cvt_pk_bf16_f32 v56, v56, v57
    v_cvt_pk_bf16_f32 v57, v58, v59
    v_cvt_pk_bf16_f32 v58, v72, v73
    v_cvt_pk_bf16_f32 v59, v74, v75
    v_accvgpr_read_b32 v12, a6
    v_accvgpr_read_b32 v14, a7
    v_mul_f32 v158, s52, v12
    v_mul_f32 v120, s52, v14
    v_pk_mul_f32 v[122:123], v[140:141], v[120:121] op_sel_hi:[1,0]
    v_pk_mul_f32 v[124:125], v[142:143], v[120:121] op_sel_hi:[1,0]
    v_pk_mul_f32 v[126:127], v[144:145], v[120:121] op_sel_hi:[1,0]
    v_pk_mul_f32 v[128:129], v[146:147], v[120:121] op_sel_hi:[1,0]
    v_pk_fma_f32 v[28:29], v[28:29], v[158:159], v[122:123] op_sel_hi:[1,0,1]
    v_pk_fma_f32 v[30:31], v[30:31], v[158:159], v[124:125] op_sel_hi:[1,0,1]
    v_pk_fma_f32 v[44:45], v[44:45], v[158:159], v[126:127] op_sel_hi:[1,0,1]
    v_pk_fma_f32 v[46:47], v[46:47], v[158:159], v[128:129] op_sel_hi:[1,0,1]
    v_cvt_pk_bf16_f32 v28, v28, v29
    v_cvt_pk_bf16_f32 v29, v30, v31
    v_cvt_pk_bf16_f32 v30, v44, v45
    v_cvt_pk_bf16_f32 v31, v46, v47
    v_pk_mul_f32 v[122:123], v[148:149], v[14:15] op_sel_hi:[1,0]
    v_pk_mul_f32 v[124:125], v[150:151], v[14:15] op_sel_hi:[1,0]
    v_pk_mul_f32 v[126:127], v[152:153], v[14:15] op_sel_hi:[1,0]
    v_pk_mul_f32 v[128:129], v[154:155], v[14:15] op_sel_hi:[1,0]
    v_pk_fma_f32 v[60:61], v[60:61], v[12:13], v[122:123] op_sel_hi:[1,0,1]
    v_pk_fma_f32 v[62:63], v[62:63], v[12:13], v[124:125] op_sel_hi:[1,0,1]
    v_pk_fma_f32 v[76:77], v[76:77], v[12:13], v[126:127] op_sel_hi:[1,0,1]
    v_pk_fma_f32 v[78:79], v[78:79], v[12:13], v[128:129] op_sel_hi:[1,0,1]
    v_cvt_pk_bf16_f32 v60, v60, v61
    v_cvt_pk_bf16_f32 v61, v62, v63
    v_cvt_pk_bf16_f32 v62, v76, v77
    v_cvt_pk_bf16_f32 v63, v78, v79
    v_mov_b32 v40, v156
    v_mov_b32 v42, v157
    s_mul_i32 s51, s50, 3072
    v_lshlrev_b32 v6, 4, v1
    v_add_u32 v6, s51, v6
    v_accvgpr_read_b32 v32, a40
    v_accvgpr_read_b32 v33, a41
    v_accvgpr_read_b32 v34, a42
    v_accvgpr_read_b32 v35, a43
    v_accvgpr_read_b32 v36, a44
    v_accvgpr_read_b32 v37, a45
    v_accvgpr_read_b32 v38, a46
    v_accvgpr_read_b32 v39, a47
    v_pk_mul_f32 v[64:65], v[36:37], v[40:41] op_sel_hi:[1,0]
    v_pk_mul_f32 v[66:67], v[38:39], v[40:41] op_sel_hi:[1,0]
    v_pk_mul_f32 v[68:69], v[36:37], v[42:43] op_sel_hi:[1,0]
    v_pk_mul_f32 v[70:71], v[38:39], v[42:43] op_sel_hi:[1,0]
    v_pk_fma_f32 v[92:93], v[92:93], v[32:33], v[64:65]
    v_pk_fma_f32 v[94:95], v[94:95], v[34:35], v[66:67]
    v_pk_fma_f32 v[108:109], v[108:109], v[32:33], v[68:69]
    v_pk_fma_f32 v[110:111], v[110:111], v[34:35], v[70:71]
    v_cvt_pk_bf16_f32 v128, v92, v93
    v_cvt_pk_bf16_f32 v129, v94, v95
    v_cvt_pk_bf16_f32 v138, v108, v109
    v_cvt_pk_bf16_f32 v139, v110, v111
    v_accvgpr_read_b32 v32, a48
    v_accvgpr_read_b32 v33, a49
    v_accvgpr_read_b32 v34, a50
    v_accvgpr_read_b32 v35, a51
    v_accvgpr_read_b32 v36, a52
    v_accvgpr_read_b32 v37, a53
    v_accvgpr_read_b32 v38, a54
    v_accvgpr_read_b32 v39, a55
    v_pk_mul_f32 v[64:65], v[36:37], v[40:41] op_sel_hi:[1,0]
    v_pk_mul_f32 v[66:67], v[38:39], v[40:41] op_sel_hi:[1,0]
    v_pk_mul_f32 v[68:69], v[36:37], v[42:43] op_sel_hi:[1,0]
    v_pk_mul_f32 v[70:71], v[38:39], v[42:43] op_sel_hi:[1,0]
    v_pk_fma_f32 v[112:113], v[112:113], v[32:33], v[64:65]
    v_pk_fma_f32 v[114:115], v[114:115], v[34:35], v[66:67]
    v_pk_fma_f32 v[116:117], v[116:117], v[32:33], v[68:69]
    v_pk_fma_f32 v[118:119], v[118:119], v[34:35], v[70:71]
    v_cvt_pk_bf16_f32 v44, v112, v113
    v_cvt_pk_bf16_f32 v45, v114, v115
    v_cvt_pk_bf16_f32 v46, v116, v117
    v_cvt_pk_bf16_f32 v47, v118, v119
    ds_write_b128 v6, v[44:47] offset:2048
    v_accvgpr_read_b32 v32, a16
    v_accvgpr_read_b32 v33, a17
    v_accvgpr_read_b32 v34, a18
    v_accvgpr_read_b32 v35, a19
    v_accvgpr_read_b32 v36, a20
    v_accvgpr_read_b32 v37, a21
    v_accvgpr_read_b32 v38, a22
    v_accvgpr_read_b32 v39, a23
    v_pk_mul_f32 v[64:65], v[36:37], v[40:41] op_sel_hi:[1,0]
    v_pk_mul_f32 v[66:67], v[38:39], v[40:41] op_sel_hi:[1,0]
    v_pk_mul_f32 v[68:69], v[36:37], v[42:43] op_sel_hi:[1,0]
    v_pk_mul_f32 v[70:71], v[38:39], v[42:43] op_sel_hi:[1,0]
    v_pk_fma_f32 v[80:81], v[80:81], v[32:33], v[64:65]
    v_pk_fma_f32 v[82:83], v[82:83], v[34:35], v[66:67]
    v_pk_fma_f32 v[96:97], v[96:97], v[32:33], v[68:69]
    v_pk_fma_f32 v[98:99], v[98:99], v[34:35], v[70:71]
    v_cvt_pk_bf16_f32 v122, v80, v81
    v_cvt_pk_bf16_f32 v123, v82, v83
    v_cvt_pk_bf16_f32 v132, v96, v97
    v_cvt_pk_bf16_f32 v133, v98, v99
    v_accvgpr_read_b32 v32, a24
    v_accvgpr_read_b32 v33, a25
    v_accvgpr_read_b32 v34, a26
    v_accvgpr_read_b32 v35, a27
    v_accvgpr_read_b32 v36, a28
    v_accvgpr_read_b32 v37, a29
    v_accvgpr_read_b32 v38, a30
    v_accvgpr_read_b32 v39, a31
    v_pk_mul_f32 v[64:65], v[36:37], v[40:41] op_sel_hi:[1,0]
    v_pk_mul_f32 v[66:67], v[38:39], v[40:41] op_sel_hi:[1,0]
    v_pk_mul_f32 v[68:69], v[36:37], v[42:43] op_sel_hi:[1,0]
    v_pk_mul_f32 v[70:71], v[38:39], v[42:43] op_sel_hi:[1,0]
    v_pk_fma_f32 v[84:85], v[84:85], v[32:33], v[64:65]
    v_pk_fma_f32 v[86:87], v[86:87], v[34:35], v[66:67]
    v_pk_fma_f32 v[100:101], v[100:101], v[32:33], v[68:69]
    v_pk_fma_f32 v[102:103], v[102:103], v[34:35], v[70:71]
    v_cvt_pk_bf16_f32 v124, v84, v85
    v_cvt_pk_bf16_f32 v125, v86, v87
    v_cvt_pk_bf16_f32 v134, v100, v101
    v_cvt_pk_bf16_f32 v135, v102, v103
    v_accvgpr_read_b32 v32, a32
    v_accvgpr_read_b32 v33, a33
    v_accvgpr_read_b32 v34, a34
    v_accvgpr_read_b32 v35, a35
    v_accvgpr_read_b32 v36, a36
    v_accvgpr_read_b32 v37, a37
    v_accvgpr_read_b32 v38, a38
    v_accvgpr_read_b32 v39, a39
    v_pk_mul_f32 v[64:65], v[36:37], v[40:41] op_sel_hi:[1,0]
    v_pk_mul_f32 v[66:67], v[38:39], v[40:41] op_sel_hi:[1,0]
    v_pk_mul_f32 v[68:69], v[36:37], v[42:43] op_sel_hi:[1,0]
    v_pk_mul_f32 v[70:71], v[38:39], v[42:43] op_sel_hi:[1,0]
    v_pk_fma_f32 v[88:89], v[88:89], v[32:33], v[64:65]
    v_pk_fma_f32 v[90:91], v[90:91], v[34:35], v[66:67]
    v_pk_fma_f32 v[104:105], v[104:105], v[32:33], v[68:69]
    v_pk_fma_f32 v[106:107], v[106:107], v[34:35], v[70:71]
    v_cvt_pk_bf16_f32 v126, v88, v89
    v_cvt_pk_bf16_f32 v127, v90, v91
    v_cvt_pk_bf16_f32 v136, v104, v105
    v_cvt_pk_bf16_f32 v137, v106, v107
    s_waitcnt lgkmcnt(0)
    s_barrier
    ds_read_b128 v[112:115], v6 offset:3072
    ds_read_b64 v[120:121], v6 offset:4096
    ds_read_b64 v[130:131], v6 offset:4104
    s_mov_b32 s53, 4048155338
    v_lshlrev_b32 v12, 2, v2
    v_sub_u32 v12, v12, v3
    v_mov_b32 v15, s53
    v_mov_b32 v158, 0
    v_add_u32 v13, 0, v12
    v_and_b32 v14, 1, v13
    v_cmp_le_i32 vcc, 2, v13
    v_cmp_eq_u32 s[54:55], 0, v14
    s_nop 3
    s_and_b64 vcc, vcc, s[54:55]
    v_cndmask_b32 v140, v15, v158, vcc
    v_cmp_ge_i32 vcc, 0, v13
    s_nop 3
    s_and_b64 vcc, vcc, s[54:55]
    v_cndmask_b32 v144, v15, v158, vcc
    v_add_u32 v13, 1, v12
    v_and_b32 v14, 1, v13
    v_cmp_le_i32 vcc, 2, v13
    v_cmp_eq_u32 s[54:55], 0, v14
    s_nop 3
    s_and_b64 vcc, vcc, s[54:55]
    v_cndmask_b32 v141, v15, v158, vcc
    v_cmp_ge_i32 vcc, 0, v13
    s_nop 3
    s_and_b64 vcc, vcc, s[54:55]
    v_cndmask_b32 v145, v15, v158, vcc
    v_add_u32 v13, 2, v12
    v_and_b32 v14, 1, v13
    v_cmp_le_i32 vcc, 2, v13
    v_cmp_eq_u32 s[54:55], 0, v14
    s_nop 3
    s_and_b64 vcc, vcc, s[54:55]
    v_cndmask_b32 v142, v15, v158, vcc
    v_cmp_ge_i32 vcc, 0, v13
    s_nop 3
    s_and_b64 vcc, vcc, s[54:55]
    v_cndmask_b32 v146, v15, v158, vcc
    v_add_u32 v13, 3, v12
    v_and_b32 v14, 1, v13
    v_cmp_le_i32 vcc, 2, v13
    v_cmp_eq_u32 s[54:55], 0, v14
    s_nop 3
    s_and_b64 vcc, vcc, s[54:55]
    v_cndmask_b32 v143, v15, v158, vcc
    v_cmp_ge_i32 vcc, 0, v13
    s_nop 3
    s_and_b64 vcc, vcc, s[54:55]
    v_cndmask_b32 v147, v15, v158, vcc
    v_mfma_f32_16x16x32_bf16 v[92:95], v[52:55], v[20:23], 0
    v_mfma_f32_16x16x32_bf16 v[88:91], v[48:51], v[20:23], 0
    v_mfma_f32_16x16x32_bf16 v[100:103], v[56:59], v[24:27], 0
    v_mfma_f32_16x16x32_bf16 v[96:99], v[52:55], v[24:27], 0
    v_mfma_f32_16x16x32_bf16 v[108:111], v[60:63], v[28:31], 0
    v_mfma_f32_16x16x32_bf16 v[104:107], v[56:59], v[28:31], 0
    s_waitcnt lgkmcnt(0)
    v_mfma_f32_16x16x32_bf16 v[84:87], v[48:51], v[16:19], 0
    v_mfma_f32_16x16x32_bf16 v[80:83], v[112:115], v[16:19], 0
    s_nop 0
    v_pk_add_f32 v[88:89], v[88:89], v[140:141]
    v_pk_add_f32 v[92:93], v[92:93], v[144:145]
    v_pk_add_f32 v[90:91], v[90:91], v[142:143]
    v_pk_add_f32 v[94:95], v[94:95], v[146:147]
    v_pk_add_f32 v[96:97], v[96:97], v[140:141]
    v_pk_add_f32 v[100:101], v[100:101], v[144:145]
    v_pk_add_f32 v[98:99], v[98:99], v[142:143]
    v_pk_add_f32 v[102:103], v[102:103], v[146:147]
    v_pk_add_f32 v[104:105], v[104:105], v[140:141]
    v_pk_add_f32 v[108:109], v[108:109], v[144:145]
    v_pk_add_f32 v[106:107], v[106:107], v[142:143]
    v_pk_add_f32 v[110:111], v[110:111], v[146:147]
    v_pk_add_f32 v[80:81], v[80:81], v[140:141]
    v_pk_add_f32 v[84:85], v[84:85], v[144:145]
    v_pk_add_f32 v[82:83], v[82:83], v[142:143]
    v_pk_add_f32 v[86:87], v[86:87], v[146:147]
    v_max3_f32 v33, v88, v89, v90
    v_max3_f32 v37, v91, v92, v93
    v_max3_f32 v34, v96, v97, v98
    v_max3_f32 v38, v99, v100, v101
    v_max3_f32 v35, v104, v105, v106
    v_max3_f32 v39, v107, v108, v109
    v_max3_f32 v32, v80, v81, v82
    v_max3_f32 v36, v83, v84, v85
    v_max3_f32 v33, v33, v94, v95
    v_max3_f32 v34, v34, v102, v103
    v_max3_f32 v35, v35, v110, v111
    v_max3_f32 v32, v32, v86, v87
    v_max_f32 v33, v33, v37
    v_max_f32 v34, v34, v38
    v_max_f32 v35, v35, v39
    v_max_f32 v32, v32, v36
    v_mov_b32 v37, v33
    v_mov_b32 v38, v34
    v_mov_b32 v39, v35
    v_mov_b32 v36, v32
    v_permlane32_swap_b32 v33, v37
    v_permlane32_swap_b32 v34, v38
    v_permlane32_swap_b32 v35, v39
    v_permlane32_swap_b32 v32, v36
    v_max_f32 v33, v33, v37
    v_max_f32 v34, v34, v38
    v_max_f32 v35, v35, v39
    v_max_f32 v32, v32, v36
    v_mov_b32 v37, v33
    v_mov_b32 v38, v34
    v_mov_b32 v39, v35
    v_mov_b32 v36, v32
    v_permlane16_swap_b32 v33, v37
    v_permlane16_swap_b32 v34, v38
    v_permlane16_swap_b32 v35, v39
    v_permlane16_swap_b32 v32, v36
    v_max_f32 v33, v33, v37
    v_max_f32 v34, v34, v38
    v_max_f32 v35, v35, v39
    v_max_f32 v32, v32, v36
    v_sub_f32 v88, v88, v33
    v_sub_f32 v89, v89, v33
    v_sub_f32 v90, v90, v33
    v_sub_f32 v91, v91, v33
    v_sub_f32 v92, v92, v33
    v_sub_f32 v93, v93, v33
    v_sub_f32 v94, v94, v33
    v_sub_f32 v95, v95, v33
    v_sub_f32 v96, v96, v34
    v_sub_f32 v97, v97, v34
    v_sub_f32 v98, v98, v34
    v_sub_f32 v99, v99, v34
    v_sub_f32 v100, v100, v34
    v_sub_f32 v101, v101, v34
    v_sub_f32 v102, v102, v34
    v_sub_f32 v103, v103, v34
    v_sub_f32 v104, v104, v35
    v_sub_f32 v105, v105, v35
    v_sub_f32 v106, v106, v35
    v_sub_f32 v107, v107, v35
    v_sub_f32 v108, v108, v35
    v_sub_f32 v109, v109, v35
    v_sub_f32 v110, v110, v35
    v_sub_f32 v111, v111, v35
    v_sub_f32 v80, v80, v32
    v_sub_f32 v81, v81, v32
    v_sub_f32 v82, v82, v32
    v_sub_f32 v83, v83, v32
    v_sub_f32 v84, v84, v32
    v_sub_f32 v85, v85, v32
    v_sub_f32 v86, v86, v32
    v_sub_f32 v87, v87, v32
    v_exp_f32 v88, v88
    v_exp_f32 v89, v89
    v_exp_f32 v90, v90
    v_exp_f32 v91, v91
    v_exp_f32 v92, v92
    v_exp_f32 v93, v93
    v_exp_f32 v94, v94
    v_exp_f32 v95, v95
    v_exp_f32 v96, v96
    v_exp_f32 v97, v97
    v_exp_f32 v98, v98
    v_exp_f32 v99, v99
    v_exp_f32 v100, v100
    v_exp_f32 v101, v101
    v_exp_f32 v102, v102
    v_exp_f32 v103, v103
    v_exp_f32 v104, v104
    v_exp_f32 v105, v105
    v_exp_f32 v106, v106
    v_exp_f32 v107, v107
    v_exp_f32 v108, v108
    v_exp_f32 v109, v109
    v_exp_f32 v110, v110
    v_exp_f32 v111, v111
    v_exp_f32 v80, v80
    v_exp_f32 v81, v81
    v_exp_f32 v82, v82
    v_exp_f32 v83, v83
    v_exp_f32 v84, v84
    v_exp_f32 v85, v85
    v_exp_f32 v86, v86
    v_exp_f32 v87, v87
    v_cvt_pk_bf16_f32 v68, v88, v89
    v_cvt_pk_bf16_f32 v69, v90, v91
    v_cvt_pk_bf16_f32 v70, v92, v93
    v_cvt_pk_bf16_f32 v71, v94, v95
    v_cvt_pk_bf16_f32 v72, v96, v97
    v_cvt_pk_bf16_f32 v73, v98, v99
    v_cvt_pk_bf16_f32 v74, v100, v101
    v_cvt_pk_bf16_f32 v75, v102, v103
    v_cvt_pk_bf16_f32 v76, v104, v105
    v_cvt_pk_bf16_f32 v77, v106, v107
    v_cvt_pk_bf16_f32 v78, v108, v109
    v_cvt_pk_bf16_f32 v79, v110, v111
    v_cvt_pk_bf16_f32 v64, v80, v81
    v_cvt_pk_bf16_f32 v65, v82, v83
    v_cvt_pk_bf16_f32 v66, v84, v85
    v_cvt_pk_bf16_f32 v67, v86, v87
    v_pk_add_f32 v[88:89], v[88:89], v[90:91]
    v_pk_add_f32 v[92:93], v[92:93], v[94:95]
    v_pk_add_f32 v[96:97], v[96:97], v[98:99]
    v_pk_add_f32 v[100:101], v[100:101], v[102:103]
    v_pk_add_f32 v[104:105], v[104:105], v[106:107]
    v_pk_add_f32 v[108:109], v[108:109], v[110:111]
    v_pk_add_f32 v[80:81], v[80:81], v[82:83]
    v_pk_add_f32 v[84:85], v[84:85], v[86:87]
    v_pk_add_f32 v[88:89], v[88:89], v[92:93]
    v_pk_add_f32 v[96:97], v[96:97], v[100:101]
    v_pk_add_f32 v[104:105], v[104:105], v[108:109]
    v_pk_add_f32 v[80:81], v[80:81], v[84:85]
    v_add_f32 v41, v88, v89
    v_add_f32 v42, v96, v97
    v_add_f32 v43, v104, v105
    v_add_f32 v40, v80, v81
    v_mfma_f32_16x16x32_bf16 v[88:91], v[122:125], v[68:71], 0
    v_mfma_f32_16x16x32_bf16 v[92:95], v[132:135], v[68:71], 0
    v_mfma_f32_16x16x32_bf16 v[96:99], v[124:127], v[72:75], 0
    v_mfma_f32_16x16x32_bf16 v[100:103], v[134:137], v[72:75], 0
    v_mfma_f32_16x16x32_bf16 v[104:107], v[126:129], v[76:79], 0
    v_mfma_f32_16x16x32_bf16 v[108:111], v[136:139], v[76:79], 0
    v_mfma_f32_16x16x32_bf16 v[80:83], v[120:123], v[64:67], 0
    v_mfma_f32_16x16x32_bf16 v[84:87], v[130:133], v[64:67], 0
    v_mov_b32 v37, v41
    v_mov_b32 v38, v42
    v_mov_b32 v39, v43
    v_mov_b32 v36, v40
    v_permlane32_swap_b32 v41, v37
    v_permlane32_swap_b32 v42, v38
    v_permlane32_swap_b32 v43, v39
    v_permlane32_swap_b32 v40, v36
    v_add_f32 v41, v41, v37
    v_add_f32 v42, v42, v38
    v_add_f32 v43, v43, v39
    v_add_f32 v40, v40, v36
    v_mov_b32 v37, v41
    v_mov_b32 v38, v42
    v_mov_b32 v39, v43
    v_mov_b32 v36, v40
    v_permlane16_swap_b32 v41, v37
    v_permlane16_swap_b32 v42, v38
    v_permlane16_swap_b32 v43, v39
    v_permlane16_swap_b32 v40, v36
    v_add_f32 v41, v41, v37
    v_add_f32 v42, v42, v38
    v_add_f32 v43, v43, v39
    v_add_f32 v40, v40, v36
    v_rcp_f32 v41, v41
    v_rcp_f32 v42, v42
    v_rcp_f32 v43, v43
    v_rcp_f32 v40, v40
    s_lshl_b32 s51, s26, 7
    s_add_u32 s51, s51, 64
    v_add_u32 v12, s51, v3
    v_lshlrev_b32 v12, 11, v12
    v_and_b32 v13, 1, v2
    v_lshlrev_b32 v13, 5, v13
    v_lshrrev_b32 v14, 1, v2
    v_lshlrev_b32 v14, 4, v14
    v_add3_u32 v12, v12, v13, v14
    s_lshl_b32 s51, s3, 7
    s_lshl_b32 s52, s50, 6
    s_add_u32 s51, s51, s52
    s_add_u32 s51, s51, 0
    v_pk_mul_f32 v[88:89], v[88:89], v[40:41] op_sel:[0,1] op_sel_hi:[1,1]
    v_pk_mul_f32 v[90:91], v[90:91], v[40:41] op_sel:[0,1] op_sel_hi:[1,1]
    v_pk_mul_f32 v[92:93], v[92:93], v[40:41] op_sel:[0,1] op_sel_hi:[1,1]
    v_pk_mul_f32 v[94:95], v[94:95], v[40:41] op_sel:[0,1] op_sel_hi:[1,1]
    v_cvt_pk_bf16_f32 v68, v88, v89
    v_cvt_pk_bf16_f32 v69, v90, v91
    v_cvt_pk_bf16_f32 v70, v92, v93
    v_cvt_pk_bf16_f32 v71, v94, v95
    s_nop 0
    v_permlane16_swap_b32 v68, v70
    v_permlane16_swap_b32 v69, v71
    s_add_u32 s52, s51, 32768
    buffer_store_dwordx4 v[68:71], v12, s[32:35], s52 offen sc1
    v_pk_mul_f32 v[96:97], v[96:97], v[42:43] op_sel:[0,0] op_sel_hi:[1,0]
    v_pk_mul_f32 v[98:99], v[98:99], v[42:43] op_sel:[0,0] op_sel_hi:[1,0]
    v_pk_mul_f32 v[100:101], v[100:101], v[42:43] op_sel:[0,0] op_sel_hi:[1,0]
    v_pk_mul_f32 v[102:103], v[102:103], v[42:43] op_sel:[0,0] op_sel_hi:[1,0]
    v_cvt_pk_bf16_f32 v72, v96, v97
    v_cvt_pk_bf16_f32 v73, v98, v99
    v_cvt_pk_bf16_f32 v74, v100, v101
    v_cvt_pk_bf16_f32 v75, v102, v103
    s_nop 0
    v_permlane16_swap_b32 v72, v74
    v_permlane16_swap_b32 v73, v75
    s_add_u32 s52, s51, 65536
    buffer_store_dwordx4 v[72:75], v12, s[32:35], s52 offen sc1
    v_pk_mul_f32 v[104:105], v[104:105], v[42:43] op_sel:[0,1] op_sel_hi:[1,1]
    v_pk_mul_f32 v[106:107], v[106:107], v[42:43] op_sel:[0,1] op_sel_hi:[1,1]
    v_pk_mul_f32 v[108:109], v[108:109], v[42:43] op_sel:[0,1] op_sel_hi:[1,1]
    v_pk_mul_f32 v[110:111], v[110:111], v[42:43] op_sel:[0,1] op_sel_hi:[1,1]
    v_cvt_pk_bf16_f32 v76, v104, v105
    v_cvt_pk_bf16_f32 v77, v106, v107
    v_cvt_pk_bf16_f32 v78, v108, v109
    v_cvt_pk_bf16_f32 v79, v110, v111
    s_nop 0
    v_permlane16_swap_b32 v76, v78
    v_permlane16_swap_b32 v77, v79
    s_add_u32 s52, s51, 98304
    buffer_store_dwordx4 v[76:79], v12, s[32:35], s52 offen sc1
    v_pk_mul_f32 v[80:81], v[80:81], v[40:41] op_sel:[0,0] op_sel_hi:[1,0]
    v_pk_mul_f32 v[82:83], v[82:83], v[40:41] op_sel:[0,0] op_sel_hi:[1,0]
    v_pk_mul_f32 v[84:85], v[84:85], v[40:41] op_sel:[0,0] op_sel_hi:[1,0]
    v_pk_mul_f32 v[86:87], v[86:87], v[40:41] op_sel:[0,0] op_sel_hi:[1,0]
    v_cvt_pk_bf16_f32 v64, v80, v81
    v_cvt_pk_bf16_f32 v65, v82, v83
    v_cvt_pk_bf16_f32 v66, v84, v85
    v_cvt_pk_bf16_f32 v67, v86, v87
    s_nop 0
    v_permlane16_swap_b32 v64, v66
    v_permlane16_swap_b32 v65, v67
    s_add_u32 s52, s51, 0
    buffer_store_dwordx4 v[64:67], v12, s[32:35], s52 offen sc1
    s_barrier
    s_waitcnt vmcnt(0)
    s_barrier
g1_cend:
    s_barrier
    v_lshrrev_b32 v4, 1, v3
    v_xor_b32 v4, v2, v4
    v_lshlrev_b32 v4, 4, v4
    v_lshlrev_b32 v5, 7, v3
    v_add_u32 v8, v4, v5
    v_add_u32 v8, 106496, v8
    v_xor_b32 v9, 64, v8
    s_lshr_b32 s51, s30, 1
    s_lshl_b32 s51, s51, 13
    s_and_b32 s52, s30, 1
    s_lshl_b32 s52, s52, 1
    s_add_u32 s53, s52, 1
    v_lshrrev_b32 v4, 2, v3
    v_and_b32 v5, 3, v3
    v_lshrrev_b32 v6, 1, v4
    v_and_b32 v7, 1, v2
    v_lshlrev_b32 v7, 1, v7
    v_or_b32 v6, v6, v7
    v_lshlrev_b32 v7, 3, v2
    v_add_u32 v7, v7, v4
    v_lshlrev_b32 v7, 7, v7
    v_lshlrev_b32 v12, 3, v5
    v_add_u32 v7, v7, v12
    v_add_u32 v7, 8192, v7
    v_add_u32 v7, s51, v7
    v_xor_b32 v12, s52, v6
    v_lshlrev_b32 v12, 5, v12
    v_add_u32 v144, v12, v7
    v_xor_b32 v12, s53, v6
    v_lshlrev_b32 v12, 5, v12
    v_add_u32 v145, v12, v7
    s_and_b32 s52, s29, 1
    s_lshl_b32 s52, s52, 6
    s_lshl_b32 s53, s26, 7
    s_add_u32 s57, s52, s53
    s_lshr_b32 s53, s29, 1
    s_lshl_b32 s54, s28, 2
    s_add_u32 s53, s53, s54
    s_lshl_b32 s54, s53, 8
    s_lshl_b32 s55, s30, 6
    s_add_u32 s54, s54, s55
    v_add_u32 v13, s57, v3
    v_lshlrev_b32 v13, 11, v13
    v_add_u32 v13, s54, v13
    v_lshlrev_b32 v14, 3, v2
    v_add_u32 v14, v14, v13
    v_and_b32 v15, 1, v2
    v_lshlrev_b32 v15, 5, v15
    v_lshrrev_b32 v12, 1, v2
    v_lshlrev_b32 v12, 4, v12
    v_add3_u32 v15, v13, v15, v12
    s_mov_b32 s36, s4
    s_and_b32 s37, s5, 0xffff
    s_mov_b32 s38, 4194304
    s_mov_b32 s39, 0x20000
    s_mov_b32 s56, 0
    buffer_load_dwordx2 v[48:49], v14, s[36:39], s56 offen offset:0
    buffer_load_dwordx2 v[50:51], v14, s[36:39], s56 offen offset:32
    s_mov_b32 s56, 32768
    buffer_load_dwordx2 v[52:53], v14, s[36:39], s56 offen offset:0
    buffer_load_dwordx2 v[54:55], v14, s[36:39], s56 offen offset:32
    s_mov_b32 s56, 65536
    buffer_load_dwordx2 v[56:57], v14, s[36:39], s56 offen offset:0
    buffer_load_dwordx2 v[58:59], v14, s[36:39], s56 offen offset:32
    s_mov_b32 s56, 98304
    buffer_load_dwordx2 v[60:61], v14, s[36:39], s56 offen offset:0
    buffer_load_dwordx2 v[62:63], v14, s[36:39], s56 offen offset:32
    s_mov_b32 s65, 0
    s_mov_b32 s67, 0
    s_barrier
    ds_read_b64_tr_b16 a[16:17], v144 offset:0
    ds_read_b64_tr_b16 a[18:19], v144 offset:512
    ds_read_b128 a[0:3], v8 offset:0
    ds_read_b128 a[4:7], v8 offset:2048
    ds_read_b128 a[8:11], v8 offset:4096
    ds_read_b128 a[12:15], v8 offset:6144
    ds_read_b64_tr_b16 a[20:21], v145 offset:0
    ds_read_b64_tr_b16 a[22:23], v145 offset:512
    ds_read_b64_tr_b16 a[40:41], v144 offset:4096
    ds_read_b64_tr_b16 a[42:43], v144 offset:4608
    ds_read_b128 a[24:27], v9 offset:0
    ds_read_b128 a[28:31], v9 offset:2048
    ds_read_b128 a[32:35], v9 offset:4096
    ds_read_b128 a[36:39], v9 offset:6144
    ds_read_b64_tr_b16 a[44:45], v145 offset:4096
    ds_read_b64_tr_b16 a[46:47], v145 offset:4608
    s_add_u32 s65, s65, 1
    s_cmp_eq_u32 s65, 6
    s_mov_b32 s66, 8192
    s_cselect_b32 s66, 4294926336, s66
    s_cselect_b32 s65, 0, s65
    s_add_u32 s67, s67, 1
    s_cmp_eq_u32 s67, 6
    s_mov_b32 s62, 16384
    s_cselect_b32 s62, 4294885376, s62
    s_cselect_b32 s67, 0, s67
    v_add_u32 v8, s66, v8
    v_add_u32 v9, s66, v9
    v_add_u32 v144, s62, v144
    v_add_u32 v145, s62, v145
    s_waitcnt lgkmcnt(0)
    s_mov_b32 s64, 0
    s_barrier
    v_mfma_f32_16x16x32_bf16 v[16:19], a[16:19], a[0:3], 0
    ds_read_b64_tr_b16 a[64:65], v144 offset:0
    ds_read_b64_tr_b16 a[66:67], v144 offset:512
    s_add_u32 s65, s65, 1
    v_mfma_f32_16x16x32_bf16 v[24:27], a[16:19], a[4:7], 0
    ds_read_b128 a[48:51], v8 offset:0
    ds_read_b128 a[52:55], v8 offset:2048
    s_cmp_eq_u32 s65, 6
    v_mfma_f32_16x16x32_bf16 v[32:35], a[16:19], a[8:11], 0
    ds_read_b128 a[56:59], v8 offset:4096
    ds_read_b128 a[60:63], v8 offset:6144
    s_mov_b32 s66, 8192
    v_mfma_f32_16x16x32_bf16 v[40:43], a[16:19], a[12:15], 0
    ds_read_b64_tr_b16 a[68:69], v145 offset:0
    ds_read_b64_tr_b16 a[70:71], v145 offset:512
    s_cselect_b32 s66, 4294926336, s66
    v_mfma_f32_16x16x32_bf16 v[20:23], a[20:23], a[0:3], 0
    ds_read_b64_tr_b16 a[88:89], v144 offset:4096
    ds_read_b64_tr_b16 a[90:91], v144 offset:4608
    s_cselect_b32 s65, 0, s65
    v_mfma_f32_16x16x32_bf16 v[28:31], a[20:23], a[4:7], 0
    ds_read_b128 a[72:75], v9 offset:0
    s_add_u32 s67, s67, 1
    v_mfma_f32_16x16x32_bf16 v[36:39], a[20:23], a[8:11], 0
    ds_read_b128 a[76:79], v9 offset:2048
    s_cmp_eq_u32 s67, 6
    v_mfma_f32_16x16x32_bf16 v[44:47], a[20:23], a[12:15], 0
    ds_read_b128 a[80:83], v9 offset:4096
    s_mov_b32 s62, 16384
    v_mfma_f32_16x16x32_bf16 v[16:19], a[40:43], a[24:27], v[16:19]
    ds_read_b128 a[84:87], v9 offset:6144
    s_cselect_b32 s62, 4294885376, s62
    v_mfma_f32_16x16x32_bf16 v[24:27], a[40:43], a[28:31], v[24:27]
    ds_read_b64_tr_b16 a[92:93], v145 offset:4096
    s_cselect_b32 s67, 0, s67
    v_mfma_f32_16x16x32_bf16 v[32:35], a[40:43], a[32:35], v[32:35]
    ds_read_b64_tr_b16 a[94:95], v145 offset:4608
    v_add_u32 v8, s66, v8
    v_mfma_f32_16x16x32_bf16 v[40:43], a[40:43], a[36:39], v[40:43]
    v_add_u32 v9, s66, v9
    v_add_u32 v144, s62, v144
    v_mfma_f32_16x16x32_bf16 v[20:23], a[44:47], a[24:27], v[20:23]
    v_add_u32 v145, s62, v145
    v_mfma_f32_16x16x32_bf16 v[28:31], a[44:47], a[28:31], v[28:31]
    v_mfma_f32_16x16x32_bf16 v[36:39], a[44:47], a[32:35], v[36:39]
    v_mfma_f32_16x16x32_bf16 v[44:47], a[44:47], a[36:39], v[44:47]
    s_waitcnt lgkmcnt(0)
    s_barrier
    v_mfma_f32_16x16x32_bf16 v[16:19], a[64:67], a[48:51], v[16:19]
    ds_read_b64_tr_b16 a[16:17], v144 offset:0
    ds_read_b64_tr_b16 a[18:19], v144 offset:512
    s_add_u32 s65, s65, 1
    v_mfma_f32_16x16x32_bf16 v[24:27], a[64:67], a[52:55], v[24:27]
    ds_read_b128 a[0:3], v8 offset:0
    ds_read_b128 a[4:7], v8 offset:2048
    s_cmp_eq_u32 s65, 6
    v_mfma_f32_16x16x32_bf16 v[32:35], a[64:67], a[56:59], v[32:35]
    ds_read_b128 a[8:11], v8 offset:4096
    ds_read_b128 a[12:15], v8 offset:6144
    s_mov_b32 s66, 8192
    v_mfma_f32_16x16x32_bf16 v[40:43], a[64:67], a[60:63], v[40:43]
    ds_read_b64_tr_b16 a[20:21], v145 offset:0
    ds_read_b64_tr_b16 a[22:23], v145 offset:512
    s_cselect_b32 s66, 4294926336, s66
    v_mfma_f32_16x16x32_bf16 v[20:23], a[68:71], a[48:51], v[20:23]
    ds_read_b64_tr_b16 a[40:41], v144 offset:4096
    ds_read_b64_tr_b16 a[42:43], v144 offset:4608
    s_cselect_b32 s65, 0, s65
    v_mfma_f32_16x16x32_bf16 v[28:31], a[68:71], a[52:55], v[28:31]
    ds_read_b128 a[24:27], v9 offset:0
    s_add_u32 s67, s67, 1
    v_mfma_f32_16x16x32_bf16 v[36:39], a[68:71], a[56:59], v[36:39]
    ds_read_b128 a[28:31], v9 offset:2048
    s_cmp_eq_u32 s67, 6
    v_mfma_f32_16x16x32_bf16 v[44:47], a[68:71], a[60:63], v[44:47]
    ds_read_b128 a[32:35], v9 offset:4096
    s_mov_b32 s62, 16384
    v_mfma_f32_16x16x32_bf16 v[16:19], a[88:91], a[72:75], v[16:19]
    ds_read_b128 a[36:39], v9 offset:6144
    s_cselect_b32 s62, 4294885376, s62
    v_mfma_f32_16x16x32_bf16 v[24:27], a[88:91], a[76:79], v[24:27]
    ds_read_b64_tr_b16 a[44:45], v145 offset:4096
    s_cselect_b32 s67, 0, s67
    v_mfma_f32_16x16x32_bf16 v[32:35], a[88:91], a[80:83], v[32:35]
    ds_read_b64_tr_b16 a[46:47], v145 offset:4608
    v_add_u32 v8, s66, v8
    v_mfma_f32_16x16x32_bf16 v[40:43], a[88:91], a[84:87], v[40:43]
    v_add_u32 v9, s66, v9
    v_add_u32 v144, s62, v144
    v_mfma_f32_16x16x32_bf16 v[20:23], a[92:95], a[72:75], v[20:23]
    v_add_u32 v145, s62, v145
    v_mfma_f32_16x16x32_bf16 v[28:31], a[92:95], a[76:79], v[28:31]
    v_mfma_f32_16x16x32_bf16 v[36:39], a[92:95], a[80:83], v[36:39]
    v_mfma_f32_16x16x32_bf16 v[44:47], a[92:95], a[84:87], v[44:47]
    s_waitcnt lgkmcnt(0)
g2_loop:
    s_barrier
    v_mfma_f32_16x16x32_bf16 v[16:19], a[16:19], a[0:3], v[16:19]
    ds_read_b64_tr_b16 a[64:65], v144 offset:0
    ds_read_b64_tr_b16 a[66:67], v144 offset:512
    s_add_u32 s65, s65, 1
    s_cmp_eq_u32 s65, 6
    v_mfma_f32_16x16x32_bf16 v[24:27], a[16:19], a[4:7], v[24:27]
    ds_read_b128 a[48:51], v8 offset:0
    ds_read_b128 a[52:55], v8 offset:2048
    s_mov_b32 s66, 8192
    s_cselect_b32 s66, 4294926336, s66
    v_mfma_f32_16x16x32_bf16 v[32:35], a[16:19], a[8:11], v[32:35]
    ds_read_b128 a[56:59], v8 offset:4096
    ds_read_b128 a[60:63], v8 offset:6144
    s_cselect_b32 s65, 0, s65
    s_add_u32 s67, s67, 1
    v_mfma_f32_16x16x32_bf16 v[40:43], a[16:19], a[12:15], v[40:43]
    ds_read_b64_tr_b16 a[68:69], v145 offset:0
    ds_read_b64_tr_b16 a[70:71], v145 offset:512
    s_cmp_eq_u32 s67, 6
    s_mov_b32 s62, 16384
    v_mfma_f32_16x16x32_bf16 v[20:23], a[20:23], a[0:3], v[20:23]
    ds_read_b64_tr_b16 a[88:89], v144 offset:4096
    ds_read_b64_tr_b16 a[90:91], v144 offset:4608
    s_cselect_b32 s62, 4294885376, s62
    s_cselect_b32 s67, 0, s67
    v_mfma_f32_16x16x32_bf16 v[28:31], a[20:23], a[4:7], v[28:31]
    ds_read_b128 a[72:75], v9 offset:0
    s_add_u32 s64, s64, 2
    v_mfma_f32_16x16x32_bf16 v[36:39], a[20:23], a[8:11], v[36:39]
    ds_read_b128 a[76:79], v9 offset:2048
    v_mfma_f32_16x16x32_bf16 v[44:47], a[20:23], a[12:15], v[44:47]
    ds_read_b128 a[80:83], v9 offset:4096
    v_mfma_f32_16x16x32_bf16 v[16:19], a[40:43], a[24:27], v[16:19]
    ds_read_b128 a[84:87], v9 offset:6144
    v_mfma_f32_16x16x32_bf16 v[24:27], a[40:43], a[28:31], v[24:27]
    ds_read_b64_tr_b16 a[92:93], v145 offset:4096
    v_mfma_f32_16x16x32_bf16 v[32:35], a[40:43], a[32:35], v[32:35]
    ds_read_b64_tr_b16 a[94:95], v145 offset:4608
    v_add_u32 v8, s66, v8
    v_mfma_f32_16x16x32_bf16 v[40:43], a[40:43], a[36:39], v[40:43]
    v_add_u32 v9, s66, v9
    v_add_u32 v144, s62, v144
    v_mfma_f32_16x16x32_bf16 v[20:23], a[44:47], a[24:27], v[20:23]
    v_add_u32 v145, s62, v145
    v_mfma_f32_16x16x32_bf16 v[28:31], a[44:47], a[28:31], v[28:31]
    v_mfma_f32_16x16x32_bf16 v[36:39], a[44:47], a[32:35], v[36:39]
    v_mfma_f32_16x16x32_bf16 v[44:47], a[44:47], a[36:39], v[44:47]
    s_waitcnt lgkmcnt(0)
    s_barrier
    v_mfma_f32_16x16x32_bf16 v[16:19], a[64:67], a[48:51], v[16:19]
    ds_read_b64_tr_b16 a[16:17], v144 offset:0
    ds_read_b64_tr_b16 a[18:19], v144 offset:512
    s_add_u32 s65, s65, 1
    v_mfma_f32_16x16x32_bf16 v[24:27], a[64:67], a[52:55], v[24:27]
    ds_read_b128 a[0:3], v8 offset:0
    ds_read_b128 a[4:7], v8 offset:2048
    s_cmp_eq_u32 s65, 6
    v_mfma_f32_16x16x32_bf16 v[32:35], a[64:67], a[56:59], v[32:35]
    ds_read_b128 a[8:11], v8 offset:4096
    ds_read_b128 a[12:15], v8 offset:6144
    s_mov_b32 s66, 8192
    v_mfma_f32_16x16x32_bf16 v[40:43], a[64:67], a[60:63], v[40:43]
    ds_read_b64_tr_b16 a[20:21], v145 offset:0
    ds_read_b64_tr_b16 a[22:23], v145 offset:512
    s_cselect_b32 s66, 4294926336, s66
    v_mfma_f32_16x16x32_bf16 v[20:23], a[68:71], a[48:51], v[20:23]
    ds_read_b64_tr_b16 a[40:41], v144 offset:4096
    ds_read_b64_tr_b16 a[42:43], v144 offset:4608
    s_cselect_b32 s65, 0, s65
    v_mfma_f32_16x16x32_bf16 v[28:31], a[68:71], a[52:55], v[28:31]
    ds_read_b128 a[24:27], v9 offset:0
    s_add_u32 s67, s67, 1
    v_mfma_f32_16x16x32_bf16 v[36:39], a[68:71], a[56:59], v[36:39]
    ds_read_b128 a[28:31], v9 offset:2048
    s_cmp_eq_u32 s67, 6
    v_mfma_f32_16x16x32_bf16 v[44:47], a[68:71], a[60:63], v[44:47]
    ds_read_b128 a[32:35], v9 offset:4096
    s_mov_b32 s62, 16384
    v_mfma_f32_16x16x32_bf16 v[16:19], a[88:91], a[72:75], v[16:19]
    ds_read_b128 a[36:39], v9 offset:6144
    s_cselect_b32 s62, 4294885376, s62
    v_mfma_f32_16x16x32_bf16 v[24:27], a[88:91], a[76:79], v[24:27]
    ds_read_b64_tr_b16 a[44:45], v145 offset:4096
    s_cselect_b32 s67, 0, s67
    v_mfma_f32_16x16x32_bf16 v[32:35], a[88:91], a[80:83], v[32:35]
    ds_read_b64_tr_b16 a[46:47], v145 offset:4608
    v_add_u32 v8, s66, v8
    v_mfma_f32_16x16x32_bf16 v[40:43], a[88:91], a[84:87], v[40:43]
    v_add_u32 v9, s66, v9
    v_add_u32 v144, s62, v144
    v_mfma_f32_16x16x32_bf16 v[20:23], a[92:95], a[72:75], v[20:23]
    v_add_u32 v145, s62, v145
    v_mfma_f32_16x16x32_bf16 v[28:31], a[92:95], a[76:79], v[28:31]
    v_mfma_f32_16x16x32_bf16 v[36:39], a[92:95], a[80:83], v[36:39]
    v_mfma_f32_16x16x32_bf16 v[44:47], a[92:95], a[84:87], v[44:47]
    s_cmp_lt_u32 s64, 14
    s_waitcnt lgkmcnt(0)
    s_cbranch_scc1 g2_loop
    s_waitcnt vmcnt(0)
    v_lshlrev_b32 v64, 16, v48
    v_and_b32 v65, 0xffff0000, v48
    v_lshlrev_b32 v66, 16, v49
    v_and_b32 v67, 0xffff0000, v49
    v_lshlrev_b32 v68, 16, v50
    v_and_b32 v69, 0xffff0000, v50
    v_lshlrev_b32 v70, 16, v51
    v_and_b32 v71, 0xffff0000, v51
    v_pk_add_f32 v[16:17], v[16:17], v[64:65]
    v_pk_add_f32 v[18:19], v[18:19], v[66:67]
    v_pk_add_f32 v[20:21], v[20:21], v[68:69]
    v_pk_add_f32 v[22:23], v[22:23], v[70:71]
    v_cvt_pk_bf16_f32 v72, v16, v17
    v_cvt_pk_bf16_f32 v73, v18, v19
    v_cvt_pk_bf16_f32 v74, v20, v21
    v_cvt_pk_bf16_f32 v75, v22, v23
    s_nop 0
    v_permlane16_swap_b32 v72, v74
    v_permlane16_swap_b32 v73, v75
    s_mov_b32 s56, 4194304
    buffer_store_dwordx4 v[72:75], v15, s[32:35], s56 offen sc1
    v_lshlrev_b32 v64, 16, v52
    v_and_b32 v65, 0xffff0000, v52
    v_lshlrev_b32 v66, 16, v53
    v_and_b32 v67, 0xffff0000, v53
    v_lshlrev_b32 v68, 16, v54
    v_and_b32 v69, 0xffff0000, v54
    v_lshlrev_b32 v70, 16, v55
    v_and_b32 v71, 0xffff0000, v55
    v_pk_add_f32 v[24:25], v[24:25], v[64:65]
    v_pk_add_f32 v[26:27], v[26:27], v[66:67]
    v_pk_add_f32 v[28:29], v[28:29], v[68:69]
    v_pk_add_f32 v[30:31], v[30:31], v[70:71]
    v_cvt_pk_bf16_f32 v76, v24, v25
    v_cvt_pk_bf16_f32 v77, v26, v27
    v_cvt_pk_bf16_f32 v78, v28, v29
    v_cvt_pk_bf16_f32 v79, v30, v31
    s_nop 0
    v_permlane16_swap_b32 v76, v78
    v_permlane16_swap_b32 v77, v79
    s_mov_b32 s56, 4227072
    buffer_store_dwordx4 v[76:79], v15, s[32:35], s56 offen sc1
    v_lshlrev_b32 v64, 16, v56
    v_and_b32 v65, 0xffff0000, v56
    v_lshlrev_b32 v66, 16, v57
    v_and_b32 v67, 0xffff0000, v57
    v_lshlrev_b32 v68, 16, v58
    v_and_b32 v69, 0xffff0000, v58
    v_lshlrev_b32 v70, 16, v59
    v_and_b32 v71, 0xffff0000, v59
    v_pk_add_f32 v[32:33], v[32:33], v[64:65]
    v_pk_add_f32 v[34:35], v[34:35], v[66:67]
    v_pk_add_f32 v[36:37], v[36:37], v[68:69]
    v_pk_add_f32 v[38:39], v[38:39], v[70:71]
    v_cvt_pk_bf16_f32 v80, v32, v33
    v_cvt_pk_bf16_f32 v81, v34, v35
    v_cvt_pk_bf16_f32 v82, v36, v37
    v_cvt_pk_bf16_f32 v83, v38, v39
    s_nop 0
    v_permlane16_swap_b32 v80, v82
    v_permlane16_swap_b32 v81, v83
    s_mov_b32 s56, 4259840
    buffer_store_dwordx4 v[80:83], v15, s[32:35], s56 offen sc1
    v_lshlrev_b32 v64, 16, v60
    v_and_b32 v65, 0xffff0000, v60
    v_lshlrev_b32 v66, 16, v61
    v_and_b32 v67, 0xffff0000, v61
    v_lshlrev_b32 v68, 16, v62
    v_and_b32 v69, 0xffff0000, v62
    v_lshlrev_b32 v70, 16, v63
    v_and_b32 v71, 0xffff0000, v63
    v_pk_add_f32 v[40:41], v[40:41], v[64:65]
    v_pk_add_f32 v[42:43], v[42:43], v[66:67]
    v_pk_add_f32 v[44:45], v[44:45], v[68:69]
    v_pk_add_f32 v[46:47], v[46:47], v[70:71]
    v_cvt_pk_bf16_f32 v84, v40, v41
    v_cvt_pk_bf16_f32 v85, v42, v43
    v_cvt_pk_bf16_f32 v86, v44, v45
    v_cvt_pk_bf16_f32 v87, v46, v47
    s_nop 0
    v_permlane16_swap_b32 v84, v86
    v_permlane16_swap_b32 v85, v87
    s_mov_b32 s56, 4292608
    buffer_store_dwordx4 v[84:87], v15, s[32:35], s56 offen sc1
    v_pk_add_f32 v[96:97], v[16:17], v[18:19]
    v_pk_mul_f32 v[98:99], v[16:17], v[16:17]
    v_pk_add_f32 v[100:101], v[20:21], v[22:23]
    v_pk_fma_f32 v[98:99], v[18:19], v[18:19], v[98:99]
    v_pk_add_f32 v[96:97], v[96:97], v[100:101]
    v_pk_fma_f32 v[98:99], v[20:21], v[20:21], v[98:99]
    v_add_f32 v88, v96, v97
    v_pk_fma_f32 v[98:99], v[22:23], v[22:23], v[98:99]
    v_add_f32 v92, v98, v99
    v_pk_add_f32 v[96:97], v[24:25], v[26:27]
    v_pk_mul_f32 v[98:99], v[24:25], v[24:25]
    v_pk_add_f32 v[100:101], v[28:29], v[30:31]
    v_pk_fma_f32 v[98:99], v[26:27], v[26:27], v[98:99]
    v_pk_add_f32 v[96:97], v[96:97], v[100:101]
    v_pk_fma_f32 v[98:99], v[28:29], v[28:29], v[98:99]
    v_add_f32 v89, v96, v97
    v_pk_fma_f32 v[98:99], v[30:31], v[30:31], v[98:99]
    v_add_f32 v93, v98, v99
    v_pk_add_f32 v[96:97], v[32:33], v[34:35]
    v_pk_mul_f32 v[98:99], v[32:33], v[32:33]
    v_pk_add_f32 v[100:101], v[36:37], v[38:39]
    v_pk_fma_f32 v[98:99], v[34:35], v[34:35], v[98:99]
    v_pk_add_f32 v[96:97], v[96:97], v[100:101]
    v_pk_fma_f32 v[98:99], v[36:37], v[36:37], v[98:99]
    v_add_f32 v90, v96, v97
    v_pk_fma_f32 v[98:99], v[38:39], v[38:39], v[98:99]
    v_add_f32 v94, v98, v99
    v_pk_add_f32 v[96:97], v[40:41], v[42:43]
    v_pk_mul_f32 v[98:99], v[40:41], v[40:41]
    v_pk_add_f32 v[100:101], v[44:45], v[46:47]
    v_pk_fma_f32 v[98:99], v[42:43], v[42:43], v[98:99]
    v_pk_add_f32 v[96:97], v[96:97], v[100:101]
    v_pk_fma_f32 v[98:99], v[44:45], v[44:45], v[98:99]
    v_add_f32 v91, v96, v97
    v_pk_fma_f32 v[98:99], v[46:47], v[46:47], v[98:99]
    v_add_f32 v95, v98, v99
    v_permlane32_swap_b32 v88, v90
    v_permlane32_swap_b32 v89, v91
    v_permlane32_swap_b32 v92, v94
    v_permlane32_swap_b32 v93, v95
    v_add_f32 v88, v88, v90
    v_add_f32 v89, v89, v91
    v_add_f32 v92, v92, v94
    v_add_f32 v93, v93, v95
    v_permlane16_swap_b32 v88, v89
    s_nop 0
    v_permlane16_swap_b32 v92, v93
    v_add_f32 v88, v88, v89
    v_add_f32 v92, v92, v93
    v_mov_b32 v89, v92
    v_lshlrev_b32 v12, 3, v1
    s_lshl_b32 s56, s57, 3
    s_add_u32 s56, s56, 25821184
    s_lshr_b32 s55, s54, 6
    s_lshl_b32 s55, s55, 14
    s_add_u32 s56, s56, s55
    buffer_store_dwordx2 v[88:89], v12, s[32:35], s56 offen sc1
    s_barrier
    s_waitcnt vmcnt(0)
    s_barrier
    s_cmp_eq_u32 s29, 7
    s_cbranch_scc1 c_g5
    s_barrier
    s_and_b32 s50, s30, 1
    s_lshl_b32 s50, s50, 13
    v_lshrrev_b32 v4, 1, v3
    v_xor_b32 v4, v2, v4
    v_lshlrev_b32 v4, 4, v4
    v_lshlrev_b32 v5, 7, v3
    v_add_u32 v8, v4, v5
    v_add_u32 v8, 49152, v8
    v_add_u32 v8, s50, v8
    v_xor_b32 v9, 64, v8
    s_lshr_b32 s51, s30, 1
    s_lshl_b32 s51, s51, 13
    v_lshrrev_b32 v4, 2, v3
    v_and_b32 v5, 3, v3
    v_lshrrev_b32 v6, 1, v4
    v_and_b32 v7, 1, v2
    v_lshlrev_b32 v7, 1, v7
    v_or_b32 v6, v6, v7
    v_lshlrev_b32 v7, 3, v2
    v_add_u32 v7, v7, v4
    v_lshlrev_b32 v7, 7, v7
    v_lshlrev_b32 v12, 3, v5
    v_add_u32 v7, v7, v12
    v_add_u32 v7, 98304, v7
    v_add_u32 v7, s51, v7
    v_xor_b32 v12, 0, v6
    v_lshlrev_b32 v12, 5, v12
    v_add_u32 v144, v12, v7
    v_xor_b32 v12, 1, v6
    v_lshlrev_b32 v12, 5, v12
    v_add_u32 v145, v12, v7
    v_xor_b32 v12, 2, v6
    v_lshlrev_b32 v12, 5, v12
    v_add_u32 v146, v12, v7
    v_xor_b32 v12, 3, v6
    v_lshlrev_b32 v12, 5, v12
    v_add_u32 v147, v12, v7
    s_and_b32 s50, s30, 1
    s_lshr_b32 s51, s30, 1
    v_lshlrev_b32 v7, 8, v3
    s_lshl_b32 s52, s50, 14
    s_add_u32 s52, s52, 16384
    v_add_u32 v7, s52, v7
    v_and_b32 v12, 1, v2
    v_lshlrev_b32 v12, 3, v12
    v_add_u32 v7, v7, v12
    v_lshrrev_b32 v12, 1, v2
    s_lshl_b32 s53, s51, 3
    v_or_b32 v12, s53, v12
    v_or_b32 v14, 0, v12
    v_xor_b32 v14, v14, v3
    v_lshlrev_b32 v14, 4, v14
    v_add_u32 v152, v14, v7
    v_or_b32 v14, 2, v12
    v_xor_b32 v14, v14, v3
    v_lshlrev_b32 v14, 4, v14
    v_add_u32 v153, v14, v7
    v_or_b32 v14, 4, v12
    v_xor_b32 v14, v14, v3
    v_lshlrev_b32 v14, 4, v14
    v_add_u32 v154, v14, v7
    v_or_b32 v14, 6, v12
    v_xor_b32 v14, v14, v3
    v_lshlrev_b32 v14, 4, v14
    v_add_u32 v155, v14, v7
    v_lshlrev_b32 v156, 2, v3
    s_lshl_b32 s52, s50, 8
    v_add_u32 v156, s52, v156
    v_lshlrev_b32 v157, 4, v2
    s_lshl_b32 s52, s51, 8
    v_add_u32 v157, s52, v157
    s_mov_b32 s65, 0
    s_mov_b32 s67, 0
    s_barrier
    ds_read_b128 a[0:3], v8 offset:0
    ds_read_b64_tr_b16 a[16:17], v144 offset:0
    ds_read_b64_tr_b16 a[18:19], v144 offset:512
    ds_read_b128 a[4:7], v8 offset:2048
    ds_read_b128 a[8:11], v8 offset:4096
    ds_read_b128 a[12:15], v8 offset:6144
    ds_read_b64_tr_b16 a[20:21], v145 offset:0
    ds_read_b64_tr_b16 a[22:23], v145 offset:512
    ds_read_b64_tr_b16 a[24:25], v146 offset:0
    ds_read_b64_tr_b16 a[26:27], v146 offset:512
    ds_read_b64_tr_b16 a[28:29], v147 offset:0
    ds_read_b64_tr_b16 a[30:31], v147 offset:512
    ds_read_b128 a[32:35], v9 offset:0
    ds_read_b64_tr_b16 a[48:49], v144 offset:4096
    ds_read_b64_tr_b16 a[50:51], v144 offset:4608
    ds_read_b128 a[36:39], v9 offset:2048
    ds_read_b128 a[40:43], v9 offset:4096
    ds_read_b128 a[44:47], v9 offset:6144
    ds_read_b64_tr_b16 a[52:53], v145 offset:4096
    ds_read_b64_tr_b16 a[54:55], v145 offset:4608
    ds_read_b64_tr_b16 a[56:57], v146 offset:4096
    ds_read_b64_tr_b16 a[58:59], v146 offset:4608
    ds_read_b64_tr_b16 a[60:61], v147 offset:4096
    ds_read_b64_tr_b16 a[62:63], v147 offset:4608
    s_add_u32 s65, s65, 1
    s_cmp_eq_u32 s65, 3
    s_mov_b32 s66, 16384
    s_cselect_b32 s66, 4294934528, s66
    s_cselect_b32 s65, 0, s65
    s_add_u32 s67, s67, 1
    s_cmp_eq_u32 s67, 4
    s_mov_b32 s62, 16384
    s_cselect_b32 s62, 4294918144, s62
    s_cselect_b32 s67, 0, s67
    v_add_u32 v8, s66, v8
    v_add_u32 v9, s66, v9
    v_add_u32 v144, s62, v144
    v_add_u32 v145, s62, v145
    v_add_u32 v146, s62, v146
    v_add_u32 v147, s62, v147
    s_waitcnt lgkmcnt(0)
    s_mov_b32 s64, 0
    s_barrier
    v_mfma_f32_16x16x32_bf16 v[16:19], a[16:19], a[0:3], 0
    ds_read_b128 v[80:83], v8 offset:0
    s_add_u32 s65, s65, 1
    v_mfma_f32_16x16x32_bf16 v[32:35], a[16:19], a[4:7], 0
    ds_read_b64_tr_b16 v[96:97], v144 offset:0
    s_cmp_eq_u32 s65, 3
    v_mfma_f32_16x16x32_bf16 v[48:51], a[16:19], a[8:11], 0
    ds_read_b64_tr_b16 v[98:99], v144 offset:512
    s_mov_b32 s66, 16384
    v_mfma_f32_16x16x32_bf16 v[64:67], a[16:19], a[12:15], 0
    ds_read_b128 v[84:87], v8 offset:2048
    s_cselect_b32 s66, 4294934528, s66
    v_mfma_f32_16x16x32_bf16 v[20:23], a[20:23], a[0:3], 0
    ds_read_b128 v[88:91], v8 offset:4096
    s_cselect_b32 s65, 0, s65
    v_mfma_f32_16x16x32_bf16 v[36:39], a[20:23], a[4:7], 0
    ds_read_b128 v[92:95], v8 offset:6144
    s_add_u32 s67, s67, 1
    v_mfma_f32_16x16x32_bf16 v[52:55], a[20:23], a[8:11], 0
    ds_read_b64_tr_b16 v[100:101], v145 offset:0
    s_cmp_eq_u32 s67, 4
    v_mfma_f32_16x16x32_bf16 v[68:71], a[20:23], a[12:15], 0
    ds_read_b64_tr_b16 v[102:103], v145 offset:512
    s_mov_b32 s62, 16384
    v_mfma_f32_16x16x32_bf16 v[24:27], a[24:27], a[0:3], 0
    ds_read_b64_tr_b16 v[104:105], v146 offset:0
    s_cselect_b32 s62, 4294918144, s62
    v_mfma_f32_16x16x32_bf16 v[40:43], a[24:27], a[4:7], 0
    ds_read_b64_tr_b16 v[106:107], v146 offset:512
    s_cselect_b32 s67, 0, s67
    v_mfma_f32_16x16x32_bf16 v[56:59], a[24:27], a[8:11], 0
    ds_read_b64_tr_b16 v[108:109], v147 offset:0
    v_mfma_f32_16x16x32_bf16 v[72:75], a[24:27], a[12:15], 0
    ds_read_b64_tr_b16 v[110:111], v147 offset:512
    v_mfma_f32_16x16x32_bf16 v[28:31], a[28:31], a[0:3], 0
    ds_read_b128 v[112:115], v9 offset:0
    v_mfma_f32_16x16x32_bf16 v[44:47], a[28:31], a[4:7], 0
    ds_read_b64_tr_b16 v[128:129], v144 offset:4096
    v_mfma_f32_16x16x32_bf16 v[60:63], a[28:31], a[8:11], 0
    ds_read_b64_tr_b16 v[130:131], v144 offset:4608
    v_mfma_f32_16x16x32_bf16 v[76:79], a[28:31], a[12:15], 0
    ds_read_b128 v[116:119], v9 offset:2048
    v_mfma_f32_16x16x32_bf16 v[16:19], a[48:51], a[32:35], v[16:19]
    ds_read_b128 v[120:123], v9 offset:4096
    v_mfma_f32_16x16x32_bf16 v[32:35], a[48:51], a[36:39], v[32:35]
    ds_read_b128 v[124:127], v9 offset:6144
    v_mfma_f32_16x16x32_bf16 v[48:51], a[48:51], a[40:43], v[48:51]
    ds_read_b64_tr_b16 v[132:133], v145 offset:4096
    v_mfma_f32_16x16x32_bf16 v[64:67], a[48:51], a[44:47], v[64:67]
    ds_read_b64_tr_b16 v[134:135], v145 offset:4608
    v_mfma_f32_16x16x32_bf16 v[20:23], a[52:55], a[32:35], v[20:23]
    ds_read_b64_tr_b16 v[136:137], v146 offset:4096
    v_mfma_f32_16x16x32_bf16 v[36:39], a[52:55], a[36:39], v[36:39]
    ds_read_b64_tr_b16 v[138:139], v146 offset:4608
    v_mfma_f32_16x16x32_bf16 v[52:55], a[52:55], a[40:43], v[52:55]
    ds_read_b64_tr_b16 v[140:141], v147 offset:4096
    v_mfma_f32_16x16x32_bf16 v[68:71], a[52:55], a[44:47], v[68:71]
    ds_read_b64_tr_b16 v[142:143], v147 offset:4608
    v_add_u32 v8, s66, v8
    v_mfma_f32_16x16x32_bf16 v[24:27], a[56:59], a[32:35], v[24:27]
    v_add_u32 v9, s66, v9
    v_add_u32 v144, s62, v144
    v_mfma_f32_16x16x32_bf16 v[40:43], a[56:59], a[36:39], v[40:43]
    v_add_u32 v145, s62, v145
    v_add_u32 v146, s62, v146
    v_mfma_f32_16x16x32_bf16 v[56:59], a[56:59], a[40:43], v[56:59]
    v_add_u32 v147, s62, v147
    v_mfma_f32_16x16x32_bf16 v[72:75], a[56:59], a[44:47], v[72:75]
    v_mfma_f32_16x16x32_bf16 v[28:31], a[60:63], a[32:35], v[28:31]
    v_mfma_f32_16x16x32_bf16 v[44:47], a[60:63], a[36:39], v[44:47]
    v_mfma_f32_16x16x32_bf16 v[60:63], a[60:63], a[40:43], v[60:63]
    v_mfma_f32_16x16x32_bf16 v[76:79], a[60:63], a[44:47], v[76:79]
    s_waitcnt lgkmcnt(0)
    s_barrier
    v_mfma_f32_16x16x32_bf16 v[16:19], v[96:99], v[80:83], v[16:19]
    ds_read_b128 a[0:3], v8 offset:0
    s_add_u32 s65, s65, 1
    v_mfma_f32_16x16x32_bf16 v[32:35], v[96:99], v[84:87], v[32:35]
    ds_read_b64_tr_b16 a[16:17], v144 offset:0
    s_cmp_eq_u32 s65, 3
    v_mfma_f32_16x16x32_bf16 v[48:51], v[96:99], v[88:91], v[48:51]
    ds_read_b64_tr_b16 a[18:19], v144 offset:512
    s_mov_b32 s66, 16384
    v_mfma_f32_16x16x32_bf16 v[64:67], v[96:99], v[92:95], v[64:67]
    ds_read_b128 a[4:7], v8 offset:2048
    s_cselect_b32 s66, 4294934528, s66
    v_mfma_f32_16x16x32_bf16 v[20:23], v[100:103], v[80:83], v[20:23]
    ds_read_b128 a[8:11], v8 offset:4096
    s_cselect_b32 s65, 0, s65
    v_mfma_f32_16x16x32_bf16 v[36:39], v[100:103], v[84:87], v[36:39]
    ds_read_b128 a[12:15], v8 offset:6144
    s_add_u32 s67, s67, 1
    v_mfma_f32_16x16x32_bf16 v[52:55], v[100:103], v[88:91], v[52:55]
    ds_read_b64_tr_b16 a[20:21], v145 offset:0
    s_cmp_eq_u32 s67, 4
    v_mfma_f32_16x16x32_bf16 v[68:71], v[100:103], v[92:95], v[68:71]
    ds_read_b64_tr_b16 a[22:23], v145 offset:512
    s_mov_b32 s62, 16384
    v_mfma_f32_16x16x32_bf16 v[24:27], v[104:107], v[80:83], v[24:27]
    ds_read_b64_tr_b16 a[24:25], v146 offset:0
    s_cselect_b32 s62, 4294918144, s62
    v_mfma_f32_16x16x32_bf16 v[40:43], v[104:107], v[84:87], v[40:43]
    ds_read_b64_tr_b16 a[26:27], v146 offset:512
    s_cselect_b32 s67, 0, s67
    v_mfma_f32_16x16x32_bf16 v[56:59], v[104:107], v[88:91], v[56:59]
    ds_read_b64_tr_b16 a[28:29], v147 offset:0
    v_mfma_f32_16x16x32_bf16 v[72:75], v[104:107], v[92:95], v[72:75]
    ds_read_b64_tr_b16 a[30:31], v147 offset:512
    v_mfma_f32_16x16x32_bf16 v[28:31], v[108:111], v[80:83], v[28:31]
    ds_read_b128 a[32:35], v9 offset:0
    v_mfma_f32_16x16x32_bf16 v[44:47], v[108:111], v[84:87], v[44:47]
    ds_read_b64_tr_b16 a[48:49], v144 offset:4096
    v_mfma_f32_16x16x32_bf16 v[60:63], v[108:111], v[88:91], v[60:63]
    ds_read_b64_tr_b16 a[50:51], v144 offset:4608
    v_mfma_f32_16x16x32_bf16 v[76:79], v[108:111], v[92:95], v[76:79]
    ds_read_b128 a[36:39], v9 offset:2048
    v_mfma_f32_16x16x32_bf16 v[16:19], v[128:131], v[112:115], v[16:19]
    ds_read_b128 a[40:43], v9 offset:4096
    v_mfma_f32_16x16x32_bf16 v[32:35], v[128:131], v[116:119], v[32:35]
    ds_read_b128 a[44:47], v9 offset:6144
    v_mfma_f32_16x16x32_bf16 v[48:51], v[128:131], v[120:123], v[48:51]
    ds_read_b64_tr_b16 a[52:53], v145 offset:4096
    v_mfma_f32_16x16x32_bf16 v[64:67], v[128:131], v[124:127], v[64:67]
    ds_read_b64_tr_b16 a[54:55], v145 offset:4608
    v_mfma_f32_16x16x32_bf16 v[20:23], v[132:135], v[112:115], v[20:23]
    ds_read_b64_tr_b16 a[56:57], v146 offset:4096
    v_mfma_f32_16x16x32_bf16 v[36:39], v[132:135], v[116:119], v[36:39]
    ds_read_b64_tr_b16 a[58:59], v146 offset:4608
    v_mfma_f32_16x16x32_bf16 v[52:55], v[132:135], v[120:123], v[52:55]
    ds_read_b64_tr_b16 a[60:61], v147 offset:4096
    v_mfma_f32_16x16x32_bf16 v[68:71], v[132:135], v[124:127], v[68:71]
    ds_read_b64_tr_b16 a[62:63], v147 offset:4608
    v_add_u32 v8, s66, v8
    v_mfma_f32_16x16x32_bf16 v[24:27], v[136:139], v[112:115], v[24:27]
    v_add_u32 v9, s66, v9
    v_add_u32 v144, s62, v144
    v_mfma_f32_16x16x32_bf16 v[40:43], v[136:139], v[116:119], v[40:43]
    v_add_u32 v145, s62, v145
    v_add_u32 v146, s62, v146
    v_mfma_f32_16x16x32_bf16 v[56:59], v[136:139], v[120:123], v[56:59]
    v_add_u32 v147, s62, v147
    v_mfma_f32_16x16x32_bf16 v[72:75], v[136:139], v[124:127], v[72:75]
    v_mfma_f32_16x16x32_bf16 v[28:31], v[140:143], v[112:115], v[28:31]
    v_mfma_f32_16x16x32_bf16 v[44:47], v[140:143], v[116:119], v[44:47]
    v_mfma_f32_16x16x32_bf16 v[60:63], v[140:143], v[120:123], v[60:63]
    v_mfma_f32_16x16x32_bf16 v[76:79], v[140:143], v[124:127], v[76:79]
    s_waitcnt lgkmcnt(0)
g3a_loop:
    s_barrier
    v_mfma_f32_16x16x32_bf16 v[16:19], a[16:19], a[0:3], v[16:19]
    ds_read_b128 v[80:83], v8 offset:0
    s_add_u32 s65, s65, 1
    v_mfma_f32_16x16x32_bf16 v[32:35], a[16:19], a[4:7], v[32:35]
    ds_read_b64_tr_b16 v[96:97], v144 offset:0
    s_cmp_eq_u32 s65, 3
    v_mfma_f32_16x16x32_bf16 v[48:51], a[16:19], a[8:11], v[48:51]
    ds_read_b64_tr_b16 v[98:99], v144 offset:512
    s_mov_b32 s66, 16384
    v_mfma_f32_16x16x32_bf16 v[64:67], a[16:19], a[12:15], v[64:67]
    ds_read_b128 v[84:87], v8 offset:2048
    s_cselect_b32 s66, 4294934528, s66
    v_mfma_f32_16x16x32_bf16 v[20:23], a[20:23], a[0:3], v[20:23]
    ds_read_b128 v[88:91], v8 offset:4096
    s_cselect_b32 s65, 0, s65
    v_mfma_f32_16x16x32_bf16 v[36:39], a[20:23], a[4:7], v[36:39]
    ds_read_b128 v[92:95], v8 offset:6144
    s_add_u32 s67, s67, 1
    v_mfma_f32_16x16x32_bf16 v[52:55], a[20:23], a[8:11], v[52:55]
    ds_read_b64_tr_b16 v[100:101], v145 offset:0
    s_cmp_eq_u32 s67, 4
    v_mfma_f32_16x16x32_bf16 v[68:71], a[20:23], a[12:15], v[68:71]
    ds_read_b64_tr_b16 v[102:103], v145 offset:512
    s_mov_b32 s62, 16384
    v_mfma_f32_16x16x32_bf16 v[24:27], a[24:27], a[0:3], v[24:27]
    ds_read_b64_tr_b16 v[104:105], v146 offset:0
    s_cselect_b32 s62, 4294918144, s62
    v_mfma_f32_16x16x32_bf16 v[40:43], a[24:27], a[4:7], v[40:43]
    ds_read_b64_tr_b16 v[106:107], v146 offset:512
    s_cselect_b32 s67, 0, s67
    v_mfma_f32_16x16x32_bf16 v[56:59], a[24:27], a[8:11], v[56:59]
    ds_read_b64_tr_b16 v[108:109], v147 offset:0
    s_add_u32 s64, s64, 2
    v_mfma_f32_16x16x32_bf16 v[72:75], a[24:27], a[12:15], v[72:75]
    ds_read_b64_tr_b16 v[110:111], v147 offset:512
    v_mfma_f32_16x16x32_bf16 v[28:31], a[28:31], a[0:3], v[28:31]
    ds_read_b128 v[112:115], v9 offset:0
    v_mfma_f32_16x16x32_bf16 v[44:47], a[28:31], a[4:7], v[44:47]
    ds_read_b64_tr_b16 v[128:129], v144 offset:4096
    v_mfma_f32_16x16x32_bf16 v[60:63], a[28:31], a[8:11], v[60:63]
    ds_read_b64_tr_b16 v[130:131], v144 offset:4608
    v_mfma_f32_16x16x32_bf16 v[76:79], a[28:31], a[12:15], v[76:79]
    ds_read_b128 v[116:119], v9 offset:2048
    v_mfma_f32_16x16x32_bf16 v[16:19], a[48:51], a[32:35], v[16:19]
    ds_read_b128 v[120:123], v9 offset:4096
    v_mfma_f32_16x16x32_bf16 v[32:35], a[48:51], a[36:39], v[32:35]
    ds_read_b128 v[124:127], v9 offset:6144
    v_mfma_f32_16x16x32_bf16 v[48:51], a[48:51], a[40:43], v[48:51]
    ds_read_b64_tr_b16 v[132:133], v145 offset:4096
    v_mfma_f32_16x16x32_bf16 v[64:67], a[48:51], a[44:47], v[64:67]
    ds_read_b64_tr_b16 v[134:135], v145 offset:4608
    v_mfma_f32_16x16x32_bf16 v[20:23], a[52:55], a[32:35], v[20:23]
    ds_read_b64_tr_b16 v[136:137], v146 offset:4096
    v_mfma_f32_16x16x32_bf16 v[36:39], a[52:55], a[36:39], v[36:39]
    ds_read_b64_tr_b16 v[138:139], v146 offset:4608
    v_mfma_f32_16x16x32_bf16 v[52:55], a[52:55], a[40:43], v[52:55]
    ds_read_b64_tr_b16 v[140:141], v147 offset:4096
    v_mfma_f32_16x16x32_bf16 v[68:71], a[52:55], a[44:47], v[68:71]
    ds_read_b64_tr_b16 v[142:143], v147 offset:4608
    v_add_u32 v8, s66, v8
    v_mfma_f32_16x16x32_bf16 v[24:27], a[56:59], a[32:35], v[24:27]
    v_add_u32 v9, s66, v9
    v_add_u32 v144, s62, v144
    v_mfma_f32_16x16x32_bf16 v[40:43], a[56:59], a[36:39], v[40:43]
    v_add_u32 v145, s62, v145
    v_add_u32 v146, s62, v146
    v_mfma_f32_16x16x32_bf16 v[56:59], a[56:59], a[40:43], v[56:59]
    v_add_u32 v147, s62, v147
    v_mfma_f32_16x16x32_bf16 v[72:75], a[56:59], a[44:47], v[72:75]
    v_mfma_f32_16x16x32_bf16 v[28:31], a[60:63], a[32:35], v[28:31]
    v_mfma_f32_16x16x32_bf16 v[44:47], a[60:63], a[36:39], v[44:47]
    v_mfma_f32_16x16x32_bf16 v[60:63], a[60:63], a[40:43], v[60:63]
    v_mfma_f32_16x16x32_bf16 v[76:79], a[60:63], a[44:47], v[76:79]
    s_waitcnt lgkmcnt(0)
    s_barrier
    v_mfma_f32_16x16x32_bf16 v[16:19], v[96:99], v[80:83], v[16:19]
    ds_read_b128 a[0:3], v8 offset:0
    s_add_u32 s65, s65, 1
    v_mfma_f32_16x16x32_bf16 v[32:35], v[96:99], v[84:87], v[32:35]
    ds_read_b64_tr_b16 a[16:17], v144 offset:0
    s_cmp_eq_u32 s65, 3
    v_mfma_f32_16x16x32_bf16 v[48:51], v[96:99], v[88:91], v[48:51]
    ds_read_b64_tr_b16 a[18:19], v144 offset:512
    s_mov_b32 s66, 16384
    v_mfma_f32_16x16x32_bf16 v[64:67], v[96:99], v[92:95], v[64:67]
    ds_read_b128 a[4:7], v8 offset:2048
    s_cselect_b32 s66, 4294934528, s66
    v_mfma_f32_16x16x32_bf16 v[20:23], v[100:103], v[80:83], v[20:23]
    ds_read_b128 a[8:11], v8 offset:4096
    s_cselect_b32 s65, 0, s65
    v_mfma_f32_16x16x32_bf16 v[36:39], v[100:103], v[84:87], v[36:39]
    ds_read_b128 a[12:15], v8 offset:6144
    s_add_u32 s67, s67, 1
    v_mfma_f32_16x16x32_bf16 v[52:55], v[100:103], v[88:91], v[52:55]
    ds_read_b64_tr_b16 a[20:21], v145 offset:0
    s_cmp_eq_u32 s67, 4
    v_mfma_f32_16x16x32_bf16 v[68:71], v[100:103], v[92:95], v[68:71]
    ds_read_b64_tr_b16 a[22:23], v145 offset:512
    s_mov_b32 s62, 16384
    v_mfma_f32_16x16x32_bf16 v[24:27], v[104:107], v[80:83], v[24:27]
    ds_read_b64_tr_b16 a[24:25], v146 offset:0
    s_cselect_b32 s62, 4294918144, s62
    v_mfma_f32_16x16x32_bf16 v[40:43], v[104:107], v[84:87], v[40:43]
    ds_read_b64_tr_b16 a[26:27], v146 offset:512
    s_cselect_b32 s67, 0, s67
    v_mfma_f32_16x16x32_bf16 v[56:59], v[104:107], v[88:91], v[56:59]
    ds_read_b64_tr_b16 a[28:29], v147 offset:0
    v_mfma_f32_16x16x32_bf16 v[72:75], v[104:107], v[92:95], v[72:75]
    ds_read_b64_tr_b16 a[30:31], v147 offset:512
    v_mfma_f32_16x16x32_bf16 v[28:31], v[108:111], v[80:83], v[28:31]
    ds_read_b128 a[32:35], v9 offset:0
    v_mfma_f32_16x16x32_bf16 v[44:47], v[108:111], v[84:87], v[44:47]
    ds_read_b64_tr_b16 a[48:49], v144 offset:4096
    v_mfma_f32_16x16x32_bf16 v[60:63], v[108:111], v[88:91], v[60:63]
    ds_read_b64_tr_b16 a[50:51], v144 offset:4608
    v_mfma_f32_16x16x32_bf16 v[76:79], v[108:111], v[92:95], v[76:79]
    ds_read_b128 a[36:39], v9 offset:2048
    v_mfma_f32_16x16x32_bf16 v[16:19], v[128:131], v[112:115], v[16:19]
    ds_read_b128 a[40:43], v9 offset:4096
    v_mfma_f32_16x16x32_bf16 v[32:35], v[128:131], v[116:119], v[32:35]
    ds_read_b128 a[44:47], v9 offset:6144
    v_mfma_f32_16x16x32_bf16 v[48:51], v[128:131], v[120:123], v[48:51]
    ds_read_b64_tr_b16 a[52:53], v145 offset:4096
    v_mfma_f32_16x16x32_bf16 v[64:67], v[128:131], v[124:127], v[64:67]
    ds_read_b64_tr_b16 a[54:55], v145 offset:4608
    v_mfma_f32_16x16x32_bf16 v[20:23], v[132:135], v[112:115], v[20:23]
    ds_read_b64_tr_b16 a[56:57], v146 offset:4096
    v_mfma_f32_16x16x32_bf16 v[36:39], v[132:135], v[116:119], v[36:39]
    ds_read_b64_tr_b16 a[58:59], v146 offset:4608
    v_mfma_f32_16x16x32_bf16 v[52:55], v[132:135], v[120:123], v[52:55]
    ds_read_b64_tr_b16 a[60:61], v147 offset:4096
    v_mfma_f32_16x16x32_bf16 v[68:71], v[132:135], v[124:127], v[68:71]
    ds_read_b64_tr_b16 a[62:63], v147 offset:4608
    v_add_u32 v8, s66, v8
    v_mfma_f32_16x16x32_bf16 v[24:27], v[136:139], v[112:115], v[24:27]
    v_add_u32 v9, s66, v9
    v_add_u32 v144, s62, v144
    v_mfma_f32_16x16x32_bf16 v[40:43], v[136:139], v[116:119], v[40:43]
    v_add_u32 v145, s62, v145
    v_add_u32 v146, s62, v146
    v_mfma_f32_16x16x32_bf16 v[56:59], v[136:139], v[120:123], v[56:59]
    v_add_u32 v147, s62, v147
    v_mfma_f32_16x16x32_bf16 v[72:75], v[136:139], v[124:127], v[72:75]
    v_mfma_f32_16x16x32_bf16 v[28:31], v[140:143], v[112:115], v[28:31]
    v_mfma_f32_16x16x32_bf16 v[44:47], v[140:143], v[116:119], v[44:47]
    v_mfma_f32_16x16x32_bf16 v[60:63], v[140:143], v[120:123], v[60:63]
    v_mfma_f32_16x16x32_bf16 v[76:79], v[140:143], v[124:127], v[76:79]
    s_cmp_lt_u32 s64, 14
    s_waitcnt lgkmcnt(0)
    s_cbranch_scc1 g3a_loop
    ds_read_b128 v[80:83], v157 offset:1536
    ds_read_b128 v[84:87], v157 offset:1600
    ds_read_b128 v[88:91], v157 offset:1664
    ds_read_b128 v[92:95], v157 offset:1728
    ds_read_b32 v96, v156 offset:0
    ds_read_b32 v98, v156 offset:512
    ds_read_b32 v100, v156 offset:64
    ds_read_b32 v102, v156 offset:576
    ds_read_b32 v104, v156 offset:128
    ds_read_b32 v106, v156 offset:640
    ds_read_b32 v108, v156 offset:192
    ds_read_b32 v110, v156 offset:704
    s_waitcnt lgkmcnt(0)
    v_pk_mul_f32 v[112:113], v[80:81], v[106:107] op_sel_hi:[1,0]
    v_pk_mul_f32 v[114:115], v[82:83], v[106:107] op_sel_hi:[1,0]
    v_pk_mul_f32 v[116:117], v[84:85], v[106:107] op_sel_hi:[1,0]
    v_pk_mul_f32 v[118:119], v[86:87], v[106:107] op_sel_hi:[1,0]
    v_pk_mul_f32 v[120:121], v[88:89], v[106:107] op_sel_hi:[1,0]
    v_pk_mul_f32 v[122:123], v[90:91], v[106:107] op_sel_hi:[1,0]
    v_pk_mul_f32 v[124:125], v[92:93], v[106:107] op_sel_hi:[1,0]
    v_pk_mul_f32 v[126:127], v[94:95], v[106:107] op_sel_hi:[1,0]
    v_pk_fma_f32 v[48:49], v[48:49], v[104:105], v[112:113] op_sel_hi:[1,0,1]
    v_pk_fma_f32 v[50:51], v[50:51], v[104:105], v[114:115] op_sel_hi:[1,0,1]
    v_pk_fma_f32 v[52:53], v[52:53], v[104:105], v[116:117] op_sel_hi:[1,0,1]
    v_pk_fma_f32 v[54:55], v[54:55], v[104:105], v[118:119] op_sel_hi:[1,0,1]
    v_pk_fma_f32 v[56:57], v[56:57], v[104:105], v[120:121] op_sel_hi:[1,0,1]
    v_pk_fma_f32 v[58:59], v[58:59], v[104:105], v[122:123] op_sel_hi:[1,0,1]
    v_pk_fma_f32 v[60:61], v[60:61], v[104:105], v[124:125] op_sel_hi:[1,0,1]
    v_pk_fma_f32 v[62:63], v[62:63], v[104:105], v[126:127] op_sel_hi:[1,0,1]
    v_cvt_pk_bf16_f32 v48, v48, v49
    v_cvt_pk_bf16_f32 v49, v50, v51
    ds_write_b64 v152, v[48:49] offset:8192
    v_cvt_pk_bf16_f32 v52, v52, v53
    v_cvt_pk_bf16_f32 v53, v54, v55
    ds_write_b64 v153, v[52:53] offset:8192
    v_cvt_pk_bf16_f32 v56, v56, v57
    v_cvt_pk_bf16_f32 v57, v58, v59
    ds_write_b64 v154, v[56:57] offset:8192
    v_cvt_pk_bf16_f32 v60, v60, v61
    v_cvt_pk_bf16_f32 v61, v62, v63
    ds_write_b64 v155, v[60:61] offset:8192
    v_pk_mul_f32 v[112:113], v[80:81], v[110:111] op_sel_hi:[1,0]
    v_pk_mul_f32 v[114:115], v[82:83], v[110:111] op_sel_hi:[1,0]
    v_pk_mul_f32 v[116:117], v[84:85], v[110:111] op_sel_hi:[1,0]
    v_pk_mul_f32 v[118:119], v[86:87], v[110:111] op_sel_hi:[1,0]
    v_pk_mul_f32 v[120:121], v[88:89], v[110:111] op_sel_hi:[1,0]
    v_pk_mul_f32 v[122:123], v[90:91], v[110:111] op_sel_hi:[1,0]
    v_pk_mul_f32 v[124:125], v[92:93], v[110:111] op_sel_hi:[1,0]
    v_pk_mul_f32 v[126:127], v[94:95], v[110:111] op_sel_hi:[1,0]
    v_pk_fma_f32 v[64:65], v[64:65], v[108:109], v[112:113] op_sel_hi:[1,0,1]
    v_pk_fma_f32 v[66:67], v[66:67], v[108:109], v[114:115] op_sel_hi:[1,0,1]
    v_pk_fma_f32 v[68:69], v[68:69], v[108:109], v[116:117] op_sel_hi:[1,0,1]
    v_pk_fma_f32 v[70:71], v[70:71], v[108:109], v[118:119] op_sel_hi:[1,0,1]
    v_pk_fma_f32 v[72:73], v[72:73], v[108:109], v[120:121] op_sel_hi:[1,0,1]
    v_pk_fma_f32 v[74:75], v[74:75], v[108:109], v[122:123] op_sel_hi:[1,0,1]
    v_pk_fma_f32 v[76:77], v[76:77], v[108:109], v[124:125] op_sel_hi:[1,0,1]
    v_pk_fma_f32 v[78:79], v[78:79], v[108:109], v[126:127] op_sel_hi:[1,0,1]
    v_cvt_pk_bf16_f32 v64, v64, v65
    v_cvt_pk_bf16_f32 v65, v66, v67
    ds_write_b64 v152, v[64:65] offset:12288
    v_cvt_pk_bf16_f32 v68, v68, v69
    v_cvt_pk_bf16_f32 v69, v70, v71
    ds_write_b64 v153, v[68:69] offset:12288
    v_cvt_pk_bf16_f32 v72, v72, v73
    v_cvt_pk_bf16_f32 v73, v74, v75
    ds_write_b64 v154, v[72:73] offset:12288
    v_cvt_pk_bf16_f32 v76, v76, v77
    v_cvt_pk_bf16_f32 v77, v78, v79
    ds_write_b64 v155, v[76:77] offset:12288
    s_waitcnt lgkmcnt(0)
    s_barrier
    s_mov_b32 s52, 3222493025
    v_mov_b32 v128, s52
    s_mov_b32 s52, 3184710632
    v_mov_b32 v130, s52
    v_mov_b32 v132, 1.0
    s_mov_b32 s54, 0x3f803f80
    v_pk_mul_f32 v[112:113], v[80:81], v[98:99] op_sel_hi:[1,0]
    v_pk_mul_f32 v[114:115], v[82:83], v[98:99] op_sel_hi:[1,0]
    v_pk_mul_f32 v[116:117], v[84:85], v[98:99] op_sel_hi:[1,0]
    v_pk_mul_f32 v[118:119], v[86:87], v[98:99] op_sel_hi:[1,0]
    v_pk_mul_f32 v[120:121], v[88:89], v[98:99] op_sel_hi:[1,0]
    v_pk_mul_f32 v[122:123], v[90:91], v[98:99] op_sel_hi:[1,0]
    v_pk_mul_f32 v[124:125], v[92:93], v[98:99] op_sel_hi:[1,0]
    v_pk_mul_f32 v[126:127], v[94:95], v[98:99] op_sel_hi:[1,0]
    v_pk_fma_f32 v[16:17], v[16:17], v[96:97], v[112:113] op_sel_hi:[1,0,1]
    v_pk_fma_f32 v[18:19], v[18:19], v[96:97], v[114:115] op_sel_hi:[1,0,1]
    v_pk_fma_f32 v[20:21], v[20:21], v[96:97], v[116:117] op_sel_hi:[1,0,1]
    v_pk_fma_f32 v[22:23], v[22:23], v[96:97], v[118:119] op_sel_hi:[1,0,1]
    v_pk_fma_f32 v[24:25], v[24:25], v[96:97], v[120:121] op_sel_hi:[1,0,1]
    v_pk_fma_f32 v[26:27], v[26:27], v[96:97], v[122:123] op_sel_hi:[1,0,1]
    v_pk_fma_f32 v[28:29], v[28:29], v[96:97], v[124:125] op_sel_hi:[1,0,1]
    v_pk_fma_f32 v[30:31], v[30:31], v[96:97], v[126:127] op_sel_hi:[1,0,1]
    v_pk_mul_f32 v[112:113], v[16:17], v[16:17]
    v_pk_mul_f32 v[114:115], v[18:19], v[18:19]
    v_pk_mul_f32 v[116:117], v[20:21], v[20:21]
    v_pk_mul_f32 v[118:119], v[22:23], v[22:23]
    v_pk_mul_f32 v[120:121], v[24:25], v[24:25]
    v_pk_mul_f32 v[122:123], v[26:27], v[26:27]
    v_pk_mul_f32 v[124:125], v[28:29], v[28:29]
    v_pk_mul_f32 v[126:127], v[30:31], v[30:31]
    v_pk_fma_f32 v[112:113], v[112:113], v[130:131], v[128:129] op_sel_hi:[1,0,0]
    v_pk_fma_f32 v[114:115], v[114:115], v[130:131], v[128:129] op_sel_hi:[1,0,0]
    v_pk_fma_f32 v[116:117], v[116:117], v[130:131], v[128:129] op_sel_hi:[1,0,0]
    v_pk_fma_f32 v[118:119], v[118:119], v[130:131], v[128:129] op_sel_hi:[1,0,0]
    v_pk_fma_f32 v[120:121], v[120:121], v[130:131], v[128:129] op_sel_hi:[1,0,0]
    v_pk_fma_f32 v[122:123], v[122:123], v[130:131], v[128:129] op_sel_hi:[1,0,0]
    v_pk_fma_f32 v[124:125], v[124:125], v[130:131], v[128:129] op_sel_hi:[1,0,0]
    v_pk_fma_f32 v[126:127], v[126:127], v[130:131], v[128:129] op_sel_hi:[1,0,0]
    v_pk_mul_f32 v[112:113], v[112:113], v[16:17]
    v_pk_mul_f32 v[114:115], v[114:115], v[18:19]
    v_pk_mul_f32 v[116:117], v[116:117], v[20:21]
    v_pk_mul_f32 v[118:119], v[118:119], v[22:23]
    v_pk_mul_f32 v[120:121], v[120:121], v[24:25]
    v_pk_mul_f32 v[122:123], v[122:123], v[26:27]
    v_pk_mul_f32 v[124:125], v[124:125], v[28:29]
    v_pk_mul_f32 v[126:127], v[126:127], v[30:31]
    v_exp_f32 v112, v112
    v_exp_f32 v113, v113
    v_exp_f32 v114, v114
    v_exp_f32 v115, v115
    v_exp_f32 v116, v116
    v_exp_f32 v117, v117
    v_exp_f32 v118, v118
    v_exp_f32 v119, v119
    v_exp_f32 v120, v120
    v_exp_f32 v121, v121
    v_exp_f32 v122, v122
    v_exp_f32 v123, v123
    v_exp_f32 v124, v124
    v_exp_f32 v125, v125
    v_exp_f32 v126, v126
    v_exp_f32 v127, v127
    v_pk_add_f32 v[112:113], v[112:113], v[132:133] op_sel_hi:[1,0]
    v_pk_add_f32 v[114:115], v[114:115], v[132:133] op_sel_hi:[1,0]
    v_pk_add_f32 v[116:117], v[116:117], v[132:133] op_sel_hi:[1,0]
    v_pk_add_f32 v[118:119], v[118:119], v[132:133] op_sel_hi:[1,0]
    v_pk_add_f32 v[120:121], v[120:121], v[132:133] op_sel_hi:[1,0]
    v_pk_add_f32 v[122:123], v[122:123], v[132:133] op_sel_hi:[1,0]
    v_pk_add_f32 v[124:125], v[124:125], v[132:133] op_sel_hi:[1,0]
    v_pk_add_f32 v[126:127], v[126:127], v[132:133] op_sel_hi:[1,0]
    v_rcp_f32 v112, v112
    v_rcp_f32 v113, v113
    v_rcp_f32 v114, v114
    v_rcp_f32 v115, v115
    v_rcp_f32 v116, v116
    v_rcp_f32 v117, v117
    v_rcp_f32 v118, v118
    v_rcp_f32 v119, v119
    v_rcp_f32 v120, v120
    v_rcp_f32 v121, v121
    v_rcp_f32 v122, v122
    v_rcp_f32 v123, v123
    v_rcp_f32 v124, v124
    v_rcp_f32 v125, v125
    v_rcp_f32 v126, v126
    v_rcp_f32 v127, v127
    v_pk_mul_f32 v[16:17], v[16:17], v[112:113]
    v_pk_mul_f32 v[18:19], v[18:19], v[114:115]
    v_pk_mul_f32 v[20:21], v[20:21], v[116:117]
    v_pk_mul_f32 v[22:23], v[22:23], v[118:119]
    v_pk_mul_f32 v[24:25], v[24:25], v[120:121]
    v_pk_mul_f32 v[26:27], v[26:27], v[122:123]
    v_pk_mul_f32 v[28:29], v[28:29], v[124:125]
    v_pk_mul_f32 v[30:31], v[30:31], v[126:127]
    v_cvt_pk_bf16_f32 v16, v16, v17
    v_cvt_pk_bf16_f32 v17, v18, v19
    ds_write_b64 v152, v[16:17] offset:0
    v_cvt_pk_bf16_f32 v20, v20, v21
    v_cvt_pk_bf16_f32 v21, v22, v23
    ds_write_b64 v153, v[20:21] offset:0
    v_cvt_pk_bf16_f32 v24, v24, v25
    v_cvt_pk_bf16_f32 v25, v26, v27
    ds_write_b64 v154, v[24:25] offset:0
    v_cvt_pk_bf16_f32 v28, v28, v29
    v_cvt_pk_bf16_f32 v29, v30, v31
    ds_write_b64 v155, v[28:29] offset:0
    v_mov_b32 v134, 0
    v_mov_b32 v135, 0
    v_dot2c_f32_bf16 v134, s54, v16
    v_dot2c_f32_bf16 v135, v16, v16
    v_dot2c_f32_bf16 v134, s54, v17
    v_dot2c_f32_bf16 v135, v17, v17
    v_dot2c_f32_bf16 v134, s54, v20
    v_dot2c_f32_bf16 v135, v20, v20
    v_dot2c_f32_bf16 v134, s54, v21
    v_dot2c_f32_bf16 v135, v21, v21
    v_dot2c_f32_bf16 v134, s54, v24
    v_dot2c_f32_bf16 v135, v24, v24
    v_dot2c_f32_bf16 v134, s54, v25
    v_dot2c_f32_bf16 v135, v25, v25
    v_dot2c_f32_bf16 v134, s54, v28
    v_dot2c_f32_bf16 v135, v28, v28
    v_dot2c_f32_bf16 v134, s54, v29
    v_dot2c_f32_bf16 v135, v29, v29
    v_pk_mul_f32 v[112:113], v[80:81], v[102:103] op_sel_hi:[1,0]
    v_pk_mul_f32 v[114:115], v[82:83], v[102:103] op_sel_hi:[1,0]
    v_pk_mul_f32 v[116:117], v[84:85], v[102:103] op_sel_hi:[1,0]
    v_pk_mul_f32 v[118:119], v[86:87], v[102:103] op_sel_hi:[1,0]
    v_pk_mul_f32 v[120:121], v[88:89], v[102:103] op_sel_hi:[1,0]
    v_pk_mul_f32 v[122:123], v[90:91], v[102:103] op_sel_hi:[1,0]
    v_pk_mul_f32 v[124:125], v[92:93], v[102:103] op_sel_hi:[1,0]
    v_pk_mul_f32 v[126:127], v[94:95], v[102:103] op_sel_hi:[1,0]
    v_pk_fma_f32 v[32:33], v[32:33], v[100:101], v[112:113] op_sel_hi:[1,0,1]
    v_pk_fma_f32 v[34:35], v[34:35], v[100:101], v[114:115] op_sel_hi:[1,0,1]
    v_pk_fma_f32 v[36:37], v[36:37], v[100:101], v[116:117] op_sel_hi:[1,0,1]
    v_pk_fma_f32 v[38:39], v[38:39], v[100:101], v[118:119] op_sel_hi:[1,0,1]
    v_pk_fma_f32 v[40:41], v[40:41], v[100:101], v[120:121] op_sel_hi:[1,0,1]
    v_pk_fma_f32 v[42:43], v[42:43], v[100:101], v[122:123] op_sel_hi:[1,0,1]
    v_pk_fma_f32 v[44:45], v[44:45], v[100:101], v[124:125] op_sel_hi:[1,0,1]
    v_pk_fma_f32 v[46:47], v[46:47], v[100:101], v[126:127] op_sel_hi:[1,0,1]
    v_pk_mul_f32 v[112:113], v[32:33], v[32:33]
    v_pk_mul_f32 v[114:115], v[34:35], v[34:35]
    v_pk_mul_f32 v[116:117], v[36:37], v[36:37]
    v_pk_mul_f32 v[118:119], v[38:39], v[38:39]
    v_pk_mul_f32 v[120:121], v[40:41], v[40:41]
    v_pk_mul_f32 v[122:123], v[42:43], v[42:43]
    v_pk_mul_f32 v[124:125], v[44:45], v[44:45]
    v_pk_mul_f32 v[126:127], v[46:47], v[46:47]
    v_pk_fma_f32 v[112:113], v[112:113], v[130:131], v[128:129] op_sel_hi:[1,0,0]
    v_pk_fma_f32 v[114:115], v[114:115], v[130:131], v[128:129] op_sel_hi:[1,0,0]
    v_pk_fma_f32 v[116:117], v[116:117], v[130:131], v[128:129] op_sel_hi:[1,0,0]
    v_pk_fma_f32 v[118:119], v[118:119], v[130:131], v[128:129] op_sel_hi:[1,0,0]
    v_pk_fma_f32 v[120:121], v[120:121], v[130:131], v[128:129] op_sel_hi:[1,0,0]
    v_pk_fma_f32 v[122:123], v[122:123], v[130:131], v[128:129] op_sel_hi:[1,0,0]
    v_pk_fma_f32 v[124:125], v[124:125], v[130:131], v[128:129] op_sel_hi:[1,0,0]
    v_pk_fma_f32 v[126:127], v[126:127], v[130:131], v[128:129] op_sel_hi:[1,0,0]
    v_pk_mul_f32 v[112:113], v[112:113], v[32:33]
    v_pk_mul_f32 v[114:115], v[114:115], v[34:35]
    v_pk_mul_f32 v[116:117], v[116:117], v[36:37]
    v_pk_mul_f32 v[118:119], v[118:119], v[38:39]
    v_pk_mul_f32 v[120:121], v[120:121], v[40:41]
    v_pk_mul_f32 v[122:123], v[122:123], v[42:43]
    v_pk_mul_f32 v[124:125], v[124:125], v[44:45]
    v_pk_mul_f32 v[126:127], v[126:127], v[46:47]
    v_exp_f32 v112, v112
    v_exp_f32 v113, v113
    v_exp_f32 v114, v114
    v_exp_f32 v115, v115
    v_exp_f32 v116, v116
    v_exp_f32 v117, v117
    v_exp_f32 v118, v118
    v_exp_f32 v119, v119
    v_exp_f32 v120, v120
    v_exp_f32 v121, v121
    v_exp_f32 v122, v122
    v_exp_f32 v123, v123
    v_exp_f32 v124, v124
    v_exp_f32 v125, v125
    v_exp_f32 v126, v126
    v_exp_f32 v127, v127
    v_pk_add_f32 v[112:113], v[112:113], v[132:133] op_sel_hi:[1,0]
    v_pk_add_f32 v[114:115], v[114:115], v[132:133] op_sel_hi:[1,0]
    v_pk_add_f32 v[116:117], v[116:117], v[132:133] op_sel_hi:[1,0]
    v_pk_add_f32 v[118:119], v[118:119], v[132:133] op_sel_hi:[1,0]
    v_pk_add_f32 v[120:121], v[120:121], v[132:133] op_sel_hi:[1,0]
    v_pk_add_f32 v[122:123], v[122:123], v[132:133] op_sel_hi:[1,0]
    v_pk_add_f32 v[124:125], v[124:125], v[132:133] op_sel_hi:[1,0]
    v_pk_add_f32 v[126:127], v[126:127], v[132:133] op_sel_hi:[1,0]
    v_rcp_f32 v112, v112
    v_rcp_f32 v113, v113
    v_rcp_f32 v114, v114
    v_rcp_f32 v115, v115
    v_rcp_f32 v116, v116
    v_rcp_f32 v117, v117
    v_rcp_f32 v118, v118
    v_rcp_f32 v119, v119
    v_rcp_f32 v120, v120
    v_rcp_f32 v121, v121
    v_rcp_f32 v122, v122
    v_rcp_f32 v123, v123
    v_rcp_f32 v124, v124
    v_rcp_f32 v125, v125
    v_rcp_f32 v126, v126
    v_rcp_f32 v127, v127
    v_pk_mul_f32 v[32:33], v[32:33], v[112:113]
    v_pk_mul_f32 v[34:35], v[34:35], v[114:115]
    v_pk_mul_f32 v[36:37], v[36:37], v[116:117]
    v_pk_mul_f32 v[38:39], v[38:39], v[118:119]
    v_pk_mul_f32 v[40:41], v[40:41], v[120:121]
    v_pk_mul_f32 v[42:43], v[42:43], v[122:123]
    v_pk_mul_f32 v[44:45], v[44:45], v[124:125]
    v_pk_mul_f32 v[46:47], v[46:47], v[126:127]
    v_cvt_pk_bf16_f32 v32, v32, v33
    v_cvt_pk_bf16_f32 v33, v34, v35
    ds_write_b64 v152, v[32:33] offset:4096
    v_cvt_pk_bf16_f32 v36, v36, v37
    v_cvt_pk_bf16_f32 v37, v38, v39
    ds_write_b64 v153, v[36:37] offset:4096
    v_cvt_pk_bf16_f32 v40, v40, v41
    v_cvt_pk_bf16_f32 v41, v42, v43
    ds_write_b64 v154, v[40:41] offset:4096
    v_cvt_pk_bf16_f32 v44, v44, v45
    v_cvt_pk_bf16_f32 v45, v46, v47
    ds_write_b64 v155, v[44:45] offset:4096
    v_mov_b32 v136, 0
    v_mov_b32 v137, 0
    v_dot2c_f32_bf16 v136, s54, v32
    v_dot2c_f32_bf16 v137, v32, v32
    v_dot2c_f32_bf16 v136, s54, v33
    v_dot2c_f32_bf16 v137, v33, v33
    v_dot2c_f32_bf16 v136, s54, v36
    v_dot2c_f32_bf16 v137, v36, v36
    v_dot2c_f32_bf16 v136, s54, v37
    v_dot2c_f32_bf16 v137, v37, v37
    v_dot2c_f32_bf16 v136, s54, v40
    v_dot2c_f32_bf16 v137, v40, v40
    v_dot2c_f32_bf16 v136, s54, v41
    v_dot2c_f32_bf16 v137, v41, v41
    v_dot2c_f32_bf16 v136, s54, v44
    v_dot2c_f32_bf16 v137, v44, v44
    v_dot2c_f32_bf16 v136, s54, v45
    v_dot2c_f32_bf16 v137, v45, v45
    v_mov_b32 v112, v134
    v_mov_b32 v113, v135
    v_mov_b32 v114, v136
    v_mov_b32 v115, v137
    v_permlane32_swap_b32 v134, v112
    v_permlane32_swap_b32 v135, v113
    v_permlane32_swap_b32 v136, v114
    v_permlane32_swap_b32 v137, v115
    v_add_f32 v134, v134, v112
    v_add_f32 v135, v135, v113
    v_add_f32 v136, v136, v114
    v_add_f32 v137, v137, v115
    v_mov_b32 v112, v134
    v_mov_b32 v113, v135
    v_mov_b32 v114, v136
    v_mov_b32 v115, v137
    v_permlane16_swap_b32 v134, v112
    v_permlane16_swap_b32 v135, v113
    v_permlane16_swap_b32 v136, v114
    v_permlane16_swap_b32 v137, v115
    v_add_f32 v134, v134, v112
    v_add_f32 v135, v135, v113
    v_add_f32 v136, v136, v114
    v_add_f32 v137, v137, v115
    v_lshlrev_b32 v12, 2, v156
    s_lshr_b32 s51, s30, 1
    s_lshl_b32 s51, s51, 3
    v_add_u32 v12, s51, v12
    s_mov_b64 s[54:55], exec
    s_mov_b64 exec, 0xffff
    ds_write_b64 v12, v[134:135] offset:4096
    ds_write_b64 v12, v[136:137] offset:4352
    s_mov_b64 exec, s[54:55]
    s_mov_b32 s64, 0
    s_barrier
    v_mfma_f32_16x16x32_bf16 v[16:19], a[16:19], a[0:3], 0
    ds_read_b128 v[80:83], v8 offset:0
    s_add_u32 s65, s65, 1
    v_mfma_f32_16x16x32_bf16 v[32:35], a[16:19], a[4:7], 0
    ds_read_b64_tr_b16 v[96:97], v144 offset:0
    s_cmp_eq_u32 s65, 3
    v_mfma_f32_16x16x32_bf16 v[48:51], a[16:19], a[8:11], 0
    ds_read_b64_tr_b16 v[98:99], v144 offset:512
    s_mov_b32 s66, 16384
    v_mfma_f32_16x16x32_bf16 v[64:67], a[16:19], a[12:15], 0
    ds_read_b128 v[84:87], v8 offset:2048
    s_cselect_b32 s66, 4294934528, s66
    v_mfma_f32_16x16x32_bf16 v[20:23], a[20:23], a[0:3], 0
    ds_read_b128 v[88:91], v8 offset:4096
    s_cselect_b32 s65, 0, s65
    v_mfma_f32_16x16x32_bf16 v[36:39], a[20:23], a[4:7], 0
    ds_read_b128 v[92:95], v8 offset:6144
    s_add_u32 s67, s67, 1
    v_mfma_f32_16x16x32_bf16 v[52:55], a[20:23], a[8:11], 0
    ds_read_b64_tr_b16 v[100:101], v145 offset:0
    s_cmp_eq_u32 s67, 4
    v_mfma_f32_16x16x32_bf16 v[68:71], a[20:23], a[12:15], 0
    ds_read_b64_tr_b16 v[102:103], v145 offset:512
    s_mov_b32 s62, 16384
    v_mfma_f32_16x16x32_bf16 v[24:27], a[24:27], a[0:3], 0
    ds_read_b64_tr_b16 v[104:105], v146 offset:0
    s_cselect_b32 s62, 4294918144, s62
    v_mfma_f32_16x16x32_bf16 v[40:43], a[24:27], a[4:7], 0
    ds_read_b64_tr_b16 v[106:107], v146 offset:512
    s_cselect_b32 s67, 0, s67
    v_mfma_f32_16x16x32_bf16 v[56:59], a[24:27], a[8:11], 0
    ds_read_b64_tr_b16 v[108:109], v147 offset:0
    v_mfma_f32_16x16x32_bf16 v[72:75], a[24:27], a[12:15], 0
    ds_read_b64_tr_b16 v[110:111], v147 offset:512
    v_mfma_f32_16x16x32_bf16 v[28:31], a[28:31], a[0:3], 0
    ds_read_b128 v[112:115], v9 offset:0
    v_mfma_f32_16x16x32_bf16 v[44:47], a[28:31], a[4:7], 0
    ds_read_b64_tr_b16 v[128:129], v144 offset:4096
    v_mfma_f32_16x16x32_bf16 v[60:63], a[28:31], a[8:11], 0
    ds_read_b64_tr_b16 v[130:131], v144 offset:4608
    v_mfma_f32_16x16x32_bf16 v[76:79], a[28:31], a[12:15], 0
    ds_read_b128 v[116:119], v9 offset:2048
    v_mfma_f32_16x16x32_bf16 v[16:19], a[48:51], a[32:35], v[16:19]
    ds_read_b128 v[120:123], v9 offset:4096
    v_mfma_f32_16x16x32_bf16 v[32:35], a[48:51], a[36:39], v[32:35]
    ds_read_b128 v[124:127], v9 offset:6144
    v_mfma_f32_16x16x32_bf16 v[48:51], a[48:51], a[40:43], v[48:51]
    ds_read_b64_tr_b16 v[132:133], v145 offset:4096
    v_mfma_f32_16x16x32_bf16 v[64:67], a[48:51], a[44:47], v[64:67]
    ds_read_b64_tr_b16 v[134:135], v145 offset:4608
    v_mfma_f32_16x16x32_bf16 v[20:23], a[52:55], a[32:35], v[20:23]
    ds_read_b64_tr_b16 v[136:137], v146 offset:4096
    v_mfma_f32_16x16x32_bf16 v[36:39], a[52:55], a[36:39], v[36:39]
    ds_read_b64_tr_b16 v[138:139], v146 offset:4608
    v_mfma_f32_16x16x32_bf16 v[52:55], a[52:55], a[40:43], v[52:55]
    ds_read_b64_tr_b16 v[140:141], v147 offset:4096
    v_mfma_f32_16x16x32_bf16 v[68:71], a[52:55], a[44:47], v[68:71]
    ds_read_b64_tr_b16 v[142:143], v147 offset:4608
    v_add_u32 v8, s66, v8
    v_mfma_f32_16x16x32_bf16 v[24:27], a[56:59], a[32:35], v[24:27]
    v_add_u32 v9, s66, v9
    v_add_u32 v144, s62, v144
    v_mfma_f32_16x16x32_bf16 v[40:43], a[56:59], a[36:39], v[40:43]
    v_add_u32 v145, s62, v145
    v_add_u32 v146, s62, v146
    v_mfma_f32_16x16x32_bf16 v[56:59], a[56:59], a[40:43], v[56:59]
    v_add_u32 v147, s62, v147
    v_mfma_f32_16x16x32_bf16 v[72:75], a[56:59], a[44:47], v[72:75]
    v_mfma_f32_16x16x32_bf16 v[28:31], a[60:63], a[32:35], v[28:31]
    v_mfma_f32_16x16x32_bf16 v[44:47], a[60:63], a[36:39], v[44:47]
    v_mfma_f32_16x16x32_bf16 v[60:63], a[60:63], a[40:43], v[60:63]
    v_mfma_f32_16x16x32_bf16 v[76:79], a[60:63], a[44:47], v[76:79]
    s_waitcnt lgkmcnt(0)
    s_barrier
    v_mfma_f32_16x16x32_bf16 v[16:19], v[96:99], v[80:83], v[16:19]
    ds_read_b128 a[0:3], v8 offset:0
    s_add_u32 s65, s65, 1
    v_mfma_f32_16x16x32_bf16 v[32:35], v[96:99], v[84:87], v[32:35]
    ds_read_b64_tr_b16 a[16:17], v144 offset:0
    s_cmp_eq_u32 s65, 3
    v_mfma_f32_16x16x32_bf16 v[48:51], v[96:99], v[88:91], v[48:51]
    ds_read_b64_tr_b16 a[18:19], v144 offset:512
    s_mov_b32 s66, 16384
    v_mfma_f32_16x16x32_bf16 v[64:67], v[96:99], v[92:95], v[64:67]
    ds_read_b128 a[4:7], v8 offset:2048
    s_cselect_b32 s66, 4294934528, s66
    v_mfma_f32_16x16x32_bf16 v[20:23], v[100:103], v[80:83], v[20:23]
    ds_read_b128 a[8:11], v8 offset:4096
    s_cselect_b32 s65, 0, s65
    v_mfma_f32_16x16x32_bf16 v[36:39], v[100:103], v[84:87], v[36:39]
    ds_read_b128 a[12:15], v8 offset:6144
    s_add_u32 s67, s67, 1
    v_mfma_f32_16x16x32_bf16 v[52:55], v[100:103], v[88:91], v[52:55]
    ds_read_b64_tr_b16 a[20:21], v145 offset:0
    s_cmp_eq_u32 s67, 4
    v_mfma_f32_16x16x32_bf16 v[68:71], v[100:103], v[92:95], v[68:71]
    ds_read_b64_tr_b16 a[22:23], v145 offset:512
    s_mov_b32 s62, 16384
    v_mfma_f32_16x16x32_bf16 v[24:27], v[104:107], v[80:83], v[24:27]
    ds_read_b64_tr_b16 a[24:25], v146 offset:0
    s_cselect_b32 s62, 4294918144, s62
    v_mfma_f32_16x16x32_bf16 v[40:43], v[104:107], v[84:87], v[40:43]
    ds_read_b64_tr_b16 a[26:27], v146 offset:512
    s_cselect_b32 s67, 0, s67
    v_mfma_f32_16x16x32_bf16 v[56:59], v[104:107], v[88:91], v[56:59]
    ds_read_b64_tr_b16 a[28:29], v147 offset:0
    v_mfma_f32_16x16x32_bf16 v[72:75], v[104:107], v[92:95], v[72:75]
    ds_read_b64_tr_b16 a[30:31], v147 offset:512
    v_mfma_f32_16x16x32_bf16 v[28:31], v[108:111], v[80:83], v[28:31]
    ds_read_b128 a[32:35], v9 offset:0
    v_mfma_f32_16x16x32_bf16 v[44:47], v[108:111], v[84:87], v[44:47]
    ds_read_b64_tr_b16 a[48:49], v144 offset:4096
    v_mfma_f32_16x16x32_bf16 v[60:63], v[108:111], v[88:91], v[60:63]
    ds_read_b64_tr_b16 a[50:51], v144 offset:4608
    v_mfma_f32_16x16x32_bf16 v[76:79], v[108:111], v[92:95], v[76:79]
    ds_read_b128 a[36:39], v9 offset:2048
    v_mfma_f32_16x16x32_bf16 v[16:19], v[128:131], v[112:115], v[16:19]
    ds_read_b128 a[40:43], v9 offset:4096
    v_mfma_f32_16x16x32_bf16 v[32:35], v[128:131], v[116:119], v[32:35]
    ds_read_b128 a[44:47], v9 offset:6144
    v_mfma_f32_16x16x32_bf16 v[48:51], v[128:131], v[120:123], v[48:51]
    ds_read_b64_tr_b16 a[52:53], v145 offset:4096
    v_mfma_f32_16x16x32_bf16 v[64:67], v[128:131], v[124:127], v[64:67]
    ds_read_b64_tr_b16 a[54:55], v145 offset:4608
    v_mfma_f32_16x16x32_bf16 v[20:23], v[132:135], v[112:115], v[20:23]
    ds_read_b64_tr_b16 a[56:57], v146 offset:4096
    v_mfma_f32_16x16x32_bf16 v[36:39], v[132:135], v[116:119], v[36:39]
    ds_read_b64_tr_b16 a[58:59], v146 offset:4608
    v_mfma_f32_16x16x32_bf16 v[52:55], v[132:135], v[120:123], v[52:55]
    ds_read_b64_tr_b16 a[60:61], v147 offset:4096
    v_mfma_f32_16x16x32_bf16 v[68:71], v[132:135], v[124:127], v[68:71]
    ds_read_b64_tr_b16 a[62:63], v147 offset:4608
    v_add_u32 v8, s66, v8
    v_mfma_f32_16x16x32_bf16 v[24:27], v[136:139], v[112:115], v[24:27]
    v_add_u32 v9, s66, v9
    v_add_u32 v144, s62, v144
    v_mfma_f32_16x16x32_bf16 v[40:43], v[136:139], v[116:119], v[40:43]
    v_add_u32 v145, s62, v145
    v_add_u32 v146, s62, v146
    v_mfma_f32_16x16x32_bf16 v[56:59], v[136:139], v[120:123], v[56:59]
    v_add_u32 v147, s62, v147
    v_mfma_f32_16x16x32_bf16 v[72:75], v[136:139], v[124:127], v[72:75]
    v_mfma_f32_16x16x32_bf16 v[28:31], v[140:143], v[112:115], v[28:31]
    v_mfma_f32_16x16x32_bf16 v[44:47], v[140:143], v[116:119], v[44:47]
    v_mfma_f32_16x16x32_bf16 v[60:63], v[140:143], v[120:123], v[60:63]
    v_mfma_f32_16x16x32_bf16 v[76:79], v[140:143], v[124:127], v[76:79]
    s_waitcnt lgkmcnt(0)
g3b_loop:
    s_barrier
    v_mfma_f32_16x16x32_bf16 v[16:19], a[16:19], a[0:3], v[16:19]
    ds_read_b128 v[80:83], v8 offset:0
    s_add_u32 s65, s65, 1
    v_mfma_f32_16x16x32_bf16 v[32:35], a[16:19], a[4:7], v[32:35]
    ds_read_b64_tr_b16 v[96:97], v144 offset:0
    s_cmp_eq_u32 s65, 3
    v_mfma_f32_16x16x32_bf16 v[48:51], a[16:19], a[8:11], v[48:51]
    ds_read_b64_tr_b16 v[98:99], v144 offset:512
    s_mov_b32 s66, 16384
    v_mfma_f32_16x16x32_bf16 v[64:67], a[16:19], a[12:15], v[64:67]
    ds_read_b128 v[84:87], v8 offset:2048
    s_cselect_b32 s66, 4294934528, s66
    v_mfma_f32_16x16x32_bf16 v[20:23], a[20:23], a[0:3], v[20:23]
    ds_read_b128 v[88:91], v8 offset:4096
    s_cselect_b32 s65, 0, s65
    v_mfma_f32_16x16x32_bf16 v[36:39], a[20:23], a[4:7], v[36:39]
    ds_read_b128 v[92:95], v8 offset:6144
    s_add_u32 s67, s67, 1
    v_mfma_f32_16x16x32_bf16 v[52:55], a[20:23], a[8:11], v[52:55]
    ds_read_b64_tr_b16 v[100:101], v145 offset:0
    s_cmp_eq_u32 s67, 4
    v_mfma_f32_16x16x32_bf16 v[68:71], a[20:23], a[12:15], v[68:71]
    ds_read_b64_tr_b16 v[102:103], v145 offset:512
    s_mov_b32 s62, 16384
    v_mfma_f32_16x16x32_bf16 v[24:27], a[24:27], a[0:3], v[24:27]
    ds_read_b64_tr_b16 v[104:105], v146 offset:0
    s_cselect_b32 s62, 4294918144, s62
    v_mfma_f32_16x16x32_bf16 v[40:43], a[24:27], a[4:7], v[40:43]
    ds_read_b64_tr_b16 v[106:107], v146 offset:512
    s_cselect_b32 s67, 0, s67
    v_mfma_f32_16x16x32_bf16 v[56:59], a[24:27], a[8:11], v[56:59]
    ds_read_b64_tr_b16 v[108:109], v147 offset:0
    s_add_u32 s64, s64, 2
    v_mfma_f32_16x16x32_bf16 v[72:75], a[24:27], a[12:15], v[72:75]
    ds_read_b64_tr_b16 v[110:111], v147 offset:512
    v_mfma_f32_16x16x32_bf16 v[28:31], a[28:31], a[0:3], v[28:31]
    ds_read_b128 v[112:115], v9 offset:0
    v_mfma_f32_16x16x32_bf16 v[44:47], a[28:31], a[4:7], v[44:47]
    ds_read_b64_tr_b16 v[128:129], v144 offset:4096
    v_mfma_f32_16x16x32_bf16 v[60:63], a[28:31], a[8:11], v[60:63]
    ds_read_b64_tr_b16 v[130:131], v144 offset:4608
    v_mfma_f32_16x16x32_bf16 v[76:79], a[28:31], a[12:15], v[76:79]
    ds_read_b128 v[116:119], v9 offset:2048
    v_mfma_f32_16x16x32_bf16 v[16:19], a[48:51], a[32:35], v[16:19]
    ds_read_b128 v[120:123], v9 offset:4096
    v_mfma_f32_16x16x32_bf16 v[32:35], a[48:51], a[36:39], v[32:35]
    ds_read_b128 v[124:127], v9 offset:6144
    v_mfma_f32_16x16x32_bf16 v[48:51], a[48:51], a[40:43], v[48:51]
    ds_read_b64_tr_b16 v[132:133], v145 offset:4096
    v_mfma_f32_16x16x32_bf16 v[64:67], a[48:51], a[44:47], v[64:67]
    ds_read_b64_tr_b16 v[134:135], v145 offset:4608
    v_mfma_f32_16x16x32_bf16 v[20:23], a[52:55], a[32:35], v[20:23]
    ds_read_b64_tr_b16 v[136:137], v146 offset:4096
    v_mfma_f32_16x16x32_bf16 v[36:39], a[52:55], a[36:39], v[36:39]
    ds_read_b64_tr_b16 v[138:139], v146 offset:4608
    v_mfma_f32_16x16x32_bf16 v[52:55], a[52:55], a[40:43], v[52:55]
    ds_read_b64_tr_b16 v[140:141], v147 offset:4096
    v_mfma_f32_16x16x32_bf16 v[68:71], a[52:55], a[44:47], v[68:71]
    ds_read_b64_tr_b16 v[142:143], v147 offset:4608
    v_add_u32 v8, s66, v8
    v_mfma_f32_16x16x32_bf16 v[24:27], a[56:59], a[32:35], v[24:27]
    v_add_u32 v9, s66, v9
    v_add_u32 v144, s62, v144
    v_mfma_f32_16x16x32_bf16 v[40:43], a[56:59], a[36:39], v[40:43]
    v_add_u32 v145, s62, v145
    v_add_u32 v146, s62, v146
    v_mfma_f32_16x16x32_bf16 v[56:59], a[56:59], a[40:43], v[56:59]
    v_add_u32 v147, s62, v147
    v_mfma_f32_16x16x32_bf16 v[72:75], a[56:59], a[44:47], v[72:75]
    v_mfma_f32_16x16x32_bf16 v[28:31], a[60:63], a[32:35], v[28:31]
    v_mfma_f32_16x16x32_bf16 v[44:47], a[60:63], a[36:39], v[44:47]
    v_mfma_f32_16x16x32_bf16 v[60:63], a[60:63], a[40:43], v[60:63]
    v_mfma_f32_16x16x32_bf16 v[76:79], a[60:63], a[44:47], v[76:79]
    s_waitcnt lgkmcnt(0)
    s_barrier
    v_mfma_f32_16x16x32_bf16 v[16:19], v[96:99], v[80:83], v[16:19]
    ds_read_b128 a[0:3], v8 offset:0
    s_add_u32 s65, s65, 1
    v_mfma_f32_16x16x32_bf16 v[32:35], v[96:99], v[84:87], v[32:35]
    ds_read_b64_tr_b16 a[16:17], v144 offset:0
    s_cmp_eq_u32 s65, 3
    v_mfma_f32_16x16x32_bf16 v[48:51], v[96:99], v[88:91], v[48:51]
    ds_read_b64_tr_b16 a[18:19], v144 offset:512
    s_mov_b32 s66, 16384
    v_mfma_f32_16x16x32_bf16 v[64:67], v[96:99], v[92:95], v[64:67]
    ds_read_b128 a[4:7], v8 offset:2048
    s_cselect_b32 s66, 4294934528, s66
    v_mfma_f32_16x16x32_bf16 v[20:23], v[100:103], v[80:83], v[20:23]
    ds_read_b128 a[8:11], v8 offset:4096
    s_cselect_b32 s65, 0, s65
    v_mfma_f32_16x16x32_bf16 v[36:39], v[100:103], v[84:87], v[36:39]
    ds_read_b128 a[12:15], v8 offset:6144
    s_add_u32 s67, s67, 1
    v_mfma_f32_16x16x32_bf16 v[52:55], v[100:103], v[88:91], v[52:55]
    ds_read_b64_tr_b16 a[20:21], v145 offset:0
    s_cmp_eq_u32 s67, 4
    v_mfma_f32_16x16x32_bf16 v[68:71], v[100:103], v[92:95], v[68:71]
    ds_read_b64_tr_b16 a[22:23], v145 offset:512
    s_mov_b32 s62, 16384
    v_mfma_f32_16x16x32_bf16 v[24:27], v[104:107], v[80:83], v[24:27]
    ds_read_b64_tr_b16 a[24:25], v146 offset:0
    s_cselect_b32 s62, 4294918144, s62
    v_mfma_f32_16x16x32_bf16 v[40:43], v[104:107], v[84:87], v[40:43]
    ds_read_b64_tr_b16 a[26:27], v146 offset:512
    s_cselect_b32 s67, 0, s67
    v_mfma_f32_16x16x32_bf16 v[56:59], v[104:107], v[88:91], v[56:59]
    ds_read_b64_tr_b16 a[28:29], v147 offset:0
    v_mfma_f32_16x16x32_bf16 v[72:75], v[104:107], v[92:95], v[72:75]
    ds_read_b64_tr_b16 a[30:31], v147 offset:512
    v_mfma_f32_16x16x32_bf16 v[28:31], v[108:111], v[80:83], v[28:31]
    ds_read_b128 a[32:35], v9 offset:0
    v_mfma_f32_16x16x32_bf16 v[44:47], v[108:111], v[84:87], v[44:47]
    ds_read_b64_tr_b16 a[48:49], v144 offset:4096
    v_mfma_f32_16x16x32_bf16 v[60:63], v[108:111], v[88:91], v[60:63]
    ds_read_b64_tr_b16 a[50:51], v144 offset:4608
    v_mfma_f32_16x16x32_bf16 v[76:79], v[108:111], v[92:95], v[76:79]
    ds_read_b128 a[36:39], v9 offset:2048
    v_mfma_f32_16x16x32_bf16 v[16:19], v[128:131], v[112:115], v[16:19]
    ds_read_b128 a[40:43], v9 offset:4096
    v_mfma_f32_16x16x32_bf16 v[32:35], v[128:131], v[116:119], v[32:35]
    ds_read_b128 a[44:47], v9 offset:6144
    v_mfma_f32_16x16x32_bf16 v[48:51], v[128:131], v[120:123], v[48:51]
    ds_read_b64_tr_b16 a[52:53], v145 offset:4096
    v_mfma_f32_16x16x32_bf16 v[64:67], v[128:131], v[124:127], v[64:67]
    ds_read_b64_tr_b16 a[54:55], v145 offset:4608
    v_mfma_f32_16x16x32_bf16 v[20:23], v[132:135], v[112:115], v[20:23]
    ds_read_b64_tr_b16 a[56:57], v146 offset:4096
    v_mfma_f32_16x16x32_bf16 v[36:39], v[132:135], v[116:119], v[36:39]
    ds_read_b64_tr_b16 a[58:59], v146 offset:4608
    v_mfma_f32_16x16x32_bf16 v[52:55], v[132:135], v[120:123], v[52:55]
    ds_read_b64_tr_b16 a[60:61], v147 offset:4096
    v_mfma_f32_16x16x32_bf16 v[68:71], v[132:135], v[124:127], v[68:71]
    ds_read_b64_tr_b16 a[62:63], v147 offset:4608
    v_add_u32 v8, s66, v8
    v_mfma_f32_16x16x32_bf16 v[24:27], v[136:139], v[112:115], v[24:27]
    v_add_u32 v9, s66, v9
    v_add_u32 v144, s62, v144
    v_mfma_f32_16x16x32_bf16 v[40:43], v[136:139], v[116:119], v[40:43]
    v_add_u32 v145, s62, v145
    v_add_u32 v146, s62, v146
    v_mfma_f32_16x16x32_bf16 v[56:59], v[136:139], v[120:123], v[56:59]
    v_add_u32 v147, s62, v147
    v_mfma_f32_16x16x32_bf16 v[72:75], v[136:139], v[124:127], v[72:75]
    v_mfma_f32_16x16x32_bf16 v[28:31], v[140:143], v[112:115], v[28:31]
    v_mfma_f32_16x16x32_bf16 v[44:47], v[140:143], v[116:119], v[44:47]
    v_mfma_f32_16x16x32_bf16 v[60:63], v[140:143], v[120:123], v[60:63]
    v_mfma_f32_16x16x32_bf16 v[76:79], v[140:143], v[124:127], v[76:79]
    s_cmp_lt_u32 s64, 14
    s_waitcnt lgkmcnt(0)
    s_cbranch_scc1 g3b_loop
    ds_read_b128 v[80:83], v157 offset:1024
    ds_read_b128 v[84:87], v157 offset:1088
    ds_read_b128 v[88:91], v157 offset:1152
    ds_read_b128 v[92:95], v157 offset:1216
    ds_read_b32 v96, v156 offset:0
    ds_read_b32 v98, v156 offset:512
    ds_read_b32 v100, v156 offset:64
    ds_read_b32 v102, v156 offset:576
    ds_read_b32 v104, v156 offset:128
    ds_read_b32 v106, v156 offset:640
    ds_read_b32 v108, v156 offset:192
    ds_read_b32 v110, v156 offset:704
    s_waitcnt lgkmcnt(0)
    v_pk_mul_f32 v[112:113], v[80:81], v[98:99] op_sel_hi:[1,0]
    v_pk_mul_f32 v[114:115], v[82:83], v[98:99] op_sel_hi:[1,0]
    v_pk_mul_f32 v[116:117], v[84:85], v[98:99] op_sel_hi:[1,0]
    v_pk_mul_f32 v[118:119], v[86:87], v[98:99] op_sel_hi:[1,0]
    v_pk_mul_f32 v[120:121], v[88:89], v[98:99] op_sel_hi:[1,0]
    v_pk_mul_f32 v[122:123], v[90:91], v[98:99] op_sel_hi:[1,0]
    v_pk_mul_f32 v[124:125], v[92:93], v[98:99] op_sel_hi:[1,0]
    v_pk_mul_f32 v[126:127], v[94:95], v[98:99] op_sel_hi:[1,0]
    v_pk_fma_f32 v[16:17], v[16:17], v[96:97], v[112:113] op_sel_hi:[1,0,1]
    v_pk_fma_f32 v[18:19], v[18:19], v[96:97], v[114:115] op_sel_hi:[1,0,1]
    v_pk_fma_f32 v[20:21], v[20:21], v[96:97], v[116:117] op_sel_hi:[1,0,1]
    v_pk_fma_f32 v[22:23], v[22:23], v[96:97], v[118:119] op_sel_hi:[1,0,1]
    v_pk_fma_f32 v[24:25], v[24:25], v[96:97], v[120:121] op_sel_hi:[1,0,1]
    v_pk_fma_f32 v[26:27], v[26:27], v[96:97], v[122:123] op_sel_hi:[1,0,1]
    v_pk_fma_f32 v[28:29], v[28:29], v[96:97], v[124:125] op_sel_hi:[1,0,1]
    v_pk_fma_f32 v[30:31], v[30:31], v[96:97], v[126:127] op_sel_hi:[1,0,1]
    v_cvt_pk_bf16_f32 v16, v16, v17
    v_cvt_pk_bf16_f32 v17, v18, v19
    ds_write_b64 v152, v[16:17] offset:0
    v_cvt_pk_bf16_f32 v20, v20, v21
    v_cvt_pk_bf16_f32 v21, v22, v23
    ds_write_b64 v153, v[20:21] offset:0
    v_cvt_pk_bf16_f32 v24, v24, v25
    v_cvt_pk_bf16_f32 v25, v26, v27
    ds_write_b64 v154, v[24:25] offset:0
    v_cvt_pk_bf16_f32 v28, v28, v29
    v_cvt_pk_bf16_f32 v29, v30, v31
    ds_write_b64 v155, v[28:29] offset:0
    v_pk_mul_f32 v[112:113], v[80:81], v[102:103] op_sel_hi:[1,0]
    v_pk_mul_f32 v[114:115], v[82:83], v[102:103] op_sel_hi:[1,0]
    v_pk_mul_f32 v[116:117], v[84:85], v[102:103] op_sel_hi:[1,0]
    v_pk_mul_f32 v[118:119], v[86:87], v[102:103] op_sel_hi:[1,0]
    v_pk_mul_f32 v[120:121], v[88:89], v[102:103] op_sel_hi:[1,0]
    v_pk_mul_f32 v[122:123], v[90:91], v[102:103] op_sel_hi:[1,0]
    v_pk_mul_f32 v[124:125], v[92:93], v[102:103] op_sel_hi:[1,0]
    v_pk_mul_f32 v[126:127], v[94:95], v[102:103] op_sel_hi:[1,0]
    v_pk_fma_f32 v[32:33], v[32:33], v[100:101], v[112:113] op_sel_hi:[1,0,1]
    v_pk_fma_f32 v[34:35], v[34:35], v[100:101], v[114:115] op_sel_hi:[1,0,1]
    v_pk_fma_f32 v[36:37], v[36:37], v[100:101], v[116:117] op_sel_hi:[1,0,1]
    v_pk_fma_f32 v[38:39], v[38:39], v[100:101], v[118:119] op_sel_hi:[1,0,1]
    v_pk_fma_f32 v[40:41], v[40:41], v[100:101], v[120:121] op_sel_hi:[1,0,1]
    v_pk_fma_f32 v[42:43], v[42:43], v[100:101], v[122:123] op_sel_hi:[1,0,1]
    v_pk_fma_f32 v[44:45], v[44:45], v[100:101], v[124:125] op_sel_hi:[1,0,1]
    v_pk_fma_f32 v[46:47], v[46:47], v[100:101], v[126:127] op_sel_hi:[1,0,1]
    v_cvt_pk_bf16_f32 v32, v32, v33
    v_cvt_pk_bf16_f32 v33, v34, v35
    ds_write_b64 v152, v[32:33] offset:4096
    v_cvt_pk_bf16_f32 v36, v36, v37
    v_cvt_pk_bf16_f32 v37, v38, v39
    ds_write_b64 v153, v[36:37] offset:4096
    v_cvt_pk_bf16_f32 v40, v40, v41
    v_cvt_pk_bf16_f32 v41, v42, v43
    ds_write_b64 v154, v[40:41] offset:4096
    v_cvt_pk_bf16_f32 v44, v44, v45
    v_cvt_pk_bf16_f32 v45, v46, v47
    ds_write_b64 v155, v[44:45] offset:4096
    v_pk_mul_f32 v[112:113], v[80:81], v[106:107] op_sel_hi:[1,0]
    v_pk_mul_f32 v[114:115], v[82:83], v[106:107] op_sel_hi:[1,0]
    v_pk_mul_f32 v[116:117], v[84:85], v[106:107] op_sel_hi:[1,0]
    v_pk_mul_f32 v[118:119], v[86:87], v[106:107] op_sel_hi:[1,0]
    v_pk_mul_f32 v[120:121], v[88:89], v[106:107] op_sel_hi:[1,0]
    v_pk_mul_f32 v[122:123], v[90:91], v[106:107] op_sel_hi:[1,0]
    v_pk_mul_f32 v[124:125], v[92:93], v[106:107] op_sel_hi:[1,0]
    v_pk_mul_f32 v[126:127], v[94:95], v[106:107] op_sel_hi:[1,0]
    v_pk_fma_f32 v[48:49], v[48:49], v[104:105], v[112:113] op_sel_hi:[1,0,1]
    v_pk_fma_f32 v[50:51], v[50:51], v[104:105], v[114:115] op_sel_hi:[1,0,1]
    v_pk_fma_f32 v[52:53], v[52:53], v[104:105], v[116:117] op_sel_hi:[1,0,1]
    v_pk_fma_f32 v[54:55], v[54:55], v[104:105], v[118:119] op_sel_hi:[1,0,1]
    v_pk_fma_f32 v[56:57], v[56:57], v[104:105], v[120:121] op_sel_hi:[1,0,1]
    v_pk_fma_f32 v[58:59], v[58:59], v[104:105], v[122:123] op_sel_hi:[1,0,1]
    v_pk_fma_f32 v[60:61], v[60:61], v[104:105], v[124:125] op_sel_hi:[1,0,1]
    v_pk_fma_f32 v[62:63], v[62:63], v[104:105], v[126:127] op_sel_hi:[1,0,1]
    v_cvt_pk_bf16_f32 v48, v48, v49
    v_cvt_pk_bf16_f32 v49, v50, v51
    ds_write_b64 v152, v[48:49] offset:8192
    v_cvt_pk_bf16_f32 v52, v52, v53
    v_cvt_pk_bf16_f32 v53, v54, v55
    ds_write_b64 v153, v[52:53] offset:8192
    v_cvt_pk_bf16_f32 v56, v56, v57
    v_cvt_pk_bf16_f32 v57, v58, v59
    ds_write_b64 v154, v[56:57] offset:8192
    v_cvt_pk_bf16_f32 v60, v60, v61
    v_cvt_pk_bf16_f32 v61, v62, v63
    ds_write_b64 v155, v[60:61] offset:8192
    v_pk_mul_f32 v[112:113], v[80:81], v[110:111] op_sel_hi:[1,0]
    v_pk_mul_f32 v[114:115], v[82:83], v[110:111] op_sel_hi:[1,0]
    v_pk_mul_f32 v[116:117], v[84:85], v[110:111] op_sel_hi:[1,0]
    v_pk_mul_f32 v[118:119], v[86:87], v[110:111] op_sel_hi:[1,0]
    v_pk_mul_f32 v[120:121], v[88:89], v[110:111] op_sel_hi:[1,0]
    v_pk_mul_f32 v[122:123], v[90:91], v[110:111] op_sel_hi:[1,0]
    v_pk_mul_f32 v[124:125], v[92:93], v[110:111] op_sel_hi:[1,0]
    v_pk_mul_f32 v[126:127], v[94:95], v[110:111] op_sel_hi:[1,0]
    v_pk_fma_f32 v[64:65], v[64:65], v[108:109], v[112:113] op_sel_hi:[1,0,1]
    v_pk_fma_f32 v[66:67], v[66:67], v[108:109], v[114:115] op_sel_hi:[1,0,1]
    v_pk_fma_f32 v[68:69], v[68:69], v[108:109], v[116:117] op_sel_hi:[1,0,1]
    v_pk_fma_f32 v[70:71], v[70:71], v[108:109], v[118:119] op_sel_hi:[1,0,1]
    v_pk_fma_f32 v[72:73], v[72:73], v[108:109], v[120:121] op_sel_hi:[1,0,1]
    v_pk_fma_f32 v[74:75], v[74:75], v[108:109], v[122:123] op_sel_hi:[1,0,1]
    v_pk_fma_f32 v[76:77], v[76:77], v[108:109], v[124:125] op_sel_hi:[1,0,1]
    v_pk_fma_f32 v[78:79], v[78:79], v[108:109], v[126:127] op_sel_hi:[1,0,1]
    v_cvt_pk_bf16_f32 v64, v64, v65
    v_cvt_pk_bf16_f32 v65, v66, v67
    ds_write_b64 v152, v[64:65] offset:12288
    v_cvt_pk_bf16_f32 v68, v68, v69
    v_cvt_pk_bf16_f32 v69, v70, v71
    ds_write_b64 v153, v[68:69] offset:12288
    v_cvt_pk_bf16_f32 v72, v72, v73
    v_cvt_pk_bf16_f32 v73, v74, v75
    ds_write_b64 v154, v[72:73] offset:12288
    v_cvt_pk_bf16_f32 v76, v76, v77
    v_cvt_pk_bf16_f32 v77, v78, v79
    ds_write_b64 v155, v[76:77] offset:12288
    s_mov_b32 s64, 0
    s_barrier
    v_mfma_f32_16x16x32_bf16 v[16:19], a[16:19], a[0:3], 0
    ds_read_b128 v[80:83], v8 offset:0
    s_add_u32 s65, s65, 1
    v_mfma_f32_16x16x32_bf16 v[32:35], a[16:19], a[4:7], 0
    ds_read_b64_tr_b16 v[96:97], v144 offset:0
    s_cmp_eq_u32 s65, 3
    v_mfma_f32_16x16x32_bf16 v[48:51], a[16:19], a[8:11], 0
    ds_read_b64_tr_b16 v[98:99], v144 offset:512
    s_mov_b32 s66, 16384
    v_mfma_f32_16x16x32_bf16 v[64:67], a[16:19], a[12:15], 0
    ds_read_b128 v[84:87], v8 offset:2048
    s_cselect_b32 s66, 4294934528, s66
    v_mfma_f32_16x16x32_bf16 v[20:23], a[20:23], a[0:3], 0
    ds_read_b128 v[88:91], v8 offset:4096
    s_cselect_b32 s65, 0, s65
    v_mfma_f32_16x16x32_bf16 v[36:39], a[20:23], a[4:7], 0
    ds_read_b128 v[92:95], v8 offset:6144
    s_add_u32 s67, s67, 1
    v_mfma_f32_16x16x32_bf16 v[52:55], a[20:23], a[8:11], 0
    ds_read_b64_tr_b16 v[100:101], v145 offset:0
    s_cmp_eq_u32 s67, 4
    v_mfma_f32_16x16x32_bf16 v[68:71], a[20:23], a[12:15], 0
    ds_read_b64_tr_b16 v[102:103], v145 offset:512
    s_mov_b32 s62, 16384
    v_mfma_f32_16x16x32_bf16 v[24:27], a[24:27], a[0:3], 0
    ds_read_b64_tr_b16 v[104:105], v146 offset:0
    s_cselect_b32 s62, 4294918144, s62
    v_mfma_f32_16x16x32_bf16 v[40:43], a[24:27], a[4:7], 0
    ds_read_b64_tr_b16 v[106:107], v146 offset:512
    s_cselect_b32 s67, 0, s67
    v_mfma_f32_16x16x32_bf16 v[56:59], a[24:27], a[8:11], 0
    ds_read_b64_tr_b16 v[108:109], v147 offset:0
    v_mfma_f32_16x16x32_bf16 v[72:75], a[24:27], a[12:15], 0
    ds_read_b64_tr_b16 v[110:111], v147 offset:512
    v_mfma_f32_16x16x32_bf16 v[28:31], a[28:31], a[0:3], 0
    ds_read_b128 v[112:115], v9 offset:0
    v_mfma_f32_16x16x32_bf16 v[44:47], a[28:31], a[4:7], 0
    ds_read_b64_tr_b16 v[128:129], v144 offset:4096
    v_mfma_f32_16x16x32_bf16 v[60:63], a[28:31], a[8:11], 0
    ds_read_b64_tr_b16 v[130:131], v144 offset:4608
    v_mfma_f32_16x16x32_bf16 v[76:79], a[28:31], a[12:15], 0
    ds_read_b128 v[116:119], v9 offset:2048
    v_mfma_f32_16x16x32_bf16 v[16:19], a[48:51], a[32:35], v[16:19]
    ds_read_b128 v[120:123], v9 offset:4096
    v_mfma_f32_16x16x32_bf16 v[32:35], a[48:51], a[36:39], v[32:35]
    ds_read_b128 v[124:127], v9 offset:6144
    v_mfma_f32_16x16x32_bf16 v[48:51], a[48:51], a[40:43], v[48:51]
    ds_read_b64_tr_b16 v[132:133], v145 offset:4096
    v_mfma_f32_16x16x32_bf16 v[64:67], a[48:51], a[44:47], v[64:67]
    ds_read_b64_tr_b16 v[134:135], v145 offset:4608
    v_mfma_f32_16x16x32_bf16 v[20:23], a[52:55], a[32:35], v[20:23]
    ds_read_b64_tr_b16 v[136:137], v146 offset:4096
    v_mfma_f32_16x16x32_bf16 v[36:39], a[52:55], a[36:39], v[36:39]
    ds_read_b64_tr_b16 v[138:139], v146 offset:4608
    v_mfma_f32_16x16x32_bf16 v[52:55], a[52:55], a[40:43], v[52:55]
    ds_read_b64_tr_b16 v[140:141], v147 offset:4096
    v_mfma_f32_16x16x32_bf16 v[68:71], a[52:55], a[44:47], v[68:71]
    ds_read_b64_tr_b16 v[142:143], v147 offset:4608
    v_add_u32 v8, s66, v8
    v_mfma_f32_16x16x32_bf16 v[24:27], a[56:59], a[32:35], v[24:27]
    v_add_u32 v9, s66, v9
    v_add_u32 v144, s62, v144
    v_mfma_f32_16x16x32_bf16 v[40:43], a[56:59], a[36:39], v[40:43]
    v_add_u32 v145, s62, v145
    v_add_u32 v146, s62, v146
    v_mfma_f32_16x16x32_bf16 v[56:59], a[56:59], a[40:43], v[56:59]
    v_add_u32 v147, s62, v147
    v_mfma_f32_16x16x32_bf16 v[72:75], a[56:59], a[44:47], v[72:75]
    v_mfma_f32_16x16x32_bf16 v[28:31], a[60:63], a[32:35], v[28:31]
    v_mfma_f32_16x16x32_bf16 v[44:47], a[60:63], a[36:39], v[44:47]
    v_mfma_f32_16x16x32_bf16 v[60:63], a[60:63], a[40:43], v[60:63]
    v_mfma_f32_16x16x32_bf16 v[76:79], a[60:63], a[44:47], v[76:79]
    s_waitcnt lgkmcnt(0)
    s_barrier
    v_mfma_f32_16x16x32_bf16 v[16:19], v[96:99], v[80:83], v[16:19]
    ds_read_b128 a[0:3], v8 offset:0
    s_add_u32 s65, s65, 1
    v_mfma_f32_16x16x32_bf16 v[32:35], v[96:99], v[84:87], v[32:35]
    ds_read_b64_tr_b16 a[16:17], v144 offset:0
    s_cmp_eq_u32 s65, 3
    v_mfma_f32_16x16x32_bf16 v[48:51], v[96:99], v[88:91], v[48:51]
    ds_read_b64_tr_b16 a[18:19], v144 offset:512
    s_mov_b32 s66, 16384
    v_mfma_f32_16x16x32_bf16 v[64:67], v[96:99], v[92:95], v[64:67]
    ds_read_b128 a[4:7], v8 offset:2048
    s_cselect_b32 s66, 4294934528, s66
    v_mfma_f32_16x16x32_bf16 v[20:23], v[100:103], v[80:83], v[20:23]
    ds_read_b128 a[8:11], v8 offset:4096
    s_cselect_b32 s65, 0, s65
    v_mfma_f32_16x16x32_bf16 v[36:39], v[100:103], v[84:87], v[36:39]
    ds_read_b128 a[12:15], v8 offset:6144
    s_add_u32 s67, s67, 1
    v_mfma_f32_16x16x32_bf16 v[52:55], v[100:103], v[88:91], v[52:55]
    ds_read_b64_tr_b16 a[20:21], v145 offset:0
    s_cmp_eq_u32 s67, 4
    v_mfma_f32_16x16x32_bf16 v[68:71], v[100:103], v[92:95], v[68:71]
    ds_read_b64_tr_b16 a[22:23], v145 offset:512
    s_mov_b32 s62, 16384
    v_mfma_f32_16x16x32_bf16 v[24:27], v[104:107], v[80:83], v[24:27]
    ds_read_b64_tr_b16 a[24:25], v146 offset:0
    s_cselect_b32 s62, 4294918144, s62
    v_mfma_f32_16x16x32_bf16 v[40:43], v[104:107], v[84:87], v[40:43]
    ds_read_b64_tr_b16 a[26:27], v146 offset:512
    s_cselect_b32 s67, 0, s67
    v_mfma_f32_16x16x32_bf16 v[56:59], v[104:107], v[88:91], v[56:59]
    ds_read_b64_tr_b16 a[28:29], v147 offset:0
    v_mfma_f32_16x16x32_bf16 v[72:75], v[104:107], v[92:95], v[72:75]
    ds_read_b64_tr_b16 a[30:31], v147 offset:512
    v_mfma_f32_16x16x32_bf16 v[28:31], v[108:111], v[80:83], v[28:31]
    ds_read_b128 a[32:35], v9 offset:0
    v_mfma_f32_16x16x32_bf16 v[44:47], v[108:111], v[84:87], v[44:47]
    ds_read_b64_tr_b16 a[48:49], v144 offset:4096
    v_mfma_f32_16x16x32_bf16 v[60:63], v[108:111], v[88:91], v[60:63]
    ds_read_b64_tr_b16 a[50:51], v144 offset:4608
    v_mfma_f32_16x16x32_bf16 v[76:79], v[108:111], v[92:95], v[76:79]
    ds_read_b128 a[36:39], v9 offset:2048
    v_mfma_f32_16x16x32_bf16 v[16:19], v[128:131], v[112:115], v[16:19]
    ds_read_b128 a[40:43], v9 offset:4096
    v_mfma_f32_16x16x32_bf16 v[32:35], v[128:131], v[116:119], v[32:35]
    ds_read_b128 a[44:47], v9 offset:6144
    v_mfma_f32_16x16x32_bf16 v[48:51], v[128:131], v[120:123], v[48:51]
    ds_read_b64_tr_b16 a[52:53], v145 offset:4096
    v_mfma_f32_16x16x32_bf16 v[64:67], v[128:131], v[124:127], v[64:67]
    ds_read_b64_tr_b16 a[54:55], v145 offset:4608
    v_mfma_f32_16x16x32_bf16 v[20:23], v[132:135], v[112:115], v[20:23]
    ds_read_b64_tr_b16 a[56:57], v146 offset:4096
    v_mfma_f32_16x16x32_bf16 v[36:39], v[132:135], v[116:119], v[36:39]
    ds_read_b64_tr_b16 a[58:59], v146 offset:4608
    v_mfma_f32_16x16x32_bf16 v[52:55], v[132:135], v[120:123], v[52:55]
    ds_read_b64_tr_b16 a[60:61], v147 offset:4096
    v_mfma_f32_16x16x32_bf16 v[68:71], v[132:135], v[124:127], v[68:71]
    ds_read_b64_tr_b16 a[62:63], v147 offset:4608
    v_add_u32 v8, s66, v8
    v_mfma_f32_16x16x32_bf16 v[24:27], v[136:139], v[112:115], v[24:27]
    v_add_u32 v9, s66, v9
    v_add_u32 v144, s62, v144
    v_mfma_f32_16x16x32_bf16 v[40:43], v[136:139], v[116:119], v[40:43]
    v_add_u32 v145, s62, v145
    v_add_u32 v146, s62, v146
    v_mfma_f32_16x16x32_bf16 v[56:59], v[136:139], v[120:123], v[56:59]
    v_add_u32 v147, s62, v147
    v_mfma_f32_16x16x32_bf16 v[72:75], v[136:139], v[124:127], v[72:75]
    v_mfma_f32_16x16x32_bf16 v[28:31], v[140:143], v[112:115], v[28:31]
    v_mfma_f32_16x16x32_bf16 v[44:47], v[140:143], v[116:119], v[44:47]
    v_mfma_f32_16x16x32_bf16 v[60:63], v[140:143], v[120:123], v[60:63]
    v_mfma_f32_16x16x32_bf16 v[76:79], v[140:143], v[124:127], v[76:79]
    s_waitcnt lgkmcnt(0)
g4_loop:
    s_barrier
    v_mfma_f32_16x16x32_bf16 v[16:19], a[16:19], a[0:3], v[16:19]
    ds_read_b128 v[80:83], v8 offset:0
    s_add_u32 s65, s65, 1
    v_mfma_f32_16x16x32_bf16 v[32:35], a[16:19], a[4:7], v[32:35]
    ds_read_b64_tr_b16 v[96:97], v144 offset:0
    s_cmp_eq_u32 s65, 3
    v_mfma_f32_16x16x32_bf16 v[48:51], a[16:19], a[8:11], v[48:51]
    ds_read_b64_tr_b16 v[98:99], v144 offset:512
    s_mov_b32 s66, 16384
    v_mfma_f32_16x16x32_bf16 v[64:67], a[16:19], a[12:15], v[64:67]
    ds_read_b128 v[84:87], v8 offset:2048
    s_cselect_b32 s66, 4294934528, s66
    v_mfma_f32_16x16x32_bf16 v[20:23], a[20:23], a[0:3], v[20:23]
    ds_read_b128 v[88:91], v8 offset:4096
    s_cselect_b32 s65, 0, s65
    v_mfma_f32_16x16x32_bf16 v[36:39], a[20:23], a[4:7], v[36:39]
    ds_read_b128 v[92:95], v8 offset:6144
    s_add_u32 s67, s67, 1
    v_mfma_f32_16x16x32_bf16 v[52:55], a[20:23], a[8:11], v[52:55]
    ds_read_b64_tr_b16 v[100:101], v145 offset:0
    s_cmp_eq_u32 s67, 4
    v_mfma_f32_16x16x32_bf16 v[68:71], a[20:23], a[12:15], v[68:71]
    ds_read_b64_tr_b16 v[102:103], v145 offset:512
    s_mov_b32 s62, 16384
    v_mfma_f32_16x16x32_bf16 v[24:27], a[24:27], a[0:3], v[24:27]
    ds_read_b64_tr_b16 v[104:105], v146 offset:0
    s_cselect_b32 s62, 4294918144, s62
    v_mfma_f32_16x16x32_bf16 v[40:43], a[24:27], a[4:7], v[40:43]
    ds_read_b64_tr_b16 v[106:107], v146 offset:512
    s_cselect_b32 s67, 0, s67
    v_mfma_f32_16x16x32_bf16 v[56:59], a[24:27], a[8:11], v[56:59]
    ds_read_b64_tr_b16 v[108:109], v147 offset:0
    s_add_u32 s64, s64, 2
    v_mfma_f32_16x16x32_bf16 v[72:75], a[24:27], a[12:15], v[72:75]
    ds_read_b64_tr_b16 v[110:111], v147 offset:512
    v_mfma_f32_16x16x32_bf16 v[28:31], a[28:31], a[0:3], v[28:31]
    ds_read_b128 v[112:115], v9 offset:0
    v_mfma_f32_16x16x32_bf16 v[44:47], a[28:31], a[4:7], v[44:47]
    ds_read_b64_tr_b16 v[128:129], v144 offset:4096
    v_mfma_f32_16x16x32_bf16 v[60:63], a[28:31], a[8:11], v[60:63]
    ds_read_b64_tr_b16 v[130:131], v144 offset:4608
    v_mfma_f32_16x16x32_bf16 v[76:79], a[28:31], a[12:15], v[76:79]
    ds_read_b128 v[116:119], v9 offset:2048
    v_mfma_f32_16x16x32_bf16 v[16:19], a[48:51], a[32:35], v[16:19]
    ds_read_b128 v[120:123], v9 offset:4096
    v_mfma_f32_16x16x32_bf16 v[32:35], a[48:51], a[36:39], v[32:35]
    ds_read_b128 v[124:127], v9 offset:6144
    v_mfma_f32_16x16x32_bf16 v[48:51], a[48:51], a[40:43], v[48:51]
    ds_read_b64_tr_b16 v[132:133], v145 offset:4096
    v_mfma_f32_16x16x32_bf16 v[64:67], a[48:51], a[44:47], v[64:67]
    ds_read_b64_tr_b16 v[134:135], v145 offset:4608
    v_mfma_f32_16x16x32_bf16 v[20:23], a[52:55], a[32:35], v[20:23]
    ds_read_b64_tr_b16 v[136:137], v146 offset:4096
    v_mfma_f32_16x16x32_bf16 v[36:39], a[52:55], a[36:39], v[36:39]
    ds_read_b64_tr_b16 v[138:139], v146 offset:4608
    v_mfma_f32_16x16x32_bf16 v[52:55], a[52:55], a[40:43], v[52:55]
    ds_read_b64_tr_b16 v[140:141], v147 offset:4096
    v_mfma_f32_16x16x32_bf16 v[68:71], a[52:55], a[44:47], v[68:71]
    ds_read_b64_tr_b16 v[142:143], v147 offset:4608
    v_add_u32 v8, s66, v8
    v_mfma_f32_16x16x32_bf16 v[24:27], a[56:59], a[32:35], v[24:27]
    v_add_u32 v9, s66, v9
    v_add_u32 v144, s62, v144
    v_mfma_f32_16x16x32_bf16 v[40:43], a[56:59], a[36:39], v[40:43]
    v_add_u32 v145, s62, v145
    v_add_u32 v146, s62, v146
    v_mfma_f32_16x16x32_bf16 v[56:59], a[56:59], a[40:43], v[56:59]
    v_add_u32 v147, s62, v147
    v_mfma_f32_16x16x32_bf16 v[72:75], a[56:59], a[44:47], v[72:75]
    v_mfma_f32_16x16x32_bf16 v[28:31], a[60:63], a[32:35], v[28:31]
    v_mfma_f32_16x16x32_bf16 v[44:47], a[60:63], a[36:39], v[44:47]
    v_mfma_f32_16x16x32_bf16 v[60:63], a[60:63], a[40:43], v[60:63]
    v_mfma_f32_16x16x32_bf16 v[76:79], a[60:63], a[44:47], v[76:79]
    s_waitcnt lgkmcnt(0)
    s_barrier
    v_mfma_f32_16x16x32_bf16 v[16:19], v[96:99], v[80:83], v[16:19]
    ds_read_b128 a[0:3], v8 offset:0
    s_add_u32 s65, s65, 1
    v_mfma_f32_16x16x32_bf16 v[32:35], v[96:99], v[84:87], v[32:35]
    ds_read_b64_tr_b16 a[16:17], v144 offset:0
    s_cmp_eq_u32 s65, 3
    v_mfma_f32_16x16x32_bf16 v[48:51], v[96:99], v[88:91], v[48:51]
    ds_read_b64_tr_b16 a[18:19], v144 offset:512
    s_mov_b32 s66, 16384
    v_mfma_f32_16x16x32_bf16 v[64:67], v[96:99], v[92:95], v[64:67]
    ds_read_b128 a[4:7], v8 offset:2048
    s_cselect_b32 s66, 4294934528, s66
    v_mfma_f32_16x16x32_bf16 v[20:23], v[100:103], v[80:83], v[20:23]
    ds_read_b128 a[8:11], v8 offset:4096
    s_cselect_b32 s65, 0, s65
    v_mfma_f32_16x16x32_bf16 v[36:39], v[100:103], v[84:87], v[36:39]
    ds_read_b128 a[12:15], v8 offset:6144
    s_add_u32 s67, s67, 1
    v_mfma_f32_16x16x32_bf16 v[52:55], v[100:103], v[88:91], v[52:55]
    ds_read_b64_tr_b16 a[20:21], v145 offset:0
    s_cmp_eq_u32 s67, 4
    v_mfma_f32_16x16x32_bf16 v[68:71], v[100:103], v[92:95], v[68:71]
    ds_read_b64_tr_b16 a[22:23], v145 offset:512
    s_mov_b32 s62, 16384
    v_mfma_f32_16x16x32_bf16 v[24:27], v[104:107], v[80:83], v[24:27]
    ds_read_b64_tr_b16 a[24:25], v146 offset:0
    s_cselect_b32 s62, 4294918144, s62
    v_mfma_f32_16x16x32_bf16 v[40:43], v[104:107], v[84:87], v[40:43]
    ds_read_b64_tr_b16 a[26:27], v146 offset:512
    s_cselect_b32 s67, 0, s67
    v_mfma_f32_16x16x32_bf16 v[56:59], v[104:107], v[88:91], v[56:59]
    ds_read_b64_tr_b16 a[28:29], v147 offset:0
    v_mfma_f32_16x16x32_bf16 v[72:75], v[104:107], v[92:95], v[72:75]
    ds_read_b64_tr_b16 a[30:31], v147 offset:512
    v_mfma_f32_16x16x32_bf16 v[28:31], v[108:111], v[80:83], v[28:31]
    ds_read_b128 a[32:35], v9 offset:0
    v_mfma_f32_16x16x32_bf16 v[44:47], v[108:111], v[84:87], v[44:47]
    ds_read_b64_tr_b16 a[48:49], v144 offset:4096
    v_mfma_f32_16x16x32_bf16 v[60:63], v[108:111], v[88:91], v[60:63]
    ds_read_b64_tr_b16 a[50:51], v144 offset:4608
    v_mfma_f32_16x16x32_bf16 v[76:79], v[108:111], v[92:95], v[76:79]
    ds_read_b128 a[36:39], v9 offset:2048
    v_mfma_f32_16x16x32_bf16 v[16:19], v[128:131], v[112:115], v[16:19]
    ds_read_b128 a[40:43], v9 offset:4096
    v_mfma_f32_16x16x32_bf16 v[32:35], v[128:131], v[116:119], v[32:35]
    ds_read_b128 a[44:47], v9 offset:6144
    v_mfma_f32_16x16x32_bf16 v[48:51], v[128:131], v[120:123], v[48:51]
    ds_read_b64_tr_b16 a[52:53], v145 offset:4096
    v_mfma_f32_16x16x32_bf16 v[64:67], v[128:131], v[124:127], v[64:67]
    ds_read_b64_tr_b16 a[54:55], v145 offset:4608
    v_mfma_f32_16x16x32_bf16 v[20:23], v[132:135], v[112:115], v[20:23]
    ds_read_b64_tr_b16 a[56:57], v146 offset:4096
    v_mfma_f32_16x16x32_bf16 v[36:39], v[132:135], v[116:119], v[36:39]
    ds_read_b64_tr_b16 a[58:59], v146 offset:4608
    v_mfma_f32_16x16x32_bf16 v[52:55], v[132:135], v[120:123], v[52:55]
    ds_read_b64_tr_b16 a[60:61], v147 offset:4096
    v_mfma_f32_16x16x32_bf16 v[68:71], v[132:135], v[124:127], v[68:71]
    ds_read_b64_tr_b16 a[62:63], v147 offset:4608
    v_add_u32 v8, s66, v8
    v_mfma_f32_16x16x32_bf16 v[24:27], v[136:139], v[112:115], v[24:27]
    v_add_u32 v9, s66, v9
    v_add_u32 v144, s62, v144
    v_mfma_f32_16x16x32_bf16 v[40:43], v[136:139], v[116:119], v[40:43]
    v_add_u32 v145, s62, v145
    v_add_u32 v146, s62, v146
    v_mfma_f32_16x16x32_bf16 v[56:59], v[136:139], v[120:123], v[56:59]
    v_add_u32 v147, s62, v147
    v_mfma_f32_16x16x32_bf16 v[72:75], v[136:139], v[124:127], v[72:75]
    v_mfma_f32_16x16x32_bf16 v[28:31], v[140:143], v[112:115], v[28:31]
    v_mfma_f32_16x16x32_bf16 v[44:47], v[140:143], v[116:119], v[44:47]
    v_mfma_f32_16x16x32_bf16 v[60:63], v[140:143], v[120:123], v[60:63]
    v_mfma_f32_16x16x32_bf16 v[76:79], v[140:143], v[124:127], v[76:79]
    s_cmp_lt_u32 s64, 30
    s_waitcnt lgkmcnt(0)
    s_cbranch_scc1 g4_loop
    ds_read_b32 v96, v156 offset:3072
    ds_read_b32 v98, v156 offset:3136
    ds_read_b32 v100, v156 offset:3200
    ds_read_b32 v102, v156 offset:3264
    ds_read_b64 a[0:1], v152 offset:0
    ds_read_b64 a[2:3], v153 offset:0
    ds_read_b64 a[4:5], v154 offset:0
    ds_read_b64 a[6:7], v155 offset:0
    ds_read_b64 a[8:9], v152 offset:4096
    ds_read_b64 a[10:11], v153 offset:4096
    ds_read_b64 a[12:13], v154 offset:4096
    ds_read_b64 a[14:15], v155 offset:4096
    ds_read_b64 a[16:17], v152 offset:8192
    ds_read_b64 a[18:19], v153 offset:8192
    ds_read_b64 a[20:21], v154 offset:8192
    ds_read_b64 a[22:23], v155 offset:8192
    ds_read_b64 a[24:25], v152 offset:12288
    ds_read_b64 a[26:27], v153 offset:12288
    ds_read_b64 a[28:29], v154 offset:12288
    ds_read_b64 a[30:31], v155 offset:12288
    s_and_b32 s50, s30, 1
    s_lshr_b32 s51, s30, 1
    s_lshl_b32 s52, s26, 7
    s_lshl_b32 s53, s50, 6
    s_add_u32 s52, s52, s53
    v_add_u32 v12, s52, v3
    s_mov_b32 s53, 3584
    v_mul_lo_u32 v12, v12, s53
    v_and_b32 v13, 1, v2
    v_lshlrev_b32 v13, 5, v13
    v_lshrrev_b32 v14, 1, v2
    v_lshlrev_b32 v14, 4, v14
    v_add3_u32 v12, v12, v13, v14
    s_lshl_b32 s52, s49, 8
    s_lshl_b32 s53, s51, 7
    s_add_u32 s52, s52, s53
    s_add_u32 s52, s52, 16777216
    s_waitcnt lgkmcnt(0)
    v_accvgpr_read_b32 v112, a0
    v_accvgpr_read_b32 v113, a1
    v_accvgpr_read_b32 v114, a2
    v_accvgpr_read_b32 v115, a3
    v_accvgpr_read_b32 v116, a4
    v_accvgpr_read_b32 v117, a5
    v_accvgpr_read_b32 v118, a6
    v_accvgpr_read_b32 v119, a7
    v_lshlrev_b32 v80, 16, v112
    v_and_b32 v81, 0xffff0000, v112
    v_lshlrev_b32 v82, 16, v113
    v_and_b32 v83, 0xffff0000, v113
    v_lshlrev_b32 v84, 16, v114
    v_and_b32 v85, 0xffff0000, v114
    v_lshlrev_b32 v86, 16, v115
    v_and_b32 v87, 0xffff0000, v115
    v_lshlrev_b32 v88, 16, v116
    v_and_b32 v89, 0xffff0000, v116
    v_lshlrev_b32 v90, 16, v117
    v_and_b32 v91, 0xffff0000, v117
    v_lshlrev_b32 v92, 16, v118
    v_and_b32 v93, 0xffff0000, v118
    v_lshlrev_b32 v94, 16, v119
    v_and_b32 v95, 0xffff0000, v119
    v_pk_add_f32 v[16:17], v[16:17], v[96:97] op_sel_hi:[1,0]
    v_pk_add_f32 v[18:19], v[18:19], v[96:97] op_sel_hi:[1,0]
    v_pk_add_f32 v[20:21], v[20:21], v[96:97] op_sel_hi:[1,0]
    v_pk_add_f32 v[22:23], v[22:23], v[96:97] op_sel_hi:[1,0]
    v_pk_add_f32 v[24:25], v[24:25], v[96:97] op_sel_hi:[1,0]
    v_pk_add_f32 v[26:27], v[26:27], v[96:97] op_sel_hi:[1,0]
    v_pk_add_f32 v[28:29], v[28:29], v[96:97] op_sel_hi:[1,0]
    v_pk_add_f32 v[30:31], v[30:31], v[96:97] op_sel_hi:[1,0]
    v_pk_mul_f32 v[16:17], v[16:17], v[80:81]
    v_pk_mul_f32 v[18:19], v[18:19], v[82:83]
    v_pk_mul_f32 v[20:21], v[20:21], v[84:85]
    v_pk_mul_f32 v[22:23], v[22:23], v[86:87]
    v_pk_mul_f32 v[24:25], v[24:25], v[88:89]
    v_pk_mul_f32 v[26:27], v[26:27], v[90:91]
    v_pk_mul_f32 v[28:29], v[28:29], v[92:93]
    v_pk_mul_f32 v[30:31], v[30:31], v[94:95]
    s_add_u32 s53, s52, 0
    v_cvt_pk_bf16_f32 v120, v16, v17
    v_cvt_pk_bf16_f32 v121, v18, v19
    v_cvt_pk_bf16_f32 v122, v20, v21
    v_cvt_pk_bf16_f32 v123, v22, v23
    s_nop 0
    v_permlane16_swap_b32 v120, v122
    v_permlane16_swap_b32 v121, v123
    buffer_store_dwordx4 v[120:123], v12, s[32:35], s53 offen offset:0 sc1
    v_cvt_pk_bf16_f32 v124, v24, v25
    v_cvt_pk_bf16_f32 v125, v26, v27
    v_cvt_pk_bf16_f32 v126, v28, v29
    v_cvt_pk_bf16_f32 v127, v30, v31
    s_nop 0
    v_permlane16_swap_b32 v124, v126
    v_permlane16_swap_b32 v125, v127
    buffer_store_dwordx4 v[124:127], v12, s[32:35], s53 offen offset:64 sc1
    v_accvgpr_read_b32 v112, a8
    v_accvgpr_read_b32 v113, a9
    v_accvgpr_read_b32 v114, a10
    v_accvgpr_read_b32 v115, a11
    v_accvgpr_read_b32 v116, a12
    v_accvgpr_read_b32 v117, a13
    v_accvgpr_read_b32 v118, a14
    v_accvgpr_read_b32 v119, a15
    v_lshlrev_b32 v80, 16, v112
    v_and_b32 v81, 0xffff0000, v112
    v_lshlrev_b32 v82, 16, v113
    v_and_b32 v83, 0xffff0000, v113
    v_lshlrev_b32 v84, 16, v114
    v_and_b32 v85, 0xffff0000, v114
    v_lshlrev_b32 v86, 16, v115
    v_and_b32 v87, 0xffff0000, v115
    v_lshlrev_b32 v88, 16, v116
    v_and_b32 v89, 0xffff0000, v116
    v_lshlrev_b32 v90, 16, v117
    v_and_b32 v91, 0xffff0000, v117
    v_lshlrev_b32 v92, 16, v118
    v_and_b32 v93, 0xffff0000, v118
    v_lshlrev_b32 v94, 16, v119
    v_and_b32 v95, 0xffff0000, v119
    v_pk_add_f32 v[32:33], v[32:33], v[98:99] op_sel_hi:[1,0]
    v_pk_add_f32 v[34:35], v[34:35], v[98:99] op_sel_hi:[1,0]
    v_pk_add_f32 v[36:37], v[36:37], v[98:99] op_sel_hi:[1,0]
    v_pk_add_f32 v[38:39], v[38:39], v[98:99] op_sel_hi:[1,0]
    v_pk_add_f32 v[40:41], v[40:41], v[98:99] op_sel_hi:[1,0]
    v_pk_add_f32 v[42:43], v[42:43], v[98:99] op_sel_hi:[1,0]
    v_pk_add_f32 v[44:45], v[44:45], v[98:99] op_sel_hi:[1,0]
    v_pk_add_f32 v[46:47], v[46:47], v[98:99] op_sel_hi:[1,0]
    v_pk_mul_f32 v[32:33], v[32:33], v[80:81]
    v_pk_mul_f32 v[34:35], v[34:35], v[82:83]
    v_pk_mul_f32 v[36:37], v[36:37], v[84:85]
    v_pk_mul_f32 v[38:39], v[38:39], v[86:87]
    v_pk_mul_f32 v[40:41], v[40:41], v[88:89]
    v_pk_mul_f32 v[42:43], v[42:43], v[90:91]
    v_pk_mul_f32 v[44:45], v[44:45], v[92:93]
    v_pk_mul_f32 v[46:47], v[46:47], v[94:95]
    s_add_u32 s53, s52, 57344
    v_cvt_pk_bf16_f32 v128, v32, v33
    v_cvt_pk_bf16_f32 v129, v34, v35
    v_cvt_pk_bf16_f32 v130, v36, v37
    v_cvt_pk_bf16_f32 v131, v38, v39
    s_nop 0
    v_permlane16_swap_b32 v128, v130
    v_permlane16_swap_b32 v129, v131
    buffer_store_dwordx4 v[128:131], v12, s[32:35], s53 offen offset:0 sc1
    v_cvt_pk_bf16_f32 v132, v40, v41
    v_cvt_pk_bf16_f32 v133, v42, v43
    v_cvt_pk_bf16_f32 v134, v44, v45
    v_cvt_pk_bf16_f32 v135, v46, v47
    s_nop 0
    v_permlane16_swap_b32 v132, v134
    v_permlane16_swap_b32 v133, v135
    buffer_store_dwordx4 v[132:135], v12, s[32:35], s53 offen offset:64 sc1
    v_accvgpr_read_b32 v112, a16
    v_accvgpr_read_b32 v113, a17
    v_accvgpr_read_b32 v114, a18
    v_accvgpr_read_b32 v115, a19
    v_accvgpr_read_b32 v116, a20
    v_accvgpr_read_b32 v117, a21
    v_accvgpr_read_b32 v118, a22
    v_accvgpr_read_b32 v119, a23
    v_lshlrev_b32 v80, 16, v112
    v_and_b32 v81, 0xffff0000, v112
    v_lshlrev_b32 v82, 16, v113
    v_and_b32 v83, 0xffff0000, v113
    v_lshlrev_b32 v84, 16, v114
    v_and_b32 v85, 0xffff0000, v114
    v_lshlrev_b32 v86, 16, v115
    v_and_b32 v87, 0xffff0000, v115
    v_lshlrev_b32 v88, 16, v116
    v_and_b32 v89, 0xffff0000, v116
    v_lshlrev_b32 v90, 16, v117
    v_and_b32 v91, 0xffff0000, v117
    v_lshlrev_b32 v92, 16, v118
    v_and_b32 v93, 0xffff0000, v118
    v_lshlrev_b32 v94, 16, v119
    v_and_b32 v95, 0xffff0000, v119
    v_pk_add_f32 v[48:49], v[48:49], v[100:101] op_sel_hi:[1,0]
    v_pk_add_f32 v[50:51], v[50:51], v[100:101] op_sel_hi:[1,0]
    v_pk_add_f32 v[52:53], v[52:53], v[100:101] op_sel_hi:[1,0]
    v_pk_add_f32 v[54:55], v[54:55], v[100:101] op_sel_hi:[1,0]
    v_pk_add_f32 v[56:57], v[56:57], v[100:101] op_sel_hi:[1,0]
    v_pk_add_f32 v[58:59], v[58:59], v[100:101] op_sel_hi:[1,0]
    v_pk_add_f32 v[60:61], v[60:61], v[100:101] op_sel_hi:[1,0]
    v_pk_add_f32 v[62:63], v[62:63], v[100:101] op_sel_hi:[1,0]
    v_pk_mul_f32 v[48:49], v[48:49], v[80:81]
    v_pk_mul_f32 v[50:51], v[50:51], v[82:83]
    v_pk_mul_f32 v[52:53], v[52:53], v[84:85]
    v_pk_mul_f32 v[54:55], v[54:55], v[86:87]
    v_pk_mul_f32 v[56:57], v[56:57], v[88:89]
    v_pk_mul_f32 v[58:59], v[58:59], v[90:91]
    v_pk_mul_f32 v[60:61], v[60:61], v[92:93]
    v_pk_mul_f32 v[62:63], v[62:63], v[94:95]
    s_add_u32 s53, s52, 114688
    v_cvt_pk_bf16_f32 v120, v48, v49
    v_cvt_pk_bf16_f32 v121, v50, v51
    v_cvt_pk_bf16_f32 v122, v52, v53
    v_cvt_pk_bf16_f32 v123, v54, v55
    s_nop 0
    v_permlane16_swap_b32 v120, v122
    v_permlane16_swap_b32 v121, v123
    buffer_store_dwordx4 v[120:123], v12, s[32:35], s53 offen offset:0 sc1
    v_cvt_pk_bf16_f32 v124, v56, v57
    v_cvt_pk_bf16_f32 v125, v58, v59
    v_cvt_pk_bf16_f32 v126, v60, v61
    v_cvt_pk_bf16_f32 v127, v62, v63
    s_nop 0
    v_permlane16_swap_b32 v124, v126
    v_permlane16_swap_b32 v125, v127
    buffer_store_dwordx4 v[124:127], v12, s[32:35], s53 offen offset:64 sc1
    v_accvgpr_read_b32 v112, a24
    v_accvgpr_read_b32 v113, a25
    v_accvgpr_read_b32 v114, a26
    v_accvgpr_read_b32 v115, a27
    v_accvgpr_read_b32 v116, a28
    v_accvgpr_read_b32 v117, a29
    v_accvgpr_read_b32 v118, a30
    v_accvgpr_read_b32 v119, a31
    v_lshlrev_b32 v80, 16, v112
    v_and_b32 v81, 0xffff0000, v112
    v_lshlrev_b32 v82, 16, v113
    v_and_b32 v83, 0xffff0000, v113
    v_lshlrev_b32 v84, 16, v114
    v_and_b32 v85, 0xffff0000, v114
    v_lshlrev_b32 v86, 16, v115
    v_and_b32 v87, 0xffff0000, v115
    v_lshlrev_b32 v88, 16, v116
    v_and_b32 v89, 0xffff0000, v116
    v_lshlrev_b32 v90, 16, v117
    v_and_b32 v91, 0xffff0000, v117
    v_lshlrev_b32 v92, 16, v118
    v_and_b32 v93, 0xffff0000, v118
    v_lshlrev_b32 v94, 16, v119
    v_and_b32 v95, 0xffff0000, v119
    v_pk_add_f32 v[64:65], v[64:65], v[102:103] op_sel_hi:[1,0]
    v_pk_add_f32 v[66:67], v[66:67], v[102:103] op_sel_hi:[1,0]
    v_pk_add_f32 v[68:69], v[68:69], v[102:103] op_sel_hi:[1,0]
    v_pk_add_f32 v[70:71], v[70:71], v[102:103] op_sel_hi:[1,0]
    v_pk_add_f32 v[72:73], v[72:73], v[102:103] op_sel_hi:[1,0]
    v_pk_add_f32 v[74:75], v[74:75], v[102:103] op_sel_hi:[1,0]
    v_pk_add_f32 v[76:77], v[76:77], v[102:103] op_sel_hi:[1,0]
    v_pk_add_f32 v[78:79], v[78:79], v[102:103] op_sel_hi:[1,0]
    v_pk_mul_f32 v[64:65], v[64:65], v[80:81]
    v_pk_mul_f32 v[66:67], v[66:67], v[82:83]
    v_pk_mul_f32 v[68:69], v[68:69], v[84:85]
    v_pk_mul_f32 v[70:71], v[70:71], v[86:87]
    v_pk_mul_f32 v[72:73], v[72:73], v[88:89]
    v_pk_mul_f32 v[74:75], v[74:75], v[90:91]
    v_pk_mul_f32 v[76:77], v[76:77], v[92:93]
    v_pk_mul_f32 v[78:79], v[78:79], v[94:95]
    s_add_u32 s53, s52, 172032
    v_cvt_pk_bf16_f32 v128, v64, v65
    v_cvt_pk_bf16_f32 v129, v66, v67
    v_cvt_pk_bf16_f32 v130, v68, v69
    v_cvt_pk_bf16_f32 v131, v70, v71
    s_nop 0
    v_permlane16_swap_b32 v128, v130
    v_permlane16_swap_b32 v129, v131
    buffer_store_dwordx4 v[128:131], v12, s[32:35], s53 offen offset:0 sc1
    v_cvt_pk_bf16_f32 v132, v72, v73
    v_cvt_pk_bf16_f32 v133, v74, v75
    v_cvt_pk_bf16_f32 v134, v76, v77
    v_cvt_pk_bf16_f32 v135, v78, v79
    s_nop 0
    v_permlane16_swap_b32 v132, v134
    v_permlane16_swap_b32 v133, v135
    buffer_store_dwordx4 v[132:135], v12, s[32:35], s53 offen offset:64 sc1
    s_barrier
    s_waitcnt vmcnt(0)
    s_barrier
c_g5:
    s_barrier
    v_lshrrev_b32 v4, 1, v3
    v_xor_b32 v4, v2, v4
    v_lshlrev_b32 v4, 4, v4
    v_lshlrev_b32 v5, 7, v3
    v_add_u32 v8, v4, v5
    v_add_u32 v8, 16384, v8
    v_xor_b32 v9, 64, v8
    s_lshr_b32 s51, s30, 1
    s_lshl_b32 s51, s51, 13
    s_and_b32 s52, s30, 1
    s_lshl_b32 s52, s52, 1
    s_add_u32 s53, s52, 1
    v_lshrrev_b32 v4, 2, v3
    v_and_b32 v5, 3, v3
    v_lshrrev_b32 v6, 1, v4
    v_and_b32 v7, 1, v2
    v_lshlrev_b32 v7, 1, v7
    v_or_b32 v6, v6, v7
    v_lshlrev_b32 v7, 3, v2
    v_add_u32 v7, v7, v4
    v_lshlrev_b32 v7, 7, v7
    v_lshlrev_b32 v12, 3, v5
    v_add_u32 v7, v7, v12
    v_add_u32 v7, 49152, v7
    v_add_u32 v7, s51, v7
    v_xor_b32 v12, s52, v6
    v_lshlrev_b32 v12, 5, v12
    v_add_u32 v144, v12, v7
    v_xor_b32 v12, s53, v6
    v_lshlrev_b32 v12, 5, v12
    v_add_u32 v145, v12, v7
    s_and_b32 s52, s29, 1
    s_lshl_b32 s52, s52, 6
    s_lshl_b32 s53, s26, 7
    s_add_u32 s57, s52, s53
    s_lshr_b32 s53, s29, 1
    s_lshl_b32 s54, s28, 2
    s_add_u32 s53, s53, s54
    s_lshl_b32 s54, s53, 8
    s_lshl_b32 s55, s30, 6
    s_add_u32 s54, s54, s55
    v_add_u32 v13, s57, v3
    v_lshlrev_b32 v13, 11, v13
    v_add_u32 v13, s54, v13
    v_lshlrev_b32 v14, 3, v2
    v_add_u32 v14, v14, v13
    v_and_b32 v15, 1, v2
    v_lshlrev_b32 v15, 5, v15
    v_lshrrev_b32 v12, 1, v2
    v_lshlrev_b32 v12, 4, v12
    v_add3_u32 v15, v13, v15, v12
    s_mov_b32 s56, 4194304
    buffer_load_dwordx2 v[48:49], v14, s[32:35], s56 offen offset:0 sc1
    buffer_load_dwordx2 v[50:51], v14, s[32:35], s56 offen offset:32 sc1
    s_mov_b32 s56, 4227072
    buffer_load_dwordx2 v[52:53], v14, s[32:35], s56 offen offset:0 sc1
    buffer_load_dwordx2 v[54:55], v14, s[32:35], s56 offen offset:32 sc1
    s_mov_b32 s56, 4259840
    buffer_load_dwordx2 v[56:57], v14, s[32:35], s56 offen offset:0 sc1
    buffer_load_dwordx2 v[58:59], v14, s[32:35], s56 offen offset:32 sc1
    s_mov_b32 s56, 4292608
    buffer_load_dwordx2 v[60:61], v14, s[32:35], s56 offen offset:0 sc1
    buffer_load_dwordx2 v[62:63], v14, s[32:35], s56 offen offset:32 sc1
    s_mov_b32 s65, 0
    s_mov_b32 s67, 0
    s_barrier
    ds_read_b64_tr_b16 a[16:17], v144 offset:0
    ds_read_b64_tr_b16 a[18:19], v144 offset:512
    ds_read_b128 a[0:3], v8 offset:0
    ds_read_b128 a[4:7], v8 offset:2048
    ds_read_b128 a[8:11], v8 offset:4096
    ds_read_b128 a[12:15], v8 offset:6144
    ds_read_b64_tr_b16 a[20:21], v145 offset:0
    ds_read_b64_tr_b16 a[22:23], v145 offset:512
    ds_read_b64_tr_b16 a[40:41], v144 offset:4096
    ds_read_b64_tr_b16 a[42:43], v144 offset:4608
    ds_read_b128 a[24:27], v9 offset:0
    ds_read_b128 a[28:31], v9 offset:2048
    ds_read_b128 a[32:35], v9 offset:4096
    ds_read_b128 a[36:39], v9 offset:6144
    ds_read_b64_tr_b16 a[44:45], v145 offset:4096
    ds_read_b64_tr_b16 a[46:47], v145 offset:4608
    s_add_u32 s65, s65, 1
    s_cmp_eq_u32 s65, 4
    s_mov_b32 s66, 8192
    s_cselect_b32 s66, 4294942720, s66
    s_cselect_b32 s65, 0, s65
    s_add_u32 s67, s67, 1
    s_cmp_eq_u32 s67, 7
    s_mov_b32 s62, 16384
    s_cselect_b32 s62, 4294868992, s62
    s_cselect_b32 s67, 0, s67
    v_add_u32 v8, s66, v8
    v_add_u32 v9, s66, v9
    v_add_u32 v144, s62, v144
    v_add_u32 v145, s62, v145
    s_waitcnt lgkmcnt(0)
    s_mov_b32 s64, 0
    s_barrier
    v_mfma_f32_16x16x32_bf16 v[16:19], a[16:19], a[0:3], 0
    ds_read_b64_tr_b16 a[64:65], v144 offset:0
    ds_read_b64_tr_b16 a[66:67], v144 offset:512
    s_add_u32 s65, s65, 1
    v_mfma_f32_16x16x32_bf16 v[24:27], a[16:19], a[4:7], 0
    ds_read_b128 a[48:51], v8 offset:0
    ds_read_b128 a[52:55], v8 offset:2048
    s_cmp_eq_u32 s65, 4
    v_mfma_f32_16x16x32_bf16 v[32:35], a[16:19], a[8:11], 0
    ds_read_b128 a[56:59], v8 offset:4096
    ds_read_b128 a[60:63], v8 offset:6144
    s_mov_b32 s66, 8192
    v_mfma_f32_16x16x32_bf16 v[40:43], a[16:19], a[12:15], 0
    ds_read_b64_tr_b16 a[68:69], v145 offset:0
    ds_read_b64_tr_b16 a[70:71], v145 offset:512
    s_cselect_b32 s66, 4294942720, s66
    v_mfma_f32_16x16x32_bf16 v[20:23], a[20:23], a[0:3], 0
    ds_read_b64_tr_b16 a[88:89], v144 offset:4096
    ds_read_b64_tr_b16 a[90:91], v144 offset:4608
    s_cselect_b32 s65, 0, s65
    v_mfma_f32_16x16x32_bf16 v[28:31], a[20:23], a[4:7], 0
    ds_read_b128 a[72:75], v9 offset:0
    s_add_u32 s67, s67, 1
    v_mfma_f32_16x16x32_bf16 v[36:39], a[20:23], a[8:11], 0
    ds_read_b128 a[76:79], v9 offset:2048
    s_cmp_eq_u32 s67, 7
    v_mfma_f32_16x16x32_bf16 v[44:47], a[20:23], a[12:15], 0
    ds_read_b128 a[80:83], v9 offset:4096
    s_mov_b32 s62, 16384
    v_mfma_f32_16x16x32_bf16 v[16:19], a[40:43], a[24:27], v[16:19]
    ds_read_b128 a[84:87], v9 offset:6144
    s_cselect_b32 s62, 4294868992, s62
    v_mfma_f32_16x16x32_bf16 v[24:27], a[40:43], a[28:31], v[24:27]
    ds_read_b64_tr_b16 a[92:93], v145 offset:4096
    s_cselect_b32 s67, 0, s67
    v_mfma_f32_16x16x32_bf16 v[32:35], a[40:43], a[32:35], v[32:35]
    ds_read_b64_tr_b16 a[94:95], v145 offset:4608
    v_add_u32 v8, s66, v8
    v_mfma_f32_16x16x32_bf16 v[40:43], a[40:43], a[36:39], v[40:43]
    v_add_u32 v9, s66, v9
    v_add_u32 v144, s62, v144
    v_mfma_f32_16x16x32_bf16 v[20:23], a[44:47], a[24:27], v[20:23]
    v_add_u32 v145, s62, v145
    v_mfma_f32_16x16x32_bf16 v[28:31], a[44:47], a[28:31], v[28:31]
    v_mfma_f32_16x16x32_bf16 v[36:39], a[44:47], a[32:35], v[36:39]
    v_mfma_f32_16x16x32_bf16 v[44:47], a[44:47], a[36:39], v[44:47]
    s_waitcnt lgkmcnt(0)
    s_barrier
    v_mfma_f32_16x16x32_bf16 v[16:19], a[64:67], a[48:51], v[16:19]
    ds_read_b64_tr_b16 a[16:17], v144 offset:0
    ds_read_b64_tr_b16 a[18:19], v144 offset:512
    s_add_u32 s65, s65, 1
    v_mfma_f32_16x16x32_bf16 v[24:27], a[64:67], a[52:55], v[24:27]
    ds_read_b128 a[0:3], v8 offset:0
    ds_read_b128 a[4:7], v8 offset:2048
    s_cmp_eq_u32 s65, 4
    v_mfma_f32_16x16x32_bf16 v[32:35], a[64:67], a[56:59], v[32:35]
    ds_read_b128 a[8:11], v8 offset:4096
    ds_read_b128 a[12:15], v8 offset:6144
    s_mov_b32 s66, 8192
    v_mfma_f32_16x16x32_bf16 v[40:43], a[64:67], a[60:63], v[40:43]
    ds_read_b64_tr_b16 a[20:21], v145 offset:0
    ds_read_b64_tr_b16 a[22:23], v145 offset:512
    s_cselect_b32 s66, 4294942720, s66
    v_mfma_f32_16x16x32_bf16 v[20:23], a[68:71], a[48:51], v[20:23]
    ds_read_b64_tr_b16 a[40:41], v144 offset:4096
    ds_read_b64_tr_b16 a[42:43], v144 offset:4608
    s_cselect_b32 s65, 0, s65
    v_mfma_f32_16x16x32_bf16 v[28:31], a[68:71], a[52:55], v[28:31]
    ds_read_b128 a[24:27], v9 offset:0
    s_add_u32 s67, s67, 1
    v_mfma_f32_16x16x32_bf16 v[36:39], a[68:71], a[56:59], v[36:39]
    ds_read_b128 a[28:31], v9 offset:2048
    s_cmp_eq_u32 s67, 7
    v_mfma_f32_16x16x32_bf16 v[44:47], a[68:71], a[60:63], v[44:47]
    ds_read_b128 a[32:35], v9 offset:4096
    s_mov_b32 s62, 16384
    v_mfma_f32_16x16x32_bf16 v[16:19], a[88:91], a[72:75], v[16:19]
    ds_read_b128 a[36:39], v9 offset:6144
    s_cselect_b32 s62, 4294868992, s62
    v_mfma_f32_16x16x32_bf16 v[24:27], a[88:91], a[76:79], v[24:27]
    ds_read_b64_tr_b16 a[44:45], v145 offset:4096
    s_cselect_b32 s67, 0, s67
    v_mfma_f32_16x16x32_bf16 v[32:35], a[88:91], a[80:83], v[32:35]
    ds_read_b64_tr_b16 a[46:47], v145 offset:4608
    v_add_u32 v8, s66, v8
    v_mfma_f32_16x16x32_bf16 v[40:43], a[88:91], a[84:87], v[40:43]
    v_add_u32 v9, s66, v9
    v_add_u32 v144, s62, v144
    v_mfma_f32_16x16x32_bf16 v[20:23], a[92:95], a[72:75], v[20:23]
    v_add_u32 v145, s62, v145
    v_mfma_f32_16x16x32_bf16 v[28:31], a[92:95], a[76:79], v[28:31]
    v_mfma_f32_16x16x32_bf16 v[36:39], a[92:95], a[80:83], v[36:39]
    v_mfma_f32_16x16x32_bf16 v[44:47], a[92:95], a[84:87], v[44:47]
    s_waitcnt lgkmcnt(0)
g5_loop:
    s_barrier
    v_mfma_f32_16x16x32_bf16 v[16:19], a[16:19], a[0:3], v[16:19]
    ds_read_b64_tr_b16 a[64:65], v144 offset:0
    ds_read_b64_tr_b16 a[66:67], v144 offset:512
    s_add_u32 s65, s65, 1
    s_cmp_eq_u32 s65, 4
    v_mfma_f32_16x16x32_bf16 v[24:27], a[16:19], a[4:7], v[24:27]
    ds_read_b128 a[48:51], v8 offset:0
    ds_read_b128 a[52:55], v8 offset:2048
    s_mov_b32 s66, 8192
    s_cselect_b32 s66, 4294942720, s66
    v_mfma_f32_16x16x32_bf16 v[32:35], a[16:19], a[8:11], v[32:35]
    ds_read_b128 a[56:59], v8 offset:4096
    ds_read_b128 a[60:63], v8 offset:6144
    s_cselect_b32 s65, 0, s65
    s_add_u32 s67, s67, 1
    v_mfma_f32_16x16x32_bf16 v[40:43], a[16:19], a[12:15], v[40:43]
    ds_read_b64_tr_b16 a[68:69], v145 offset:0
    ds_read_b64_tr_b16 a[70:71], v145 offset:512
    s_cmp_eq_u32 s67, 7
    s_mov_b32 s62, 16384
    v_mfma_f32_16x16x32_bf16 v[20:23], a[20:23], a[0:3], v[20:23]
    ds_read_b64_tr_b16 a[88:89], v144 offset:4096
    ds_read_b64_tr_b16 a[90:91], v144 offset:4608
    s_cselect_b32 s62, 4294868992, s62
    s_cselect_b32 s67, 0, s67
    v_mfma_f32_16x16x32_bf16 v[28:31], a[20:23], a[4:7], v[28:31]
    ds_read_b128 a[72:75], v9 offset:0
    s_add_u32 s64, s64, 2
    v_mfma_f32_16x16x32_bf16 v[36:39], a[20:23], a[8:11], v[36:39]
    ds_read_b128 a[76:79], v9 offset:2048
    v_mfma_f32_16x16x32_bf16 v[44:47], a[20:23], a[12:15], v[44:47]
    ds_read_b128 a[80:83], v9 offset:4096
    v_mfma_f32_16x16x32_bf16 v[16:19], a[40:43], a[24:27], v[16:19]
    ds_read_b128 a[84:87], v9 offset:6144
    v_mfma_f32_16x16x32_bf16 v[24:27], a[40:43], a[28:31], v[24:27]
    ds_read_b64_tr_b16 a[92:93], v145 offset:4096
    v_mfma_f32_16x16x32_bf16 v[32:35], a[40:43], a[32:35], v[32:35]
    ds_read_b64_tr_b16 a[94:95], v145 offset:4608
    v_add_u32 v8, s66, v8
    v_mfma_f32_16x16x32_bf16 v[40:43], a[40:43], a[36:39], v[40:43]
    v_add_u32 v9, s66, v9
    v_add_u32 v144, s62, v144
    v_mfma_f32_16x16x32_bf16 v[20:23], a[44:47], a[24:27], v[20:23]
    v_add_u32 v145, s62, v145
    v_mfma_f32_16x16x32_bf16 v[28:31], a[44:47], a[28:31], v[28:31]
    v_mfma_f32_16x16x32_bf16 v[36:39], a[44:47], a[32:35], v[36:39]
    v_mfma_f32_16x16x32_bf16 v[44:47], a[44:47], a[36:39], v[44:47]
    s_waitcnt lgkmcnt(0)
    s_barrier
    v_mfma_f32_16x16x32_bf16 v[16:19], a[64:67], a[48:51], v[16:19]
    ds_read_b64_tr_b16 a[16:17], v144 offset:0
    ds_read_b64_tr_b16 a[18:19], v144 offset:512
    s_add_u32 s65, s65, 1
    v_mfma_f32_16x16x32_bf16 v[24:27], a[64:67], a[52:55], v[24:27]
    ds_read_b128 a[0:3], v8 offset:0
    ds_read_b128 a[4:7], v8 offset:2048
    s_cmp_eq_u32 s65, 4
    v_mfma_f32_16x16x32_bf16 v[32:35], a[64:67], a[56:59], v[32:35]
    ds_read_b128 a[8:11], v8 offset:4096
    ds_read_b128 a[12:15], v8 offset:6144
    s_mov_b32 s66, 8192
    v_mfma_f32_16x16x32_bf16 v[40:43], a[64:67], a[60:63], v[40:43]
    ds_read_b64_tr_b16 a[20:21], v145 offset:0
    ds_read_b64_tr_b16 a[22:23], v145 offset:512
    s_cselect_b32 s66, 4294942720, s66
    v_mfma_f32_16x16x32_bf16 v[20:23], a[68:71], a[48:51], v[20:23]
    ds_read_b64_tr_b16 a[40:41], v144 offset:4096
    ds_read_b64_tr_b16 a[42:43], v144 offset:4608
    s_cselect_b32 s65, 0, s65
    v_mfma_f32_16x16x32_bf16 v[28:31], a[68:71], a[52:55], v[28:31]
    ds_read_b128 a[24:27], v9 offset:0
    s_add_u32 s67, s67, 1
    v_mfma_f32_16x16x32_bf16 v[36:39], a[68:71], a[56:59], v[36:39]
    ds_read_b128 a[28:31], v9 offset:2048
    s_cmp_eq_u32 s67, 7
    v_mfma_f32_16x16x32_bf16 v[44:47], a[68:71], a[60:63], v[44:47]
    ds_read_b128 a[32:35], v9 offset:4096
    s_mov_b32 s62, 16384
    v_mfma_f32_16x16x32_bf16 v[16:19], a[88:91], a[72:75], v[16:19]
    ds_read_b128 a[36:39], v9 offset:6144
    s_cselect_b32 s62, 4294868992, s62
    v_mfma_f32_16x16x32_bf16 v[24:27], a[88:91], a[76:79], v[24:27]
    ds_read_b64_tr_b16 a[44:45], v145 offset:4096
    s_cselect_b32 s67, 0, s67
    v_mfma_f32_16x16x32_bf16 v[32:35], a[88:91], a[80:83], v[32:35]
    ds_read_b64_tr_b16 a[46:47], v145 offset:4608
    v_add_u32 v8, s66, v8
    v_mfma_f32_16x16x32_bf16 v[40:43], a[88:91], a[84:87], v[40:43]
    v_add_u32 v9, s66, v9
    v_add_u32 v144, s62, v144
    v_mfma_f32_16x16x32_bf16 v[20:23], a[92:95], a[72:75], v[20:23]
    v_add_u32 v145, s62, v145
    v_mfma_f32_16x16x32_bf16 v[28:31], a[92:95], a[76:79], v[28:31]
    v_mfma_f32_16x16x32_bf16 v[36:39], a[92:95], a[80:83], v[36:39]
    v_mfma_f32_16x16x32_bf16 v[44:47], a[92:95], a[84:87], v[44:47]
    s_cmp_lt_u32 s64, 26
    s_waitcnt lgkmcnt(0)
    s_cbranch_scc1 g5_loop
    s_waitcnt vmcnt(0)
    s_mov_b32 s44, s20
    s_and_b32 s45, s21, 0xffff
    s_mov_b32 s46, 4194304
    s_mov_b32 s47, 0x20000
    v_lshlrev_b32 v64, 16, v48
    v_and_b32 v65, 0xffff0000, v48
    v_lshlrev_b32 v66, 16, v49
    v_and_b32 v67, 0xffff0000, v49
    v_lshlrev_b32 v68, 16, v50
    v_and_b32 v69, 0xffff0000, v50
    v_lshlrev_b32 v70, 16, v51
    v_and_b32 v71, 0xffff0000, v51
    v_pk_add_f32 v[16:17], v[16:17], v[64:65]
    v_pk_add_f32 v[18:19], v[18:19], v[66:67]
    v_pk_add_f32 v[20:21], v[20:21], v[68:69]
    v_pk_add_f32 v[22:23], v[22:23], v[70:71]
    v_cvt_pk_bf16_f32 v72, v16, v17
    v_cvt_pk_bf16_f32 v73, v18, v19
    v_cvt_pk_bf16_f32 v74, v20, v21
    v_cvt_pk_bf16_f32 v75, v22, v23
    s_nop 0
    v_permlane16_swap_b32 v72, v74
    v_permlane16_swap_b32 v73, v75
    s_mov_b32 s56, 0
    buffer_store_dwordx4 v[72:75], v15, s[44:47], s56 offen nt
    v_lshlrev_b32 v64, 16, v52
    v_and_b32 v65, 0xffff0000, v52
    v_lshlrev_b32 v66, 16, v53
    v_and_b32 v67, 0xffff0000, v53
    v_lshlrev_b32 v68, 16, v54
    v_and_b32 v69, 0xffff0000, v54
    v_lshlrev_b32 v70, 16, v55
    v_and_b32 v71, 0xffff0000, v55
    v_pk_add_f32 v[24:25], v[24:25], v[64:65]
    v_pk_add_f32 v[26:27], v[26:27], v[66:67]
    v_pk_add_f32 v[28:29], v[28:29], v[68:69]
    v_pk_add_f32 v[30:31], v[30:31], v[70:71]
    v_cvt_pk_bf16_f32 v76, v24, v25
    v_cvt_pk_bf16_f32 v77, v26, v27
    v_cvt_pk_bf16_f32 v78, v28, v29
    v_cvt_pk_bf16_f32 v79, v30, v31
    s_nop 0
    v_permlane16_swap_b32 v76, v78
    v_permlane16_swap_b32 v77, v79
    s_mov_b32 s56, 32768
    buffer_store_dwordx4 v[76:79], v15, s[44:47], s56 offen nt
    v_lshlrev_b32 v64, 16, v56
    v_and_b32 v65, 0xffff0000, v56
    v_lshlrev_b32 v66, 16, v57
    v_and_b32 v67, 0xffff0000, v57
    v_lshlrev_b32 v68, 16, v58
    v_and_b32 v69, 0xffff0000, v58
    v_lshlrev_b32 v70, 16, v59
    v_and_b32 v71, 0xffff0000, v59
    v_pk_add_f32 v[32:33], v[32:33], v[64:65]
    v_pk_add_f32 v[34:35], v[34:35], v[66:67]
    v_pk_add_f32 v[36:37], v[36:37], v[68:69]
    v_pk_add_f32 v[38:39], v[38:39], v[70:71]
    v_cvt_pk_bf16_f32 v80, v32, v33
    v_cvt_pk_bf16_f32 v81, v34, v35
    v_cvt_pk_bf16_f32 v82, v36, v37
    v_cvt_pk_bf16_f32 v83, v38, v39
    s_nop 0
    v_permlane16_swap_b32 v80, v82
    v_permlane16_swap_b32 v81, v83
    s_mov_b32 s56, 65536
    buffer_store_dwordx4 v[80:83], v15, s[44:47], s56 offen nt
    v_lshlrev_b32 v64, 16, v60
    v_and_b32 v65, 0xffff0000, v60
    v_lshlrev_b32 v66, 16, v61
    v_and_b32 v67, 0xffff0000, v61
    v_lshlrev_b32 v68, 16, v62
    v_and_b32 v69, 0xffff0000, v62
    v_lshlrev_b32 v70, 16, v63
    v_and_b32 v71, 0xffff0000, v63
    v_pk_add_f32 v[40:41], v[40:41], v[64:65]
    v_pk_add_f32 v[42:43], v[42:43], v[66:67]
    v_pk_add_f32 v[44:45], v[44:45], v[68:69]
    v_pk_add_f32 v[46:47], v[46:47], v[70:71]
    v_cvt_pk_bf16_f32 v84, v40, v41
    v_cvt_pk_bf16_f32 v85, v42, v43
    v_cvt_pk_bf16_f32 v86, v44, v45
    v_cvt_pk_bf16_f32 v87, v46, v47
    s_nop 0
    v_permlane16_swap_b32 v84, v86
    v_permlane16_swap_b32 v85, v87
    s_mov_b32 s56, 98304
    buffer_store_dwordx4 v[84:87], v15, s[44:47], s56 offen nt
    s_branch mega_fin
mega_prod:
    s_sub_u32 s48, s30, 4
    s_setprio 3
    s_add_u32 s50, s24, 27525120
    s_addc_u32 s51, s25, 0
    s_load_dword s31, s[50:51], 0
    s_mov_b32 s36, s4
    s_and_b32 s37, s5, 0xffff
    s_mov_b32 s38, 4194304
    s_mov_b32 s39, 0x20000
    s_mov_b32 s40, s6
    s_and_b32 s41, s7, 0xffff
    s_mov_b32 s42, 6291456
    s_mov_b32 s43, 0x20000
    v_lshrrev_b32 v2, 3, v1
    v_and_b32 v3, 7, v1
    v_lshrrev_b32 v4, 4, v1
    v_mov_b32 v8, 0
    s_and_b32 s52, s48, 1
    s_lshl_b32 s53, s52, 2
    v_or_b32 v5, s53, v4
    v_xor_b32 v5, v5, v3
    v_lshlrev_b32 v5, 4, v5
    v_lshlrev_b32 v6, 11, v2
    v_add_u32 v10, v6, v5
    s_lshl_b32 s54, s26, 7
    s_lshl_b32 s55, s48, 3
    s_add_u32 s55, s55, s54
    s_add_u32 s55, s55, 16
    s_lshl_b32 s59, s55, 11
    s_sub_i32 s56, s55, 32
    s_max_i32 s56, s56, 0
    s_sub_u32 s56, s56, s55
    s_lshl_b32 s66, s56, 11
    s_lshl_b32 s56, s52, 3
    s_add_u32 s56, s56, s54
    s_add_u32 s56, s56, 112
    s_sub_u32 s56, s56, s55
    s_lshl_b32 s67, s56, 11
    v_mul_u32_u24 v6, 6144, v2
    v_and_b32 v7, 1, v4
    v_lshlrev_b32 v7, 1, v7
    v_xor_b32 v7, v7, v3
    v_lshlrev_b32 v5, 4, v7
    v_add_u32 v15, v6, v5
    v_xor_b32 v7, 4, v7
    v_lshlrev_b32 v5, 4, v7
    v_add_u32 v16, v6, v5
    s_mul_i32 s63, s48, 98304
    s_lshl_b32 s56, s3, 7
    s_add_u32 s63, s63, s56
    s_lshl_b32 s58, s48, 10
    s_and_b32 s65, s48, 1
    s_add_u32 s65, s65, 16
    s_lshl_b32 s65, s65, 10
    s_lshl_b32 s64, s48, 11
    s_mov_b32 s62, 0
    s_lshl_b32 s60, s62, 7
    s_add_u32 s60, s60, s59
    s_mul_i32 s61, s62, 393216
    s_add_u32 s61, s61, s63
    s_add_u32 m0, s58, 8192
    s_add_u32 s57, s60, s66
    buffer_load_dwordx4 v10, s[36:39], s57 offen lds
    s_add_u32 m0, s58, 12288
    s_nop 0
    buffer_load_dwordx4 v10, s[36:39], s60 offen lds
    s_add_u32 m0, s58, 16384
    s_add_u32 s57, s60, 65536
    buffer_load_dwordx4 v10, s[36:39], s57 offen lds
    s_add_u32 m0, s58, 20480
    s_add_u32 s57, s60, 131072
    buffer_load_dwordx4 v10, s[36:39], s57 offen lds
    s_add_u32 m0, s65, 8192
    s_add_u32 s57, s60, s67
    buffer_load_dwordx4 v10, s[36:39], s57 offen lds
    s_add_u32 s60, s60, 128
    s_sub_u32 s57, s60, s59
    s_cmp_eq_u32 s57, 2048
    s_cselect_b32 s60, s59, s60
    s_add_u32 m0, s64, 63488
    s_nop 0
    buffer_load_dwordx4 v15, s[40:43], s61 offen lds
    s_add_u32 m0, s64, 64512
    s_add_u32 s57, s61, 49152
    buffer_load_dwordx4 v16, s[40:43], s57 offen lds
    s_add_u32 m0, s64, 71680
    s_add_u32 s57, s61, 2048
    buffer_load_dwordx4 v15, s[40:43], s57 offen lds
    s_add_u32 m0, s64, 72704
    s_add_u32 s57, s61, 51200
    buffer_load_dwordx4 v16, s[40:43], s57 offen lds
    s_add_u32 m0, s64, 79872
    s_add_u32 s57, s61, 4096
    buffer_load_dwordx4 v15, s[40:43], s57 offen lds
    s_add_u32 m0, s64, 80896
    s_add_u32 s57, s61, 53248
    buffer_load_dwordx4 v16, s[40:43], s57 offen lds
    s_add_u32 s61, s61, 393216
    s_sub_u32 s57, s61, s63
    s_cmp_eq_u32 s57, 6291456
    s_cselect_b32 s61, s63, s61
    s_add_u32 m0, s58, 26624
    s_add_u32 s57, s60, s66
    buffer_load_dwordx4 v10, s[36:39], s57 offen lds
    s_add_u32 m0, s58, 30720
    s_nop 0
    buffer_load_dwordx4 v10, s[36:39], s60 offen lds
    s_add_u32 m0, s58, 34816
    s_add_u32 s57, s60, 65536
    buffer_load_dwordx4 v10, s[36:39], s57 offen lds
    s_add_u32 m0, s58, 38912
    s_add_u32 s57, s60, 131072
    buffer_load_dwordx4 v10, s[36:39], s57 offen lds
    s_add_u32 m0, s65, 26624
    s_add_u32 s57, s60, s67
    buffer_load_dwordx4 v10, s[36:39], s57 offen lds
    s_add_u32 s60, s60, 128
    s_sub_u32 s57, s60, s59
    s_cmp_eq_u32 s57, 2048
    s_cselect_b32 s60, s59, s60
    s_add_u32 m0, s64, 88064
    s_nop 0
    buffer_load_dwordx4 v15, s[40:43], s61 offen lds
    s_add_u32 m0, s64, 89088
    s_add_u32 s57, s61, 49152
    buffer_load_dwordx4 v16, s[40:43], s57 offen lds
    s_add_u32 m0, s64, 96256
    s_add_u32 s57, s61, 2048
    buffer_load_dwordx4 v15, s[40:43], s57 offen lds
    s_add_u32 m0, s64, 97280
    s_add_u32 s57, s61, 51200
    buffer_load_dwordx4 v16, s[40:43], s57 offen lds
    s_add_u32 m0, s64, 104448
    s_add_u32 s57, s61, 4096
    buffer_load_dwordx4 v15, s[40:43], s57 offen lds
    s_add_u32 m0, s64, 105472
    s_add_u32 s57, s61, 53248
    buffer_load_dwordx4 v16, s[40:43], s57 offen lds
    s_add_u32 s61, s61, 393216
    s_sub_u32 s57, s61, s63
    s_cmp_eq_u32 s57, 6291456
    s_cselect_b32 s61, s63, s61
    s_add_u32 m0, s58, 45056
    s_add_u32 s57, s60, s66
    buffer_load_dwordx4 v10, s[36:39], s57 offen lds
    s_add_u32 m0, s58, 49152
    s_nop 0
    buffer_load_dwordx4 v10, s[36:39], s60 offen lds
    s_add_u32 m0, s58, 53248
    s_add_u32 s57, s60, 65536
    buffer_load_dwordx4 v10, s[36:39], s57 offen lds
    s_add_u32 m0, s58, 57344
    s_add_u32 s57, s60, 131072
    buffer_load_dwordx4 v10, s[36:39], s57 offen lds
    s_add_u32 m0, s65, 45056
    s_add_u32 s57, s60, s67
    buffer_load_dwordx4 v10, s[36:39], s57 offen lds
    s_add_u32 s60, s60, 128
    s_sub_u32 s57, s60, s59
    s_cmp_eq_u32 s57, 2048
    s_cselect_b32 s60, s59, s60
    s_add_u32 m0, s64, 112640
    s_nop 0
    buffer_load_dwordx4 v15, s[40:43], s61 offen lds
    s_add_u32 m0, s64, 113664
    s_add_u32 s57, s61, 49152
    buffer_load_dwordx4 v16, s[40:43], s57 offen lds
    s_add_u32 m0, s64, 120832
    s_add_u32 s57, s61, 2048
    buffer_load_dwordx4 v15, s[40:43], s57 offen lds
    s_add_u32 m0, s64, 121856
    s_add_u32 s57, s61, 51200
    buffer_load_dwordx4 v16, s[40:43], s57 offen lds
    s_add_u32 m0, s64, 129024
    s_add_u32 s57, s61, 4096
    buffer_load_dwordx4 v15, s[40:43], s57 offen lds
    s_add_u32 m0, s64, 130048
    s_add_u32 s57, s61, 53248
    buffer_load_dwordx4 v16, s[40:43], s57 offen lds
    s_add_u32 s61, s61, 393216
    s_sub_u32 s57, s61, s63
    s_cmp_eq_u32 s57, 6291456
    s_cselect_b32 s61, s63, s61
    s_lshl_b32 s52, s26, 7
    s_lshl_b32 s53, s27, 3
    s_add_u32 s52, s52, s53
    s_lshl_b32 s53, s48, 1
    s_add_u32 s70, s52, s53
    s_lshl_b32 s52, s70, 11
    v_lshlrev_b32 v21, 4, v1
    buffer_load_dwordx4 v[24:27], v21, s[36:39], s52 offen offset:0
    buffer_load_dwordx4 v[28:31], v21, s[36:39], s52 offen offset:1024
    buffer_load_dwordx4 v[32:35], v21, s[36:39], s52 offen offset:2048
    buffer_load_dwordx4 v[36:39], v21, s[36:39], s52 offen offset:3072
    s_min_u32 s71, s48, 2
    s_lshl_b32 s52, s71, 11
    s_lshl_b32 s53, s3, 7
    s_add_u32 s55, s52, s53
    s_lshl_b32 s52, s27, 4
    s_add_u32 s52, s52, s26
    s_mul_i32 s52, s52, 768
    s_lshl_b32 s53, s71, 8
    s_add_u32 s52, s52, s53
    s_add_u32 s71, s52, 25231360
    s_lshl_b32 s52, s26, 6
    s_mov_b32 s56, 6144
    v_add_u32 v22, s52, v2
    v_mul_lo_u32 v22, v22, s56
    v_lshlrev_b32 v23, 4, v3
    v_add_u32 v22, v22, v23
    s_lshl_b32 s53, s56, 3
    s_mov_b32 s54, s55
    buffer_load_dwordx4 v[64:67], v22, s[40:43], s54 offen
    s_add_u32 s54, s54, s53
    buffer_load_dwordx4 v[68:71], v22, s[40:43], s54 offen
    s_add_u32 s54, s54, s53
    buffer_load_dwordx4 v[72:75], v22, s[40:43], s54 offen
    s_add_u32 s54, s54, s53
    buffer_load_dwordx4 v[76:79], v22, s[40:43], s54 offen
    s_add_u32 s54, s54, s53
    buffer_load_dwordx4 v[80:83], v22, s[40:43], s54 offen
    s_add_u32 s54, s54, s53
    buffer_load_dwordx4 v[84:87], v22, s[40:43], s54 offen
    s_add_u32 s54, s54, s53
    buffer_load_dwordx4 v[88:91], v22, s[40:43], s54 offen
    s_add_u32 s54, s54, s53
    buffer_load_dwordx4 v[92:95], v22, s[40:43], s54 offen
    s_waitcnt vmcnt(40)
    s_waitcnt vmcnt(34)
    s_barrier
    s_waitcnt vmcnt(29)
    s_waitcnt vmcnt(23)
    s_barrier
    s_add_u32 m0, s58, 8192
    s_add_u32 s57, s60, s66
    buffer_load_dwordx4 v10, s[36:39], s57 offen lds
    s_add_u32 m0, s58, 12288
    s_nop 0
    buffer_load_dwordx4 v10, s[36:39], s60 offen lds
    s_add_u32 m0, s58, 16384
    s_add_u32 s57, s60, 65536
    buffer_load_dwordx4 v10, s[36:39], s57 offen lds
    s_add_u32 m0, s58, 20480
    s_add_u32 s57, s60, 131072
    buffer_load_dwordx4 v10, s[36:39], s57 offen lds
    s_add_u32 m0, s65, 8192
    s_add_u32 s57, s60, s67
    buffer_load_dwordx4 v10, s[36:39], s57 offen lds
    s_add_u32 s60, s60, 128
    s_sub_u32 s57, s60, s59
    s_cmp_eq_u32 s57, 2048
    s_cselect_b32 s60, s59, s60
    s_add_u32 m0, s64, 63488
    s_nop 0
    buffer_load_dwordx4 v15, s[40:43], s61 offen lds
    s_add_u32 m0, s64, 64512
    s_add_u32 s57, s61, 49152
    buffer_load_dwordx4 v16, s[40:43], s57 offen lds
    s_add_u32 m0, s64, 71680
    s_add_u32 s57, s61, 2048
    buffer_load_dwordx4 v15, s[40:43], s57 offen lds
    s_add_u32 m0, s64, 72704
    s_add_u32 s57, s61, 51200
    buffer_load_dwordx4 v16, s[40:43], s57 offen lds
    s_add_u32 m0, s64, 79872
    s_add_u32 s57, s61, 4096
    buffer_load_dwordx4 v15, s[40:43], s57 offen lds
    s_add_u32 m0, s64, 80896
    s_add_u32 s57, s61, 53248
    buffer_load_dwordx4 v16, s[40:43], s57 offen lds
    s_add_u32 s61, s61, 393216
    s_sub_u32 s57, s61, s63
    s_cmp_eq_u32 s57, 6291456
    s_cselect_b32 s61, s63, s61
    s_waitcnt vmcnt(29)
    s_waitcnt vmcnt(23)
    s_barrier
    s_add_u32 m0, s58, 26624
    s_add_u32 s57, s60, s66
    buffer_load_dwordx4 v10, s[36:39], s57 offen lds
    s_add_u32 m0, s58, 30720
    s_nop 0
    buffer_load_dwordx4 v10, s[36:39], s60 offen lds
    s_add_u32 m0, s58, 34816
    s_add_u32 s57, s60, 65536
    buffer_load_dwordx4 v10, s[36:39], s57 offen lds
    s_add_u32 m0, s58, 38912
    s_add_u32 s57, s60, 131072
    buffer_load_dwordx4 v10, s[36:39], s57 offen lds
    s_add_u32 m0, s65, 26624
    s_add_u32 s57, s60, s67
    buffer_load_dwordx4 v10, s[36:39], s57 offen lds
    s_add_u32 s60, s60, 128
    s_sub_u32 s57, s60, s59
    s_cmp_eq_u32 s57, 2048
    s_cselect_b32 s60, s59, s60
    s_add_u32 m0, s64, 88064
    s_nop 0
    buffer_load_dwordx4 v15, s[40:43], s61 offen lds
    s_add_u32 m0, s64, 89088
    s_add_u32 s57, s61, 49152
    buffer_load_dwordx4 v16, s[40:43], s57 offen lds
    s_add_u32 m0, s64, 96256
    s_add_u32 s57, s61, 2048
    buffer_load_dwordx4 v15, s[40:43], s57 offen lds
    s_add_u32 m0, s64, 97280
    s_add_u32 s57, s61, 51200
    buffer_load_dwordx4 v16, s[40:43], s57 offen lds
    s_add_u32 m0, s64, 104448
    s_add_u32 s57, s61, 4096
    buffer_load_dwordx4 v15, s[40:43], s57 offen lds
    s_add_u32 m0, s64, 105472
    s_add_u32 s57, s61, 53248
    buffer_load_dwordx4 v16, s[40:43], s57 offen lds
    s_add_u32 s61, s61, 393216
    s_sub_u32 s57, s61, s63
    s_cmp_eq_u32 s57, 6291456
    s_cselect_b32 s61, s63, s61
    s_waitcnt vmcnt(17)
    s_waitcnt vmcnt(11)
    s_barrier
    s_add_u32 m0, s58, 45056
    s_add_u32 s57, s60, s66
    buffer_load_dwordx4 v10, s[36:39], s57 offen lds
    s_add_u32 m0, s58, 49152
    s_nop 0
    buffer_load_dwordx4 v10, s[36:39], s60 offen lds
    s_add_u32 m0, s58, 53248
    s_add_u32 s57, s60, 65536
    buffer_load_dwordx4 v10, s[36:39], s57 offen lds
    s_add_u32 m0, s58, 57344
    s_add_u32 s57, s60, 131072
    buffer_load_dwordx4 v10, s[36:39], s57 offen lds
    s_add_u32 m0, s65, 45056
    s_add_u32 s57, s60, s67
    buffer_load_dwordx4 v10, s[36:39], s57 offen lds
    s_add_u32 s60, s60, 128
    s_sub_u32 s57, s60, s59
    s_cmp_eq_u32 s57, 2048
    s_cselect_b32 s60, s59, s60
    s_add_u32 m0, s64, 112640
    s_nop 0
    buffer_load_dwordx4 v15, s[40:43], s61 offen lds
    s_add_u32 m0, s64, 113664
    s_add_u32 s57, s61, 49152
    buffer_load_dwordx4 v16, s[40:43], s57 offen lds
    s_add_u32 m0, s64, 120832
    s_add_u32 s57, s61, 2048
    buffer_load_dwordx4 v15, s[40:43], s57 offen lds
    s_add_u32 m0, s64, 121856
    s_add_u32 s57, s61, 51200
    buffer_load_dwordx4 v16, s[40:43], s57 offen lds
    s_add_u32 m0, s64, 129024
    s_add_u32 s57, s61, 4096
    buffer_load_dwordx4 v15, s[40:43], s57 offen lds
    s_add_u32 m0, s64, 130048
    s_add_u32 s57, s61, 53248
    buffer_load_dwordx4 v16, s[40:43], s57 offen lds
    s_add_u32 s61, s61, 393216
    s_sub_u32 s57, s61, s63
    s_cmp_eq_u32 s57, 6291456
    s_cselect_b32 s61, s63, s61
    s_waitcnt lgkmcnt(0)
    s_mul_i32 s31, s31, 1664525
    s_add_u32 s31, s31, 1013904223
    s_mov_b32 s52, 0x3f803f80
    v_mov_b32 v40, 0
    v_mov_b32 v42, 0
    v_mov_b32 v41, 0
    v_mov_b32 v43, 0
    v_dot2c_f32_bf16 v40, s52, v24
    v_dot2c_f32_bf16 v42, v24, v24
    v_dot2c_f32_bf16 v41, s52, v32
    v_dot2c_f32_bf16 v43, v32, v32
    v_dot2c_f32_bf16 v40, s52, v25
    v_dot2c_f32_bf16 v42, v25, v25
    v_dot2c_f32_bf16 v41, s52, v33
    v_dot2c_f32_bf16 v43, v33, v33
    v_dot2c_f32_bf16 v40, s52, v26
    v_dot2c_f32_bf16 v42, v26, v26
    v_dot2c_f32_bf16 v41, s52, v34
    v_dot2c_f32_bf16 v43, v34, v34
    v_dot2c_f32_bf16 v40, s52, v27
    v_dot2c_f32_bf16 v42, v27, v27
    v_dot2c_f32_bf16 v41, s52, v35
    v_dot2c_f32_bf16 v43, v35, v35
    v_dot2c_f32_bf16 v40, s52, v28
    v_dot2c_f32_bf16 v42, v28, v28
    v_dot2c_f32_bf16 v41, s52, v36
    v_dot2c_f32_bf16 v43, v36, v36
    v_dot2c_f32_bf16 v40, s52, v29
    v_dot2c_f32_bf16 v42, v29, v29
    v_dot2c_f32_bf16 v41, s52, v37
    v_dot2c_f32_bf16 v43, v37, v37
    v_dot2c_f32_bf16 v40, s52, v30
    v_dot2c_f32_bf16 v42, v30, v30
    v_dot2c_f32_bf16 v41, s52, v38
    v_dot2c_f32_bf16 v43, v38, v38
    v_dot2c_f32_bf16 v40, s52, v31
    v_dot2c_f32_bf16 v42, v31, v31
    v_dot2c_f32_bf16 v41, s52, v39
    v_dot2c_f32_bf16 v43, v39, v39
    s_waitcnt vmcnt(17)
    s_waitcnt vmcnt(11)
    s_barrier
    s_add_u32 m0, s58, 8192
    s_add_u32 s57, s60, s66
    buffer_load_dwordx4 v10, s[36:39], s57 offen lds
    s_add_u32 m0, s58, 12288
    s_nop 0
    buffer_load_dwordx4 v10, s[36:39], s60 offen lds
    s_add_u32 m0, s58, 16384
    s_add_u32 s57, s60, 65536
    buffer_load_dwordx4 v10, s[36:39], s57 offen lds
    s_add_u32 m0, s58, 20480
    s_add_u32 s57, s60, 131072
    buffer_load_dwordx4 v10, s[36:39], s57 offen lds
    s_add_u32 m0, s65, 8192
    s_add_u32 s57, s60, s67
    buffer_load_dwordx4 v10, s[36:39], s57 offen lds
    s_add_u32 s60, s60, 128
    s_sub_u32 s57, s60, s59
    s_cmp_eq_u32 s57, 2048
    s_cselect_b32 s60, s59, s60
    s_add_u32 m0, s64, 63488
    s_nop 0
    buffer_load_dwordx4 v15, s[40:43], s61 offen lds
    s_add_u32 m0, s64, 64512
    s_add_u32 s57, s61, 49152
    buffer_load_dwordx4 v16, s[40:43], s57 offen lds
    s_add_u32 m0, s64, 71680
    s_add_u32 s57, s61, 2048
    buffer_load_dwordx4 v15, s[40:43], s57 offen lds
    s_add_u32 m0, s64, 72704
    s_add_u32 s57, s61, 51200
    buffer_load_dwordx4 v16, s[40:43], s57 offen lds
    s_add_u32 m0, s64, 79872
    s_add_u32 s57, s61, 4096
    buffer_load_dwordx4 v15, s[40:43], s57 offen lds
    s_add_u32 m0, s64, 80896
    s_add_u32 s57, s61, 53248
    buffer_load_dwordx4 v16, s[40:43], s57 offen lds
    s_add_u32 s61, s61, 393216
    s_sub_u32 s57, s61, s63
    s_cmp_eq_u32 s57, 6291456
    s_cselect_b32 s61, s63, s61
    v_mov_b32 v44, v40
    v_mov_b32 v45, v41
    v_mov_b32 v46, v42
    v_mov_b32 v47, v43
    v_permlane32_swap_b32 v40, v44
    v_permlane32_swap_b32 v41, v45
    v_permlane32_swap_b32 v42, v46
    v_permlane32_swap_b32 v43, v47
    v_add_f32 v40, v40, v44
    v_add_f32 v41, v41, v45
    v_add_f32 v42, v42, v46
    v_add_f32 v43, v43, v47
    v_mov_b32 v44, v40
    v_mov_b32 v45, v41
    v_mov_b32 v46, v42
    v_mov_b32 v47, v43
    v_permlane16_swap_b32 v40, v44
    v_permlane16_swap_b32 v41, v45
    v_permlane16_swap_b32 v42, v46
    v_permlane16_swap_b32 v43, v47
    v_add_f32 v40, v40, v44
    v_add_f32 v41, v41, v45
    v_add_f32 v42, v42, v46
    v_add_f32 v43, v43, v47
    v_add_f32_dpp v40, v40, v40 row_ror:8 row_mask:0xf bank_mask:0xf
    v_add_f32_dpp v41, v41, v41 row_ror:8 row_mask:0xf bank_mask:0xf
    v_add_f32_dpp v42, v42, v42 row_ror:8 row_mask:0xf bank_mask:0xf
    v_add_f32_dpp v43, v43, v43 row_ror:8 row_mask:0xf bank_mask:0xf
    v_add_f32_dpp v40, v40, v40 row_ror:4 row_mask:0xf bank_mask:0xf
    v_add_f32_dpp v41, v41, v41 row_ror:4 row_mask:0xf bank_mask:0xf
    v_add_f32_dpp v42, v42, v42 row_ror:4 row_mask:0xf bank_mask:0xf
    v_add_f32_dpp v43, v43, v43 row_ror:4 row_mask:0xf bank_mask:0xf
    v_add_f32_dpp v40, v40, v40 row_ror:2 row_mask:0xf bank_mask:0xf
    v_add_f32_dpp v41, v41, v41 row_ror:2 row_mask:0xf bank_mask:0xf
    v_add_f32_dpp v42, v42, v42 row_ror:2 row_mask:0xf bank_mask:0xf
    v_add_f32_dpp v43, v43, v43 row_ror:2 row_mask:0xf bank_mask:0xf
    v_add_f32_dpp v40, v40, v40 row_ror:1 row_mask:0xf bank_mask:0xf
    v_add_f32_dpp v41, v41, v41 row_ror:1 row_mask:0xf bank_mask:0xf
    v_add_f32_dpp v42, v42, v42 row_ror:1 row_mask:0xf bank_mask:0xf
    v_add_f32_dpp v43, v43, v43 row_ror:1 row_mask:0xf bank_mask:0xf
    s_mov_b32 s52, 0x00003f80
    s_mov_b32 s53, 0x3f800000
    v_lshlrev_b32 v96, 16, v64
    v_and_b32 v97, 0xffff0000, v64
    v_lshlrev_b32 v98, 16, v65
    v_and_b32 v99, 0xffff0000, v65
    v_lshlrev_b32 v100, 16, v66
    v_and_b32 v101, 0xffff0000, v66
    v_lshlrev_b32 v102, 16, v67
    v_and_b32 v103, 0xffff0000, v67
    v_dot2c_f32_bf16 v96, s52, v68
    v_dot2c_f32_bf16 v97, s53, v68
    v_dot2c_f32_bf16 v98, s52, v69
    v_dot2c_f32_bf16 v99, s53, v69
    v_dot2c_f32_bf16 v100, s52, v70
    v_dot2c_f32_bf16 v101, s53, v70
    v_dot2c_f32_bf16 v102, s52, v71
    v_dot2c_f32_bf16 v103, s53, v71
    s_waitcnt vmcnt(17)
    s_waitcnt vmcnt(11)
    s_barrier
    s_add_u32 m0, s58, 26624
    s_add_u32 s57, s60, s66
    buffer_load_dwordx4 v10, s[36:39], s57 offen lds
    s_add_u32 m0, s58, 30720
    s_nop 0
    buffer_load_dwordx4 v10, s[36:39], s60 offen lds
    s_add_u32 m0, s58, 34816
    s_add_u32 s57, s60, 65536
    buffer_load_dwordx4 v10, s[36:39], s57 offen lds
    s_add_u32 m0, s58, 38912
    s_add_u32 s57, s60, 131072
    buffer_load_dwordx4 v10, s[36:39], s57 offen lds
    s_add_u32 m0, s65, 26624
    s_add_u32 s57, s60, s67
    buffer_load_dwordx4 v10, s[36:39], s57 offen lds
    s_add_u32 s60, s60, 128
    s_sub_u32 s57, s60, s59
    s_cmp_eq_u32 s57, 2048
    s_cselect_b32 s60, s59, s60
    s_add_u32 m0, s64, 88064
    s_nop 0
    buffer_load_dwordx4 v15, s[40:43], s61 offen lds
    s_add_u32 m0, s64, 89088
    s_add_u32 s57, s61, 49152
    buffer_load_dwordx4 v16, s[40:43], s57 offen lds
    s_add_u32 m0, s64, 96256
    s_add_u32 s57, s61, 2048
    buffer_load_dwordx4 v15, s[40:43], s57 offen lds
    s_add_u32 m0, s64, 97280
    s_add_u32 s57, s61, 51200
    buffer_load_dwordx4 v16, s[40:43], s57 offen lds
    s_add_u32 m0, s64, 104448
    s_add_u32 s57, s61, 4096
    buffer_load_dwordx4 v15, s[40:43], s57 offen lds
    s_add_u32 m0, s64, 105472
    s_add_u32 s57, s61, 53248
    buffer_load_dwordx4 v16, s[40:43], s57 offen lds
    s_add_u32 s61, s61, 393216
    s_sub_u32 s57, s61, s63
    s_cmp_eq_u32 s57, 6291456
    s_cselect_b32 s61, s63, s61
    s_mov_b32 s52, 981467136
    s_mov_b32 s53, 925353388
    v_mul_f32 v40, s52, v40
    v_mul_f32 v42, s52, v42
    v_fma_f32 v42, -v40, v40, v42
    v_max_f32 v42, 0, v42
    v_add_f32 v42, s53, v42
    v_rsq_f32 v42, v42
    s_nop 0
    v_mul_f32 v40, v40, v42
    v_sub_f32 v40, 0, v40
    v_mul_f32 v41, s52, v41
    v_mul_f32 v43, s52, v43
    v_fma_f32 v43, -v41, v41, v43
    v_max_f32 v43, 0, v43
    v_add_f32 v43, s53, v43
    v_rsq_f32 v43, v43
    s_nop 0
    v_mul_f32 v41, v41, v43
    v_sub_f32 v41, 0, v41
    v_cmp_eq_u32 vcc, 1, v1
    s_nop 1
    v_cndmask_b32 v44, v42, v43, vcc
    v_cmp_eq_u32 vcc, 2, v1
    s_nop 1
    v_cndmask_b32 v44, v44, v40, vcc
    v_cmp_eq_u32 vcc, 3, v1
    s_nop 1
    v_cndmask_b32 v44, v44, v41, vcc
    v_and_b32 v45, 1, v1
    v_lshlrev_b32 v45, 2, v45
    v_lshrrev_b32 v46, 1, v1
    v_lshlrev_b32 v46, 13, v46
    v_add_u32 v45, v45, v46
    s_lshl_b32 s52, s70, 2
    s_add_u32 s52, s52, 25165824
    s_mov_b64 s[54:55], exec
    s_mov_b64 exec, 15
    buffer_store_dword v44, v45, s[32:35], s52 offen sc1
    s_mov_b64 exec, s[54:55]
    v_mov_b32 v44, -1
    v_lshrrev_b32 v45, 2, v1
    v_lshlrev_b32 v45, 14, v45
    v_and_b32 v46, 3, v1
    v_lshlrev_b32 v46, 2, v46
    v_add_u32 v45, v45, v46
    s_lshl_b32 s52, s70, 3
    s_add_u32 s52, s52, 26476544
    buffer_store_dword v44, v45, s[32:35], s52 offen sc1
    s_mov_b32 s52, 0x00003f80
    s_mov_b32 s53, 0x3f800000
    v_dot2c_f32_bf16 v96, s52, v72
    v_dot2c_f32_bf16 v97, s53, v72
    v_dot2c_f32_bf16 v98, s52, v73
    v_dot2c_f32_bf16 v99, s53, v73
    v_dot2c_f32_bf16 v100, s52, v74
    v_dot2c_f32_bf16 v101, s53, v74
    v_dot2c_f32_bf16 v102, s52, v75
    v_dot2c_f32_bf16 v103, s53, v75
    v_dot2c_f32_bf16 v96, s52, v76
    v_dot2c_f32_bf16 v97, s53, v76
    v_dot2c_f32_bf16 v98, s52, v77
    v_dot2c_f32_bf16 v99, s53, v77
    v_dot2c_f32_bf16 v100, s52, v78
    v_dot2c_f32_bf16 v101, s53, v78
    v_dot2c_f32_bf16 v102, s52, v79
    v_dot2c_f32_bf16 v103, s53, v79
    v_dot2c_f32_bf16 v96, s52, v80
    v_dot2c_f32_bf16 v97, s53, v80
    v_dot2c_f32_bf16 v98, s52, v81
    v_dot2c_f32_bf16 v99, s53, v81
    v_dot2c_f32_bf16 v100, s52, v82
    v_dot2c_f32_bf16 v101, s53, v82
    v_dot2c_f32_bf16 v102, s52, v83
    v_dot2c_f32_bf16 v103, s53, v83
    s_waitcnt vmcnt(19)
    s_waitcnt vmcnt(13)
    s_barrier
    s_add_u32 m0, s58, 45056
    s_add_u32 s57, s60, s66
    buffer_load_dwordx4 v10, s[36:39], s57 offen lds
    s_add_u32 m0, s58, 49152
    s_nop 0
    buffer_load_dwordx4 v10, s[36:39], s60 offen lds
    s_add_u32 m0, s58, 53248
    s_add_u32 s57, s60, 65536
    buffer_load_dwordx4 v10, s[36:39], s57 offen lds
    s_add_u32 m0, s58, 57344
    s_add_u32 s57, s60, 131072
    buffer_load_dwordx4 v10, s[36:39], s57 offen lds
    s_add_u32 m0, s65, 45056
    s_add_u32 s57, s60, s67
    buffer_load_dwordx4 v10, s[36:39], s57 offen lds
    s_add_u32 s60, s60, 128
    s_sub_u32 s57, s60, s59
    s_cmp_eq_u32 s57, 2048
    s_cselect_b32 s60, s59, s60
    s_add_u32 m0, s64, 112640
    s_nop 0
    buffer_load_dwordx4 v15, s[40:43], s61 offen lds
    s_add_u32 m0, s64, 113664
    s_add_u32 s57, s61, 49152
    buffer_load_dwordx4 v16, s[40:43], s57 offen lds
    s_add_u32 m0, s64, 120832
    s_add_u32 s57, s61, 2048
    buffer_load_dwordx4 v15, s[40:43], s57 offen lds
    s_add_u32 m0, s64, 121856
    s_add_u32 s57, s61, 51200
    buffer_load_dwordx4 v16, s[40:43], s57 offen lds
    s_add_u32 m0, s64, 129024
    s_add_u32 s57, s61, 4096
    buffer_load_dwordx4 v15, s[40:43], s57 offen lds
    s_add_u32 m0, s64, 130048
    s_add_u32 s57, s61, 53248
    buffer_load_dwordx4 v16, s[40:43], s57 offen lds
    s_add_u32 s61, s61, 393216
    s_sub_u32 s57, s61, s63
    s_cmp_eq_u32 s57, 6291456
    s_cselect_b32 s61, s63, s61
    s_mov_b32 s52, 0x00003f80
    s_mov_b32 s53, 0x3f800000
    v_dot2c_f32_bf16 v96, s52, v84
    v_dot2c_f32_bf16 v97, s53, v84
    v_dot2c_f32_bf16 v98, s52, v85
    v_dot2c_f32_bf16 v99, s53, v85
    v_dot2c_f32_bf16 v100, s52, v86
    v_dot2c_f32_bf16 v101, s53, v86
    v_dot2c_f32_bf16 v102, s52, v87
    v_dot2c_f32_bf16 v103, s53, v87
    v_dot2c_f32_bf16 v96, s52, v88
    v_dot2c_f32_bf16 v97, s53, v88
    v_dot2c_f32_bf16 v98, s52, v89
    v_dot2c_f32_bf16 v99, s53, v89
    v_dot2c_f32_bf16 v100, s52, v90
    v_dot2c_f32_bf16 v101, s53, v90
    v_dot2c_f32_bf16 v102, s52, v91
    v_dot2c_f32_bf16 v103, s53, v91
    v_dot2c_f32_bf16 v96, s52, v92
    v_dot2c_f32_bf16 v97, s53, v92
    v_dot2c_f32_bf16 v98, s52, v93
    v_dot2c_f32_bf16 v99, s53, v93
    v_dot2c_f32_bf16 v100, s52, v94
    v_dot2c_f32_bf16 v101, s53, v94
    v_dot2c_f32_bf16 v102, s52, v95
    v_dot2c_f32_bf16 v103, s53, v95
    v_permlane32_swap_b32 v96, v97
    v_permlane32_swap_b32 v98, v99
    v_permlane32_swap_b32 v100, v101
    v_permlane32_swap_b32 v102, v103
    v_add_f32 v104, v96, v97
    v_add_f32 v105, v98, v99
    v_add_f32 v106, v100, v101
    v_add_f32 v107, v102, v103
    v_permlane16_swap_b32 v104, v105
    s_nop 0
    v_permlane16_swap_b32 v106, v107
    v_add_f32 v96, v104, v105
    v_add_f32 v97, v106, v107
    s_nop 0
    v_add_f32_dpp v96, v96, v96 row_ror:8 row_mask:0xf bank_mask:0xf
    v_add_f32_dpp v97, v97, v97 row_ror:8 row_mask:0xf bank_mask:0xf
    v_lshrrev_b32 v98, 4, v1
    v_and_b32 v99, 1, v98
    v_lshlrev_b32 v99, 1, v99
    v_lshrrev_b32 v98, 1, v98
    v_or_b32 v98, v98, v99
    v_lshlrev_b32 v99, 3, v3
    v_add_u32 v98, v98, v99
    v_and_b32 v99, 8, v1
    v_lshrrev_b32 v100, 1, v99
    v_add_u32 v98, v98, v100
    v_lshlrev_b32 v98, 2, v98
    v_cmp_ne_u32 vcc, 0, v99
    s_nop 1
    v_cndmask_b32 v96, v96, v97, vcc
    buffer_store_dword v96, v98, s[32:35], s71 offen sc1
    s_waitcnt vmcnt(20)
    s_waitcnt vmcnt(14)
    s_barrier
    s_add_u32 m0, s58, 8192
    s_add_u32 s57, s60, s66
    buffer_load_dwordx4 v10, s[36:39], s57 offen lds
    s_add_u32 m0, s58, 12288
    s_nop 0
    buffer_load_dwordx4 v10, s[36:39], s60 offen lds
    s_add_u32 m0, s58, 16384
    s_add_u32 s57, s60, 65536
    buffer_load_dwordx4 v10, s[36:39], s57 offen lds
    s_add_u32 m0, s58, 20480
    s_add_u32 s57, s60, 131072
    buffer_load_dwordx4 v10, s[36:39], s57 offen lds
    s_add_u32 m0, s65, 8192
    s_add_u32 s57, s60, s67
    buffer_load_dwordx4 v10, s[36:39], s57 offen lds
    s_add_u32 s60, s60, 128
    s_sub_u32 s57, s60, s59
    s_cmp_eq_u32 s57, 2048
    s_cselect_b32 s60, s59, s60
    s_add_u32 m0, s64, 63488
    s_nop 0
    buffer_load_dwordx4 v15, s[40:43], s61 offen lds
    s_add_u32 m0, s64, 64512
    s_add_u32 s57, s61, 49152
    buffer_load_dwordx4 v16, s[40:43], s57 offen lds
    s_add_u32 m0, s64, 71680
    s_add_u32 s57, s61, 2048
    buffer_load_dwordx4 v15, s[40:43], s57 offen lds
    s_add_u32 m0, s64, 72704
    s_add_u32 s57, s61, 51200
    buffer_load_dwordx4 v16, s[40:43], s57 offen lds
    s_add_u32 m0, s64, 79872
    s_add_u32 s57, s61, 4096
    buffer_load_dwordx4 v15, s[40:43], s57 offen lds
    s_add_u32 m0, s64, 80896
    s_add_u32 s57, s61, 53248
    buffer_load_dwordx4 v16, s[40:43], s57 offen lds
    s_add_u32 s61, s61, 393216
    s_sub_u32 s57, s61, s63
    s_cmp_eq_u32 s57, 6291456
    s_cselect_b32 s61, s63, s61
    s_waitcnt vmcnt(18)
    s_waitcnt vmcnt(12)
    s_barrier
    s_add_u32 m0, s58, 26624
    s_add_u32 s57, s60, s66
    buffer_load_dwordx4 v10, s[36:39], s57 offen lds
    s_add_u32 m0, s58, 30720
    s_nop 0
    buffer_load_dwordx4 v10, s[36:39], s60 offen lds
    s_add_u32 m0, s58, 34816
    s_add_u32 s57, s60, 65536
    buffer_load_dwordx4 v10, s[36:39], s57 offen lds
    s_add_u32 m0, s58, 38912
    s_add_u32 s57, s60, 131072
    buffer_load_dwordx4 v10, s[36:39], s57 offen lds
    s_add_u32 m0, s65, 26624
    s_add_u32 s57, s60, s67
    buffer_load_dwordx4 v10, s[36:39], s57 offen lds
    s_add_u32 s60, s60, 128
    s_sub_u32 s57, s60, s59
    s_cmp_eq_u32 s57, 2048
    s_cselect_b32 s60, s59, s60
    s_add_u32 m0, s64, 88064
    s_nop 0
    buffer_load_dwordx4 v15, s[40:43], s61 offen lds
    s_add_u32 m0, s64, 89088
    s_add_u32 s57, s61, 49152
    buffer_load_dwordx4 v16, s[40:43], s57 offen lds
    s_add_u32 m0, s64, 96256
    s_add_u32 s57, s61, 2048
    buffer_load_dwordx4 v15, s[40:43], s57 offen lds
    s_add_u32 m0, s64, 97280
    s_add_u32 s57, s61, 51200
    buffer_load_dwordx4 v16, s[40:43], s57 offen lds
    s_add_u32 m0, s64, 104448
    s_add_u32 s57, s61, 4096
    buffer_load_dwordx4 v15, s[40:43], s57 offen lds
    s_add_u32 m0, s64, 105472
    s_add_u32 s57, s61, 53248
    buffer_load_dwordx4 v16, s[40:43], s57 offen lds
    s_add_u32 s61, s61, 393216
    s_sub_u32 s57, s61, s63
    s_cmp_eq_u32 s57, 6291456
    s_cselect_b32 s61, s63, s61
    s_waitcnt vmcnt(22)
    s_waitcnt vmcnt(17)
    s_waitcnt vmcnt(11)
    s_barrier
    s_add_u32 m0, s58, 45056
    s_add_u32 s57, s60, s66
    buffer_load_dwordx4 v10, s[36:39], s57 offen lds
    s_add_u32 m0, s58, 49152
    s_nop 0
    buffer_load_dwordx4 v10, s[36:39], s60 offen lds
    s_add_u32 m0, s58, 53248
    s_add_u32 s57, s60, 65536
    buffer_load_dwordx4 v10, s[36:39], s57 offen lds
    s_add_u32 m0, s58, 57344
    s_add_u32 s57, s60, 131072
    buffer_load_dwordx4 v10, s[36:39], s57 offen lds
    s_add_u32 m0, s65, 45056
    s_add_u32 s57, s60, s67
    buffer_load_dwordx4 v10, s[36:39], s57 offen lds
    s_add_u32 s60, s60, 128
    s_sub_u32 s57, s60, s59
    s_cmp_eq_u32 s57, 2048
    s_cselect_b32 s60, s59, s60
    s_add_u32 m0, s64, 112640
    s_nop 0
    buffer_load_dwordx4 v15, s[40:43], s61 offen lds
    s_add_u32 m0, s64, 113664
    s_add_u32 s57, s61, 49152
    buffer_load_dwordx4 v16, s[40:43], s57 offen lds
    s_add_u32 m0, s64, 120832
    s_add_u32 s57, s61, 2048
    buffer_load_dwordx4 v15, s[40:43], s57 offen lds
    s_add_u32 m0, s64, 121856
    s_add_u32 s57, s61, 51200
    buffer_load_dwordx4 v16, s[40:43], s57 offen lds
    s_add_u32 m0, s64, 129024
    s_add_u32 s57, s61, 4096
    buffer_load_dwordx4 v15, s[40:43], s57 offen lds
    s_add_u32 m0, s64, 130048
    s_add_u32 s57, s61, 53248
    buffer_load_dwordx4 v16, s[40:43], s57 offen lds
    s_add_u32 s61, s61, 393216
    s_sub_u32 s57, s61, s63
    s_cmp_eq_u32 s57, 6291456
    s_cselect_b32 s61, s63, s61
    s_cmp_lg_u32 s48, 0
    s_cbranch_scc1 mega_kernel_skip1
    s_lshl_b32 s50, s26, 7
    s_lshl_b32 s51, s27, 2
    s_add_u32 s50, s50, s51
    s_add_u32 s50, s50, 27262976
    v_mov_b32 v6, s31
    v_mov_b32 v5, 0
    s_mov_b64 s[52:53], exec
    s_mov_b64 exec, 1
    buffer_store_dword v6, v5, s[32:35], s50 offen sc1
    s_mov_b64 exec, s[52:53]
mega_kernel_skip1:
    s_cmp_lg_u32 s48, 0
    s_cbranch_scc1 mega_kernel_skip2
    s_lshl_b32 s50, s27, 7
    s_lshl_b32 s51, s26, 2
    s_add_u32 s50, s50, s51
    s_add_u32 s50, s50, 27265024
    v_mov_b32 v6, s31
    v_mov_b32 v5, 0
    s_mov_b64 s[52:53], exec
    s_mov_b64 exec, 1
    buffer_store_dword v6, v5, s[32:35], s50 offen sc1
    s_mov_b64 exec, s[52:53]
mega_kernel_skip2:
    s_max_u32 s98, s26, 1
    s_sub_u32 s98, s98, 1
    s_waitcnt vmcnt(17)
    s_waitcnt vmcnt(11)
    s_barrier
    s_add_u32 m0, s58, 8192
    s_add_u32 s57, s60, s66
    buffer_load_dwordx4 v10, s[36:39], s57 offen lds
    s_add_u32 m0, s58, 12288
    s_nop 0
    buffer_load_dwordx4 v10, s[36:39], s60 offen lds
    s_add_u32 m0, s58, 16384
    s_add_u32 s57, s60, 65536
    buffer_load_dwordx4 v10, s[36:39], s57 offen lds
    s_add_u32 m0, s58, 20480
    s_add_u32 s57, s60, 131072
    buffer_load_dwordx4 v10, s[36:39], s57 offen lds
    s_add_u32 m0, s65, 8192
    s_add_u32 s57, s60, s67
    buffer_load_dwordx4 v10, s[36:39], s57 offen lds
    s_add_u32 s60, s60, 128
    s_sub_u32 s57, s60, s59
    s_cmp_eq_u32 s57, 2048
    s_cselect_b32 s60, s59, s60
    s_add_u32 m0, s64, 63488
    s_nop 0
    buffer_load_dwordx4 v15, s[40:43], s61 offen lds
    s_add_u32 m0, s64, 64512
    s_add_u32 s57, s61, 49152
    buffer_load_dwordx4 v16, s[40:43], s57 offen lds
    s_add_u32 m0, s64, 71680
    s_add_u32 s57, s61, 2048
    buffer_load_dwordx4 v15, s[40:43], s57 offen lds
    s_add_u32 m0, s64, 72704
    s_add_u32 s57, s61, 51200
    buffer_load_dwordx4 v16, s[40:43], s57 offen lds
    s_add_u32 m0, s64, 79872
    s_add_u32 s57, s61, 4096
    buffer_load_dwordx4 v15, s[40:43], s57 offen lds
    s_add_u32 m0, s64, 80896
    s_add_u32 s57, s61, 53248
    buffer_load_dwordx4 v16, s[40:43], s57 offen lds
    s_add_u32 s61, s61, 393216
    s_sub_u32 s57, s61, s63
    s_cmp_eq_u32 s57, 6291456
    s_cselect_b32 s61, s63, s61
    s_waitcnt vmcnt(17)
    s_waitcnt vmcnt(11)
    s_barrier
    s_add_u32 m0, s58, 26624
    s_add_u32 s57, s60, s66
    buffer_load_dwordx4 v10, s[36:39], s57 offen lds
    s_add_u32 m0, s58, 30720
    s_nop 0
    buffer_load_dwordx4 v10, s[36:39], s60 offen lds
    s_add_u32 m0, s58, 34816
    s_add_u32 s57, s60, 65536
    buffer_load_dwordx4 v10, s[36:39], s57 offen lds
    s_add_u32 m0, s58, 38912
    s_add_u32 s57, s60, 131072
    buffer_load_dwordx4 v10, s[36:39], s57 offen lds
    s_add_u32 m0, s65, 26624
    s_add_u32 s57, s60, s67
    buffer_load_dwordx4 v10, s[36:39], s57 offen lds
    s_add_u32 s60, s60, 128
    s_sub_u32 s57, s60, s59
    s_cmp_eq_u32 s57, 2048
    s_cselect_b32 s60, s59, s60
    s_add_u32 m0, s64, 88064
    s_nop 0
    buffer_load_dwordx4 v15, s[40:43], s61 offen lds
    s_add_u32 m0, s64, 89088
    s_add_u32 s57, s61, 49152
    buffer_load_dwordx4 v16, s[40:43], s57 offen lds
    s_add_u32 m0, s64, 96256
    s_add_u32 s57, s61, 2048
    buffer_load_dwordx4 v15, s[40:43], s57 offen lds
    s_add_u32 m0, s64, 97280
    s_add_u32 s57, s61, 51200
    buffer_load_dwordx4 v16, s[40:43], s57 offen lds
    s_add_u32 m0, s64, 104448
    s_add_u32 s57, s61, 4096
    buffer_load_dwordx4 v15, s[40:43], s57 offen lds
    s_add_u32 m0, s64, 105472
    s_add_u32 s57, s61, 53248
    buffer_load_dwordx4 v16, s[40:43], s57 offen lds
    s_add_u32 s61, s61, 393216
    s_sub_u32 s57, s61, s63
    s_cmp_eq_u32 s57, 6291456
    s_cselect_b32 s61, s63, s61
    s_waitcnt vmcnt(17)
    s_waitcnt vmcnt(11)
    s_barrier
    s_add_u32 m0, s58, 45056
    s_add_u32 s57, s60, s66
    buffer_load_dwordx4 v10, s[36:39], s57 offen lds
    s_add_u32 m0, s58, 49152
    s_nop 0
    buffer_load_dwordx4 v10, s[36:39], s60 offen lds
    s_add_u32 m0, s58, 53248
    s_add_u32 s57, s60, 65536
    buffer_load_dwordx4 v10, s[36:39], s57 offen lds
    s_add_u32 m0, s58, 57344
    s_add_u32 s57, s60, 131072
    buffer_load_dwordx4 v10, s[36:39], s57 offen lds
    s_add_u32 m0, s65, 45056
    s_add_u32 s57, s60, s67
    buffer_load_dwordx4 v10, s[36:39], s57 offen lds
    s_add_u32 s60, s60, 128
    s_sub_u32 s57, s60, s59
    s_cmp_eq_u32 s57, 2048
    s_cselect_b32 s60, s59, s60
    s_add_u32 m0, s64, 112640
    s_nop 0
    buffer_load_dwordx4 v15, s[40:43], s61 offen lds
    s_add_u32 m0, s64, 113664
    s_add_u32 s57, s61, 49152
    buffer_load_dwordx4 v16, s[40:43], s57 offen lds
    s_add_u32 m0, s64, 120832
    s_add_u32 s57, s61, 2048
    buffer_load_dwordx4 v15, s[40:43], s57 offen lds
    s_add_u32 m0, s64, 121856
    s_add_u32 s57, s61, 51200
    buffer_load_dwordx4 v16, s[40:43], s57 offen lds
    s_add_u32 m0, s64, 129024
    s_add_u32 s57, s61, 4096
    buffer_load_dwordx4 v15, s[40:43], s57 offen lds
    s_add_u32 m0, s64, 130048
    s_add_u32 s57, s61, 53248
    buffer_load_dwordx4 v16, s[40:43], s57 offen lds
    s_add_u32 s61, s61, 393216
    s_sub_u32 s57, s61, s63
    s_cmp_eq_u32 s57, 6291456
    s_cselect_b32 s61, s63, s61
    s_cmp_lg_u32 s48, 0
    s_cbranch_scc1 mega_kernel_skip3
    v_and_b32 v8, 15, v1
    v_lshlrev_b32 v8, 2, v8
    s_lshl_b32 s50, s26, 7
    s_add_u32 s50, s50, 27262976
    v_mov_b32 v9, s50
    s_lshl_b32 s50, s98, 7
    s_add_u32 s50, s50, 27262976
    v_mov_b32 v7, s50
    v_cmp_le_u32 vcc, 1, v4
    s_nop 1
    v_cndmask_b32 v9, v9, v7, vcc
    s_lshl_b32 s50, s27, 7
    s_add_u32 s50, s50, 27265024
    v_mov_b32 v7, s50
    v_cmp_le_u32 vcc, 2, v4
    s_nop 1
    v_cndmask_b32 v9, v9, v7, vcc
    v_add_u32 v8, v8, v9
    buffer_load_dword v9, v8, s[32:35], 0 offen sc1
mega_kernel_skip3:
    s_waitcnt vmcnt(17)
    s_waitcnt vmcnt(11)
    s_barrier
    s_add_u32 m0, s58, 8192
    s_add_u32 s57, s60, s66
    buffer_load_dwordx4 v10, s[36:39], s57 offen lds
    s_add_u32 m0, s58, 12288
    s_nop 0
    buffer_load_dwordx4 v10, s[36:39], s60 offen lds
    s_add_u32 m0, s58, 16384
    s_add_u32 s57, s60, 65536
    buffer_load_dwordx4 v10, s[36:39], s57 offen lds
    s_add_u32 m0, s58, 20480
    s_add_u32 s57, s60, 131072
    buffer_load_dwordx4 v10, s[36:39], s57 offen lds
    s_add_u32 m0, s65, 8192
    s_add_u32 s57, s60, s67
    buffer_load_dwordx4 v10, s[36:39], s57 offen lds
    s_add_u32 s60, s60, 128
    s_sub_u32 s57, s60, s59
    s_cmp_eq_u32 s57, 2048
    s_cselect_b32 s60, s59, s60
    s_add_u32 m0, s64, 63488
    s_nop 0
    buffer_load_dwordx4 v15, s[40:43], s61 offen lds
    s_add_u32 m0, s64, 64512
    s_add_u32 s57, s61, 49152
    buffer_load_dwordx4 v16, s[40:43], s57 offen lds
    s_add_u32 m0, s64, 71680
    s_add_u32 s57, s61, 2048
    buffer_load_dwordx4 v15, s[40:43], s57 offen lds
    s_add_u32 m0, s64, 72704
    s_add_u32 s57, s61, 51200
    buffer_load_dwordx4 v16, s[40:43], s57 offen lds
    s_add_u32 m0, s64, 79872
    s_add_u32 s57, s61, 4096
    buffer_load_dwordx4 v15, s[40:43], s57 offen lds
    s_add_u32 m0, s64, 80896
    s_add_u32 s57, s61, 53248
    buffer_load_dwordx4 v16, s[40:43], s57 offen lds
    s_add_u32 s61, s61, 393216
    s_sub_u32 s57, s61, s63
    s_cmp_eq_u32 s57, 6291456
    s_cselect_b32 s61, s63, s61
    s_cmp_lg_u32 s48, 0
    s_cbranch_scc1 mega_kernel_skip4
    s_waitcnt vmcnt(11)
    v_cmp_eq_u32 vcc, s31, v9
    s_nop 3
    s_and_b32 s50, vcc_lo, 0xffffffff
    s_xor_b32 s50, s50, 0xffffffff
    s_and_b32 s51, vcc_hi, 0xffff
    s_xor_b32 s51, s51, 0xffff
    s_or_b32 s50, s50, s51
    s_cmp_eq_u32 s50, 0
    s_cbranch_scc1 mega_kernel_ok5
    s_mov_b32 s54, 0
mega_kernel_spin6:
    buffer_load_dword v9, v8, s[32:35], 0 offen sc1
    s_waitcnt vmcnt(0)
    v_cmp_eq_u32 vcc, s31, v9
    s_nop 3
    s_and_b32 s50, vcc_lo, 0xffffffff
    s_xor_b32 s50, s50, 0xffffffff
    s_and_b32 s51, vcc_hi, 0xffff
    s_xor_b32 s51, s51, 0xffff
    s_or_b32 s50, s50, s51
    s_cmp_eq_u32 s50, 0
    s_cbranch_scc1 mega_kernel_ok5
    s_sleep 1
    s_add_u32 s54, s54, 1
    s_cmp_lt_u32 s54, 30000
    s_cbranch_scc1 mega_kernel_spin6
mega_kernel_ok5:
mega_kernel_skip4:
    s_waitcnt vmcnt(17)
    s_waitcnt vmcnt(11)
    s_barrier
    s_lshl_b32 s52, s26, 9
    s_sub_u32 s52, s52, 64
    v_lshlrev_b32 v26, 4, v1
    v_add_u32 v26, s52, v26
    v_max_i32 v26, 0, v26
    s_and_b32 s53, s48, 1
    s_lshl_b32 s53, s53, 13
    s_add_u32 s53, s53, 25165824
    buffer_load_dwordx4 v[28:31], v26, s[32:35], s53 offen sc1
    s_min_u32 s54, s48, 2
    s_lshl_b32 s54, s54, 8
    s_lshl_b32 s53, s27, 4
    s_mul_i32 s53, s53, 768
    s_add_u32 s53, s53, s54
    s_add_u32 s53, s53, 25231360
    v_mul_u32_u24 v27, 768, v4
    v_and_b32 v40, 15, v1
    v_lshlrev_b32 v40, 4, v40
    v_add_u32 v27, v27, v40
    buffer_load_dwordx4 v[32:35], v27, s[32:35], s53 offen sc1
    s_add_u32 s53, s53, 3072
    buffer_load_dwordx4 v[36:39], v27, s[32:35], s53 offen sc1
    s_add_u32 s53, s53, 3072
    buffer_load_dwordx4 v[40:43], v27, s[32:35], s53 offen sc1
    s_add_u32 s53, s53, 3072
    buffer_load_dwordx4 v[44:47], v27, s[32:35], s53 offen sc1
    v_lshlrev_b32 v49, 7, v1
    s_mov_b32 s36, s12
    s_and_b32 s37, s13, 0xffff
    s_mov_b32 s38, 7340032
    s_mov_b32 s39, 0x20000
    s_mul_i32 s52, s2, 28672
    s_lshl_b32 s53, s48, 13
    s_add_u32 s52, s52, s53
    buffer_load_dword v50, v49, s[36:39], s52 offen
    s_mov_b32 s36, s8
    s_and_b32 s37, s9, 0xffff
    s_mov_b32 s38, 2097152
    s_mov_b32 s39, 0x20000
    s_lshl_b32 s52, s2, 13
    s_lshl_b32 s53, s48, 11
    s_add_u32 s52, s52, s53
    s_mov_b64 s[54:55], exec
    s_mov_b64 exec, 0xffff
    buffer_load_dword v50, v49, s[36:39], s52 offen
    s_mov_b64 exec, s[54:55]
    s_waitcnt vmcnt(13)
    s_waitcnt vmcnt(7)
    s_barrier
    s_barrier
    s_waitcnt vmcnt(2)
    s_and_b32 s53, s48, 1
    s_mul_i32 s53, s53, 576
    v_lshlrev_b32 v26, 4, v1
    v_add_u32 v26, s53, v26
    v_cmp_gt_u32 vcc, 36, v1
    s_nop 3
    s_and_saveexec_b64 s[54:55], vcc
    ds_write_b128 v26, v[28:31] offset:0
    s_mov_b64 exec, s[54:55]
    v_add_f32 v32, v32, v36
    v_add_f32 v40, v40, v44
    v_add_f32 v33, v33, v37
    v_add_f32 v41, v41, v45
    v_add_f32 v34, v34, v38
    v_add_f32 v42, v42, v46
    v_add_f32 v35, v35, v39
    v_add_f32 v43, v43, v47
    v_add_f32 v32, v32, v40
    v_add_f32 v33, v33, v41
    v_add_f32 v34, v34, v42
    v_add_f32 v35, v35, v43
    v_mov_b32 v36, v32
    v_mov_b32 v37, v33
    v_mov_b32 v38, v34
    v_mov_b32 v39, v35
    v_permlane32_swap_b32 v32, v36
    v_permlane32_swap_b32 v33, v37
    v_permlane32_swap_b32 v34, v38
    v_permlane32_swap_b32 v35, v39
    v_add_f32 v32, v32, v36
    v_add_f32 v33, v33, v37
    v_add_f32 v34, v34, v38
    v_add_f32 v35, v35, v39
    v_mov_b32 v36, v32
    v_mov_b32 v37, v33
    v_mov_b32 v38, v34
    v_mov_b32 v39, v35
    v_permlane16_swap_b32 v32, v36
    v_permlane16_swap_b32 v33, v37
    v_permlane16_swap_b32 v34, v38
    v_permlane16_swap_b32 v35, v39
    v_add_f32 v32, v32, v36
    v_add_f32 v33, v33, v37
    v_add_f32 v34, v34, v38
    v_add_f32 v35, v35, v39
    s_min_u32 s54, s48, 2
    s_lshl_b32 s54, s54, 8
    v_and_b32 v40, 15, v1
    v_lshlrev_b32 v40, 4, v40
    v_add_u32 v40, s54, v40
    ds_write_b128 v40, v[32:35] offset:1152
    s_waitcnt lgkmcnt(0)
    s_barrier
    s_mov_b32 s44, s8
    s_and_b32 s45, s9, 0xffff
    s_mov_b32 s46, 2097152
    s_mov_b32 s47, 0x20000
    s_and_b32 s52, s29, 1
    s_lshl_b32 s52, s52, 6
    s_lshl_b32 s53, s26, 7
    s_add_u32 s52, s52, s53
    s_lshl_b32 s53, s48, 4
    s_add_u32 s52, s52, s53
    v_or_b32 v5, 0, v4
    v_xor_b32 v5, v5, v3
    v_lshlrev_b32 v5, 4, v5
    v_add_u32 v6, s52, v2
    v_lshlrev_b32 v6, 11, v6
    v_add_u32 v30, v6, v5
    v_or_b32 v5, 4, v4
    v_xor_b32 v5, v5, v3
    v_lshlrev_b32 v5, 4, v5
    v_add_u32 v6, s52, v2
    v_add_u32 v6, 8, v6
    v_lshlrev_b32 v6, 11, v6
    v_add_u32 v31, v6, v5
    s_lshr_b32 s53, s29, 1
    s_lshl_b32 s54, s28, 2
    s_add_u32 s53, s53, s54
    s_lshl_b32 s53, s53, 8
    s_lshr_b32 s54, s48, 1
    s_lshl_b32 s54, s54, 7
    s_add_u32 s53, s53, s54
    s_mov_b32 s55, 2048
    s_and_b32 s56, s48, 1
    s_lshl_b32 s56, s56, 16
    s_add_u32 s53, s53, s56
    v_add_u32 v6, 0, v2
    v_mul_lo_u32 v6, v6, s55
    v_add_u32 v6, s53, v6
    v_and_b32 v7, 1, v4
    v_or_b32 v7, 0, v7
    v_lshlrev_b32 v7, 1, v7
    v_xor_b32 v7, v7, v3
    v_lshlrev_b32 v7, 4, v7
    v_add_u32 v32, v6, v7
    v_add_u32 v6, 8, v2
    v_mul_lo_u32 v6, v6, s55
    v_add_u32 v6, s53, v6
    v_and_b32 v7, 1, v4
    v_or_b32 v7, 2, v7
    v_lshlrev_b32 v7, 1, v7
    v_xor_b32 v7, v7, v3
    v_lshlrev_b32 v7, 4, v7
    v_add_u32 v33, v6, v7
    v_add_u32 v6, 16, v2
    v_mul_lo_u32 v6, v6, s55
    v_add_u32 v6, s53, v6
    v_and_b32 v7, 1, v4
    v_or_b32 v7, 0, v7
    v_lshlrev_b32 v7, 1, v7
    v_xor_b32 v7, v7, v3
    v_lshlrev_b32 v7, 4, v7
    v_add_u32 v34, v6, v7
    v_add_u32 v6, 24, v2
    v_mul_lo_u32 v6, v6, s55
    v_add_u32 v6, s53, v6
    v_and_b32 v7, 1, v4
    v_or_b32 v7, 2, v7
    v_lshlrev_b32 v7, 1, v7
    v_xor_b32 v7, v7, v3
    v_lshlrev_b32 v7, 4, v7
    v_add_u32 v35, v6, v7
    s_lshl_b32 s58, s48, 11
    s_lshl_b32 s59, s48, 12
    v_subrev_u32 v31, 1024, v31
    v_subrev_u32 v33, 1024, v33
    v_subrev_u32 v34, 2048, v34
    v_subrev_u32 v35, 3072, v35
    s_mov_b32 s61, 0
    s_add_u32 m0, s59, 8192
    s_nop 0
    buffer_load_dwordx4 v32, s[44:47], s61 offen offset:0 lds
    buffer_load_dwordx4 v33, s[44:47], s61 offen offset:1024 lds
    buffer_load_dwordx4 v34, s[44:47], s61 offen offset:2048 lds
    buffer_load_dwordx4 v35, s[44:47], s61 offen offset:3072 lds
    s_mov_b32 s61, 131072
    s_add_u32 m0, s59, 24576
    s_nop 0
    buffer_load_dwordx4 v32, s[44:47], s61 offen offset:0 lds
    buffer_load_dwordx4 v33, s[44:47], s61 offen offset:1024 lds
    buffer_load_dwordx4 v34, s[44:47], s61 offen offset:2048 lds
    buffer_load_dwordx4 v35, s[44:47], s61 offen offset:3072 lds
    s_barrier
    s_barrier
    s_cmp_lg_u32 s48, 0
    s_cbranch_scc1 mega_kernel_skip7
    v_and_b32 v8, 15, v1
    v_lshlrev_b32 v8, 2, v8
    s_lshl_b32 s50, s26, 7
    s_add_u32 s50, s50, 27267072
    v_mov_b32 v9, s50
    v_add_u32 v8, v8, v9
    buffer_load_dword v9, v8, s[32:35], 0 offen sc1
mega_kernel_skip7:
    s_mov_b32 s61, 262144
    s_add_u32 m0, s59, 40960
    s_nop 0
    buffer_load_dwordx4 v32, s[44:47], s61 offen offset:0 lds
    buffer_load_dwordx4 v33, s[44:47], s61 offen offset:1024 lds
    buffer_load_dwordx4 v34, s[44:47], s61 offen offset:2048 lds
    buffer_load_dwordx4 v35, s[44:47], s61 offen offset:3072 lds
    s_mov_b32 s61, 524288
    s_add_u32 m0, s59, 57344
    s_nop 0
    buffer_load_dwordx4 v32, s[44:47], s61 offen offset:0 lds
    buffer_load_dwordx4 v33, s[44:47], s61 offen offset:1024 lds
    buffer_load_dwordx4 v34, s[44:47], s61 offen offset:2048 lds
    buffer_load_dwordx4 v35, s[44:47], s61 offen offset:3072 lds
    s_mov_b32 s61, 655360
    s_add_u32 m0, s59, 73728
    s_nop 0
    buffer_load_dwordx4 v32, s[44:47], s61 offen offset:0 lds
    buffer_load_dwordx4 v33, s[44:47], s61 offen offset:1024 lds
    buffer_load_dwordx4 v34, s[44:47], s61 offen offset:2048 lds
    buffer_load_dwordx4 v35, s[44:47], s61 offen offset:3072 lds
    s_mov_b32 s61, 786432
    s_add_u32 m0, s59, 90112
    s_nop 0
    buffer_load_dwordx4 v32, s[44:47], s61 offen offset:0 lds
    buffer_load_dwordx4 v33, s[44:47], s61 offen offset:1024 lds
    buffer_load_dwordx4 v34, s[44:47], s61 offen offset:2048 lds
    buffer_load_dwordx4 v35, s[44:47], s61 offen offset:3072 lds
    s_barrier
    s_cmp_lg_u32 s48, 0
    s_cbranch_scc1 mega_kernel_skip8
    s_lshl_b32 s50, s26, 7
    s_lshl_b32 s51, s27, 2
    s_add_u32 s50, s50, s51
    s_add_u32 s50, s50, 27267072
    v_mov_b32 v6, s31
    v_mov_b32 v5, 0
    s_mov_b64 s[52:53], exec
    s_mov_b64 exec, 1
    buffer_store_dword v6, v5, s[32:35], s50 offen sc1
    s_mov_b64 exec, s[52:53]
mega_kernel_skip8:
    s_mov_b32 s36, s12
    s_and_b32 s37, s13, 0xffff
    s_mov_b32 s38, 7340032
    s_mov_b32 s39, 0x20000
    s_mov_b32 s63, 7168
    s_lshl_b32 s64, s26, 6
    s_min_u32 s52, s49, 13
    s_lshl_b32 s52, s52, 8
    s_and_b32 s53, s48, 1
    s_lshl_b32 s53, s53, 7
    s_add_u32 s52, s52, s53
    s_lshr_b32 s53, s48, 1
    s_mul_i32 s53, s53, 3584
    s_add_u32 s65, s52, s53
    s_lshl_b32 s52, s27, 4
    s_add_u32 s52, s52, s26
    s_lshl_b32 s52, s52, 10
    s_lshl_b32 s53, s48, 8
    s_add_u32 s52, s52, s53
    s_add_u32 s66, s52, 25493504
    s_cmp_lg_u32 s48, 0
    s_cbranch_scc1 mega_kernel_skip9
    s_waitcnt vmcnt(16)
    v_cmp_eq_u32 vcc, s31, v9
    s_nop 3
    s_and_b32 s50, vcc_lo, 0x77
    s_xor_b32 s50, s50, 0x77
    s_lshl_b32 s51, 1, s27
    s_andn2_b32 s50, s50, s51
    s_cmp_eq_u32 s50, 0
    s_cbranch_scc1 mega_kernel_ok10
    s_mov_b32 s54, 0
mega_kernel_spin11:
    buffer_load_dword v9, v8, s[32:35], 0 offen sc1
    s_waitcnt vmcnt(0)
    v_cmp_eq_u32 vcc, s31, v9
    s_nop 3
    s_and_b32 s50, vcc_lo, 0x77
    s_xor_b32 s50, s50, 0x77
    s_lshl_b32 s51, 1, s27
    s_andn2_b32 s50, s50, s51
    s_cmp_eq_u32 s50, 0
    s_cbranch_scc1 mega_kernel_ok10
    s_sleep 1
    s_add_u32 s54, s54, 1
    s_cmp_lt_u32 s54, 30000
    s_cbranch_scc1 mega_kernel_spin11
mega_kernel_ok10:
mega_kernel_skip9:
    s_barrier
    s_mov_b32 s60, 0
    s_add_u32 m0, s58, 106496
    s_nop 0
    buffer_load_dwordx4 v30, s[32:35], s60 offen offset:0 sc1 lds
    buffer_load_dwordx4 v31, s[32:35], s60 offen offset:1024 sc1 lds
    s_mov_b32 s60, 128
    s_add_u32 m0, s58, 114688
    s_nop 0
    buffer_load_dwordx4 v30, s[32:35], s60 offen offset:0 sc1 lds
    buffer_load_dwordx4 v31, s[32:35], s60 offen offset:1024 sc1 lds
    s_mov_b32 s60, 256
    s_add_u32 m0, s58, 122880
    s_nop 0
    buffer_load_dwordx4 v30, s[32:35], s60 offen offset:0 sc1 lds
    buffer_load_dwordx4 v31, s[32:35], s60 offen offset:1024 sc1 lds
    s_mov_b32 s60, 512
    s_add_u32 m0, s58, 131072
    s_nop 0
    buffer_load_dwordx4 v30, s[32:35], s60 offen offset:0 sc1 lds
    buffer_load_dwordx4 v31, s[32:35], s60 offen offset:1024 sc1 lds
    s_mov_b32 s60, 640
    s_add_u32 m0, s58, 139264
    s_nop 0
    buffer_load_dwordx4 v30, s[32:35], s60 offen offset:0 sc1 lds
    buffer_load_dwordx4 v31, s[32:35], s60 offen offset:1024 sc1 lds
    s_mov_b32 s60, 768
    s_add_u32 m0, s58, 147456
    s_nop 0
    buffer_load_dwordx4 v30, s[32:35], s60 offen offset:0 sc1 lds
    buffer_load_dwordx4 v31, s[32:35], s60 offen offset:1024 sc1 lds
    s_waitcnt vmcnt(10)
    s_barrier
    s_waitcnt vmcnt(8)
    s_barrier
    s_mov_b32 s61, 393216
    s_add_u32 m0, s59, 8192
    s_nop 0
    buffer_load_dwordx4 v32, s[44:47], s61 offen offset:0 lds
    buffer_load_dwordx4 v33, s[44:47], s61 offen offset:1024 lds
    buffer_load_dwordx4 v34, s[44:47], s61 offen offset:2048 lds
    buffer_load_dwordx4 v35, s[44:47], s61 offen offset:3072 lds
    s_waitcnt vmcnt(10)
    s_barrier
    s_mov_b32 s61, 1441792
    s_add_u32 m0, s59, 24576
    s_nop 0
    buffer_load_dwordx4 v32, s[44:47], s61 offen offset:0 lds
    buffer_load_dwordx4 v33, s[44:47], s61 offen offset:1024 lds
    buffer_load_dwordx4 v34, s[44:47], s61 offen offset:2048 lds
    buffer_load_dwordx4 v35, s[44:47], s61 offen offset:3072 lds
    s_cmp_lg_u32 s48, 0
    s_cbranch_scc1 mega_kernel_skip12
    v_and_b32 v8, 15, v1
    v_lshlrev_b32 v8, 2, v8
    s_lshl_b32 s50, s26, 7
    s_add_u32 s50, s50, 27267072
    v_mov_b32 v9, s50
    v_add_u32 v8, v8, v9
    buffer_load_dword v9, v8, s[32:35], 0 offen sc1
mega_kernel_skip12:
    s_waitcnt vmcnt(12)
    s_barrier
    s_mov_b32 s61, 1048576
    s_add_u32 m0, s59, 40960
    s_nop 0
    buffer_load_dwordx4 v32, s[44:47], s61 offen offset:0 lds
    buffer_load_dwordx4 v33, s[44:47], s61 offen offset:1024 lds
    buffer_load_dwordx4 v34, s[44:47], s61 offen offset:2048 lds
    buffer_load_dwordx4 v35, s[44:47], s61 offen offset:3072 lds
    s_waitcnt vmcnt(14)
    s_cmp_lg_u32 s48, 0
    s_cbranch_scc1 mega_kernel_skip13
    s_waitcnt vmcnt(4)
    v_cmp_eq_u32 vcc, s31, v9
    s_nop 3
    s_and_b32 s50, vcc_lo, 0x88
    s_xor_b32 s50, s50, 0x88
    s_lshl_b32 s51, 1, s27
    s_andn2_b32 s50, s50, s51
    s_cmp_eq_u32 s50, 0
    s_cbranch_scc1 mega_kernel_ok14
    s_mov_b32 s54, 0
mega_kernel_spin15:
    buffer_load_dword v9, v8, s[32:35], 0 offen sc1
    s_waitcnt vmcnt(0)
    v_cmp_eq_u32 vcc, s31, v9
    s_nop 3
    s_and_b32 s50, vcc_lo, 0x88
    s_xor_b32 s50, s50, 0x88
    s_lshl_b32 s51, 1, s27
    s_andn2_b32 s50, s50, s51
    s_cmp_eq_u32 s50, 0
    s_cbranch_scc1 mega_kernel_ok14
    s_sleep 1
    s_add_u32 s54, s54, 1
    s_cmp_lt_u32 s54, 30000
    s_cbranch_scc1 mega_kernel_spin15
mega_kernel_ok14:
mega_kernel_skip13:
    s_barrier
    s_mov_b32 s60, 384
    s_add_u32 m0, s58, 106496
    s_nop 0
    buffer_load_dwordx4 v30, s[32:35], s60 offen offset:0 sc1 lds
    buffer_load_dwordx4 v31, s[32:35], s60 offen offset:1024 sc1 lds
    s_mov_b32 s60, 1408
    s_add_u32 m0, s58, 114688
    s_nop 0
    buffer_load_dwordx4 v30, s[32:35], s60 offen offset:0 sc1 lds
    buffer_load_dwordx4 v31, s[32:35], s60 offen offset:1024 sc1 lds
    s_mov_b32 s61, 1179648
    s_add_u32 m0, s59, 57344
    s_nop 0
    buffer_load_dwordx4 v32, s[44:47], s61 offen offset:0 lds
    buffer_load_dwordx4 v33, s[44:47], s61 offen offset:1024 lds
    buffer_load_dwordx4 v34, s[44:47], s61 offen offset:2048 lds
    buffer_load_dwordx4 v35, s[44:47], s61 offen offset:3072 lds
    s_cmp_lg_u32 s48, 0
    s_cbranch_scc1 mega_kernel_skip16
    v_and_b32 v8, 15, v1
    v_lshlrev_b32 v8, 2, v8
    s_lshl_b32 s50, s26, 7
    s_add_u32 s50, s50, 27267072
    v_mov_b32 v9, s50
    v_add_u32 v8, v8, v9
    buffer_load_dword v9, v8, s[32:35], 0 offen sc1
mega_kernel_skip16:
    s_waitcnt vmcnt(20)
    s_barrier
    s_mov_b32 s61, 1310720
    s_add_u32 m0, s59, 73728
    s_nop 0
    buffer_load_dwordx4 v32, s[44:47], s61 offen offset:0 lds
    buffer_load_dwordx4 v33, s[44:47], s61 offen offset:1024 lds
    buffer_load_dwordx4 v34, s[44:47], s61 offen offset:2048 lds
    buffer_load_dwordx4 v35, s[44:47], s61 offen offset:3072 lds
    s_waitcnt vmcnt(10)
    s_cmp_lg_u32 s48, 0
    s_cbranch_scc1 mega_kernel_skip17
    s_waitcnt vmcnt(4)
    v_cmp_eq_u32 vcc, s31, v9
    s_nop 3
    s_and_b32 s50, vcc_lo, 0xff00
    s_xor_b32 s50, s50, 0xff00
    s_lshl_b32 s51, 1, s27
    s_andn2_b32 s50, s50, s51
    s_cmp_eq_u32 s50, 0
    s_cbranch_scc1 mega_kernel_ok18
    s_mov_b32 s54, 0
mega_kernel_spin19:
    buffer_load_dword v9, v8, s[32:35], 0 offen sc1
    s_waitcnt vmcnt(0)
    v_cmp_eq_u32 vcc, s31, v9
    s_nop 3
    s_and_b32 s50, vcc_lo, 0xff00
    s_xor_b32 s50, s50, 0xff00
    s_lshl_b32 s51, 1, s27
    s_andn2_b32 s50, s50, s51
    s_cmp_eq_u32 s50, 0
    s_cbranch_scc1 mega_kernel_ok18
    s_sleep 1
    s_add_u32 s54, s54, 1
    s_cmp_lt_u32 s54, 30000
    s_cbranch_scc1 mega_kernel_spin19
mega_kernel_ok18:
mega_kernel_skip17:
    s_barrier
    s_mov_b32 s60, 1024
    s_add_u32 m0, s58, 122880
    s_nop 0
    buffer_load_dwordx4 v30, s[32:35], s60 offen offset:0 sc1 lds
    buffer_load_dwordx4 v31, s[32:35], s60 offen offset:1024 sc1 lds
    s_mov_b32 s60, 1152
    s_add_u32 m0, s58, 131072
    s_nop 0
    buffer_load_dwordx4 v30, s[32:35], s60 offen offset:0 sc1 lds
    buffer_load_dwordx4 v31, s[32:35], s60 offen offset:1024 sc1 lds
    s_mov_b32 s60, 1280
    s_add_u32 m0, s58, 139264
    s_nop 0
    buffer_load_dwordx4 v30, s[32:35], s60 offen offset:0 sc1 lds
    buffer_load_dwordx4 v31, s[32:35], s60 offen offset:1024 sc1 lds
    s_mov_b32 s60, 1536
    s_add_u32 m0, s58, 147456
    s_nop 0
    buffer_load_dwordx4 v30, s[32:35], s60 offen offset:0 sc1 lds
    buffer_load_dwordx4 v31, s[32:35], s60 offen offset:1024 sc1 lds
    s_mov_b32 s61, 1572864
    s_add_u32 m0, s59, 90112
    s_nop 0
    buffer_load_dwordx4 v32, s[44:47], s61 offen offset:0 lds
    buffer_load_dwordx4 v33, s[44:47], s61 offen offset:1024 lds
    buffer_load_dwordx4 v34, s[44:47], s61 offen offset:2048 lds
    buffer_load_dwordx4 v35, s[44:47], s61 offen offset:3072 lds
    s_waitcnt vmcnt(20)
    s_barrier
    s_mov_b32 s60, 1664
    s_add_u32 m0, s58, 106496
    s_nop 0
    buffer_load_dwordx4 v30, s[32:35], s60 offen offset:0 sc1 lds
    buffer_load_dwordx4 v31, s[32:35], s60 offen offset:1024 sc1 lds
    s_mov_b32 s61, 1703936
    s_add_u32 m0, s59, 8192
    s_nop 0
    buffer_load_dwordx4 v32, s[44:47], s61 offen offset:0 lds
    buffer_load_dwordx4 v33, s[44:47], s61 offen offset:1024 lds
    buffer_load_dwordx4 v34, s[44:47], s61 offen offset:2048 lds
    buffer_load_dwordx4 v35, s[44:47], s61 offen offset:3072 lds
    s_waitcnt vmcnt(16)
    s_barrier
    s_mov_b32 s60, 1792
    s_add_u32 m0, s58, 114688
    s_nop 0
    buffer_load_dwordx4 v30, s[32:35], s60 offen offset:0 sc1 lds
    buffer_load_dwordx4 v31, s[32:35], s60 offen offset:1024 sc1 lds
    s_mov_b32 s61, 1835008
    s_add_u32 m0, s59, 24576
    s_nop 0
    buffer_load_dwordx4 v32, s[44:47], s61 offen offset:0 lds
    buffer_load_dwordx4 v33, s[44:47], s61 offen offset:1024 lds
    buffer_load_dwordx4 v34, s[44:47], s61 offen offset:2048 lds
    buffer_load_dwordx4 v35, s[44:47], s61 offen offset:3072 lds
    s_waitcnt vmcnt(20)
    s_barrier
    s_mov_b32 s60, 1920
    s_add_u32 m0, s58, 122880
    s_nop 0
    buffer_load_dwordx4 v30, s[32:35], s60 offen offset:0 sc1 lds
    buffer_load_dwordx4 v31, s[32:35], s60 offen offset:1024 sc1 lds
    s_mov_b32 s61, 1966080
    s_add_u32 m0, s59, 40960
    s_nop 0
    buffer_load_dwordx4 v32, s[44:47], s61 offen offset:0 lds
    buffer_load_dwordx4 v33, s[44:47], s61 offen offset:1024 lds
    buffer_load_dwordx4 v34, s[44:47], s61 offen offset:2048 lds
    buffer_load_dwordx4 v35, s[44:47], s61 offen offset:3072 lds
    s_waitcnt vmcnt(24)
    s_barrier
    s_mov_b32 s60, 896
    s_add_u32 m0, s58, 131072
    s_nop 0
    buffer_load_dwordx4 v30, s[32:35], s60 offen offset:0 sc1 lds
    buffer_load_dwordx4 v31, s[32:35], s60 offen offset:1024 sc1 lds
    s_mov_b32 s61, 917504
    s_add_u32 m0, s59, 57344
    s_nop 0
    buffer_load_dwordx4 v32, s[44:47], s61 offen offset:0 lds
    buffer_load_dwordx4 v33, s[44:47], s61 offen offset:1024 lds
    buffer_load_dwordx4 v34, s[44:47], s61 offen offset:2048 lds
    buffer_load_dwordx4 v35, s[44:47], s61 offen offset:3072 lds
    s_waitcnt vmcnt(28)
    s_waitcnt vmcnt(24)
    s_barrier
    v_add_u32 v22, s64, v2
    v_mul_lo_u32 v22, v22, s63
    v_lshlrev_b32 v23, 4, v3
    v_add_u32 v22, v22, v23
    s_lshl_b32 s53, s63, 3
    s_mov_b32 s54, s65
    buffer_load_dwordx4 v[64:67], v22, s[36:39], s54 offen
    s_add_u32 s54, s54, s53
    buffer_load_dwordx4 v[68:71], v22, s[36:39], s54 offen
    s_add_u32 s54, s54, s53
    buffer_load_dwordx4 v[72:75], v22, s[36:39], s54 offen
    s_add_u32 s54, s54, s53
    buffer_load_dwordx4 v[76:79], v22, s[36:39], s54 offen
    s_add_u32 s54, s54, s53
    buffer_load_dwordx4 v[80:83], v22, s[36:39], s54 offen
    s_add_u32 s54, s54, s53
    buffer_load_dwordx4 v[84:87], v22, s[36:39], s54 offen
    s_add_u32 s54, s54, s53
    buffer_load_dwordx4 v[88:91], v22, s[36:39], s54 offen
    s_add_u32 s54, s54, s53
    buffer_load_dwordx4 v[92:95], v22, s[36:39], s54 offen
    s_waitcnt vmcnt(30)
    s_waitcnt vmcnt(26)
    s_barrier
    s_waitcnt vmcnt(24)
    s_waitcnt vmcnt(20)
    s_barrier
    s_waitcnt vmcnt(18)
    s_waitcnt vmcnt(14)
    s_barrier
    s_waitcnt vmcnt(12)
    s_waitcnt vmcnt(8)
    s_barrier
    s_barrier
    s_waitcnt vmcnt(0)
    s_mov_b32 s52, 0x00003f80
    s_mov_b32 s53, 0x3f800000
    v_lshlrev_b32 v96, 16, v64
    v_and_b32 v97, 0xffff0000, v64
    v_lshlrev_b32 v98, 16, v65
    v_and_b32 v99, 0xffff0000, v65
    v_lshlrev_b32 v100, 16, v66
    v_and_b32 v101, 0xffff0000, v66
    v_lshlrev_b32 v102, 16, v67
    v_and_b32 v103, 0xffff0000, v67
    v_dot2c_f32_bf16 v96, s52, v68
    v_dot2c_f32_bf16 v97, s53, v68
    v_dot2c_f32_bf16 v98, s52, v69
    v_dot2c_f32_bf16 v99, s53, v69
    v_dot2c_f32_bf16 v100, s52, v70
    v_dot2c_f32_bf16 v101, s53, v70
    v_dot2c_f32_bf16 v102, s52, v71
    v_dot2c_f32_bf16 v103, s53, v71
    v_dot2c_f32_bf16 v96, s52, v72
    v_dot2c_f32_bf16 v97, s53, v72
    v_dot2c_f32_bf16 v98, s52, v73
    v_dot2c_f32_bf16 v99, s53, v73
    v_dot2c_f32_bf16 v100, s52, v74
    v_dot2c_f32_bf16 v101, s53, v74
    v_dot2c_f32_bf16 v102, s52, v75
    v_dot2c_f32_bf16 v103, s53, v75
    v_dot2c_f32_bf16 v96, s52, v76
    v_dot2c_f32_bf16 v97, s53, v76
    v_dot2c_f32_bf16 v98, s52, v77
    v_dot2c_f32_bf16 v99, s53, v77
    v_dot2c_f32_bf16 v100, s52, v78
    v_dot2c_f32_bf16 v101, s53, v78
    v_dot2c_f32_bf16 v102, s52, v79
    v_dot2c_f32_bf16 v103, s53, v79
    v_dot2c_f32_bf16 v96, s52, v80
    v_dot2c_f32_bf16 v97, s53, v80
    v_dot2c_f32_bf16 v98, s52, v81
    v_dot2c_f32_bf16 v99, s53, v81
    v_dot2c_f32_bf16 v100, s52, v82
    v_dot2c_f32_bf16 v101, s53, v82
    v_dot2c_f32_bf16 v102, s52, v83
    v_dot2c_f32_bf16 v103, s53, v83
    v_dot2c_f32_bf16 v96, s52, v84
    v_dot2c_f32_bf16 v97, s53, v84
    v_dot2c_f32_bf16 v98, s52, v85
    v_dot2c_f32_bf16 v99, s53, v85
    v_dot2c_f32_bf16 v100, s52, v86
    v_dot2c_f32_bf16 v101, s53, v86
    v_dot2c_f32_bf16 v102, s52, v87
    v_dot2c_f32_bf16 v103, s53, v87
    v_dot2c_f32_bf16 v96, s52, v88
    v_dot2c_f32_bf16 v97, s53, v88
    v_dot2c_f32_bf16 v98, s52, v89
    v_dot2c_f32_bf16 v99, s53, v89
    v_dot2c_f32_bf16 v100, s52, v90
    v_dot2c_f32_bf16 v101, s53, v90
    v_dot2c_f32_bf16 v102, s52, v91
    v_dot2c_f32_bf16 v103, s53, v91
    v_dot2c_f32_bf16 v96, s52, v92
    v_dot2c_f32_bf16 v97, s53, v92
    v_dot2c_f32_bf16 v98, s52, v93
    v_dot2c_f32_bf16 v99, s53, v93
    v_dot2c_f32_bf16 v100, s52, v94
    v_dot2c_f32_bf16 v101, s53, v94
    v_dot2c_f32_bf16 v102, s52, v95
    v_dot2c_f32_bf16 v103, s53, v95
    v_permlane32_swap_b32 v96, v97
    v_permlane32_swap_b32 v98, v99
    v_permlane32_swap_b32 v100, v101
    v_permlane32_swap_b32 v102, v103
    v_add_f32 v104, v96, v97
    v_add_f32 v105, v98, v99
    v_add_f32 v106, v100, v101
    v_add_f32 v107, v102, v103
    v_permlane16_swap_b32 v104, v105
    s_nop 0
    v_permlane16_swap_b32 v106, v107
    v_add_f32 v96, v104, v105
    v_add_f32 v97, v106, v107
    s_nop 0
    v_add_f32_dpp v96, v96, v96 row_ror:8 row_mask:0xf bank_mask:0xf
    v_add_f32_dpp v97, v97, v97 row_ror:8 row_mask:0xf bank_mask:0xf
    v_lshrrev_b32 v98, 4, v1
    v_and_b32 v99, 1, v98
    v_lshlrev_b32 v99, 1, v99
    v_lshrrev_b32 v98, 1, v98
    v_or_b32 v98, v98, v99
    v_lshlrev_b32 v99, 3, v3
    v_add_u32 v98, v98, v99
    v_and_b32 v99, 8, v1
    v_lshrrev_b32 v100, 1, v99
    v_add_u32 v98, v98, v100
    v_lshlrev_b32 v98, 2, v98
    v_cmp_ne_u32 vcc, 0, v99
    s_nop 1
    v_cndmask_b32 v96, v96, v97, vcc
    buffer_store_dword v96, v98, s[32:35], s66 offen sc1
    s_barrier
    s_cmp_lg_u32 s48, 0
    s_cbranch_scc1 mega_kernel_skip20
    v_and_b32 v8, 15, v1
    v_lshlrev_b32 v8, 2, v8
    s_lshl_b32 s50, s26, 7
    s_add_u32 s50, s50, 27269120
    v_mov_b32 v9, s50
    v_add_u32 v8, v8, v9
    buffer_load_dword v9, v8, s[32:35], 0 offen sc1
mega_kernel_skip20:
    s_cmp_eq_u32 s29, 7
    s_cbranch_scc1 mega_kernel_idl22
    s_mov_b32 s40, s12
    s_and_b32 s41, s13, 0xffff
    s_mov_b32 s42, 7340032
    s_mov_b32 s43, 0x20000
    s_lshl_b32 s52, s26, 7
    s_lshl_b32 s53, s48, 5
    s_add_u32 s52, s52, s53
    v_or_b32 v5, 0, v4
    v_xor_b32 v5, v5, v3
    v_lshlrev_b32 v5, 4, v5
    v_add_u32 v6, s52, v2
    v_lshlrev_b32 v6, 11, v6
    v_add_u32 v30, v6, v5
    v_or_b32 v5, 4, v4
    v_xor_b32 v5, v5, v3
    v_lshlrev_b32 v5, 4, v5
    v_add_u32 v6, s52, v2
    v_add_u32 v6, 8, v6
    v_lshlrev_b32 v6, 11, v6
    v_add_u32 v31, v6, v5
    v_or_b32 v5, 0, v4
    v_xor_b32 v5, v5, v3
    v_lshlrev_b32 v5, 4, v5
    v_add_u32 v6, s52, v2
    v_add_u32 v6, 16, v6
    v_lshlrev_b32 v6, 11, v6
    v_add_u32 v32, v6, v5
    v_or_b32 v5, 4, v4
    v_xor_b32 v5, v5, v3
    v_lshlrev_b32 v5, 4, v5
    v_add_u32 v6, s52, v2
    v_add_u32 v6, 24, v6
    v_lshlrev_b32 v6, 11, v6
    v_add_u32 v33, v6, v5
    v_or_b32 v5, 0, v4
    v_xor_b32 v5, v5, v3
    v_lshlrev_b32 v5, 4, v5
    v_add_u32 v6, s52, v2
    v_lshlrev_b32 v6, 12, v6
    v_add_u32 v38, v6, v5
    v_or_b32 v5, 4, v4
    v_xor_b32 v5, v5, v3
    v_lshlrev_b32 v5, 4, v5
    v_add_u32 v6, s52, v2
    v_add_u32 v6, 8, v6
    v_lshlrev_b32 v6, 12, v6
    v_add_u32 v39, v6, v5
    v_or_b32 v5, 0, v4
    v_xor_b32 v5, v5, v3
    v_lshlrev_b32 v5, 4, v5
    v_add_u32 v6, s52, v2
    v_add_u32 v6, 16, v6
    v_lshlrev_b32 v6, 12, v6
    v_add_u32 v40, v6, v5
    v_or_b32 v5, 4, v4
    v_xor_b32 v5, v5, v3
    v_lshlrev_b32 v5, 4, v5
    v_add_u32 v6, s52, v2
    v_add_u32 v6, 24, v6
    v_lshlrev_b32 v6, 12, v6
    v_add_u32 v41, v6, v5
    s_lshl_b32 s53, s49, 8
    s_lshr_b32 s54, s48, 1
    s_lshl_b32 s54, s54, 7
    s_add_u32 s53, s53, s54
    s_and_b32 s56, s48, 1
    s_mul_i32 s56, s56, 229376
    s_add_u32 s53, s53, s56
    s_mov_b32 s55, 7168
    v_add_u32 v6, 0, v2
    v_mul_lo_u32 v6, v6, s55
    v_add_u32 v6, s53, v6
    v_and_b32 v7, 1, v4
    v_or_b32 v7, 0, v7
    v_lshlrev_b32 v7, 1, v7
    v_xor_b32 v7, v7, v3
    v_lshlrev_b32 v7, 4, v7
    v_add_u32 v34, v6, v7
    v_add_u32 v6, 8, v2
    v_mul_lo_u32 v6, v6, s55
    v_add_u32 v6, s53, v6
    v_and_b32 v7, 1, v4
    v_or_b32 v7, 2, v7
    v_lshlrev_b32 v7, 1, v7
    v_xor_b32 v7, v7, v3
    v_lshlrev_b32 v7, 4, v7
    v_add_u32 v35, v6, v7
    v_add_u32 v6, 16, v2
    v_mul_lo_u32 v6, v6, s55
    v_add_u32 v6, s53, v6
    v_and_b32 v7, 1, v4
    v_or_b32 v7, 0, v7
    v_lshlrev_b32 v7, 1, v7
    v_xor_b32 v7, v7, v3
    v_lshlrev_b32 v7, 4, v7
    v_add_u32 v36, v6, v7
    v_add_u32 v6, 24, v2
    v_mul_lo_u32 v6, v6, s55
    v_add_u32 v6, s53, v6
    v_and_b32 v7, 1, v4
    v_or_b32 v7, 2, v7
    v_lshlrev_b32 v7, 1, v7
    v_xor_b32 v7, v7, v3
    v_lshlrev_b32 v7, 4, v7
    v_add_u32 v37, v6, v7
    s_lshl_b32 s53, s49, 8
    s_lshr_b32 s54, s48, 1
    s_lshl_b32 s54, s54, 7
    s_add_u32 s53, s53, s54
    s_and_b32 s56, s48, 1
    s_mul_i32 s56, s56, 114688
    s_add_u32 s53, s53, s56
    s_mov_b32 s55, 3584
    v_add_u32 v6, 0, v2
    v_mul_lo_u32 v6, v6, s55
    v_add_u32 v6, s53, v6
    v_and_b32 v7, 1, v4
    v_or_b32 v7, 0, v7
    v_lshlrev_b32 v7, 1, v7
    v_xor_b32 v7, v7, v3
    v_lshlrev_b32 v7, 4, v7
    v_add_u32 v42, v6, v7
    v_add_u32 v6, 8, v2
    v_mul_lo_u32 v6, v6, s55
    v_add_u32 v6, s53, v6
    v_and_b32 v7, 1, v4
    v_or_b32 v7, 2, v7
    v_lshlrev_b32 v7, 1, v7
    v_xor_b32 v7, v7, v3
    v_lshlrev_b32 v7, 4, v7
    v_add_u32 v43, v6, v7
    v_add_u32 v6, 16, v2
    v_mul_lo_u32 v6, v6, s55
    v_add_u32 v6, s53, v6
    v_and_b32 v7, 1, v4
    v_or_b32 v7, 0, v7
    v_lshlrev_b32 v7, 1, v7
    v_xor_b32 v7, v7, v3
    v_lshlrev_b32 v7, 4, v7
    v_add_u32 v44, v6, v7
    v_add_u32 v6, 24, v2
    v_mul_lo_u32 v6, v6, s55
    v_add_u32 v6, s53, v6
    v_and_b32 v7, 1, v4
    v_or_b32 v7, 2, v7
    v_lshlrev_b32 v7, 1, v7
    v_xor_b32 v7, v7, v3
    v_lshlrev_b32 v7, 4, v7
    v_add_u32 v45, v6, v7
    s_lshl_b32 s58, s48, 12
    v_subrev_u32 v31, 1024, v31
    v_subrev_u32 v32, 2048, v32
    v_subrev_u32 v33, 3072, v33
    v_subrev_u32 v35, 1024, v35
    v_subrev_u32 v36, 2048, v36
    v_subrev_u32 v37, 3072, v37
    v_subrev_u32 v39, 1024, v39
    v_subrev_u32 v43, 1024, v43
    v_subrev_u32 v40, 2048, v40
    v_subrev_u32 v44, 2048, v44
    v_subrev_u32 v41, 3072, v41
    v_subrev_u32 v45, 3072, v45
    s_mov_b32 s61, 3584
    s_add_u32 m0, s58, 98304
    s_nop 0
    buffer_load_dwordx4 v34, s[40:43], s61 offen offset:0 lds
    buffer_load_dwordx4 v35, s[40:43], s61 offen offset:1024 lds
    buffer_load_dwordx4 v36, s[40:43], s61 offen offset:2048 lds
    buffer_load_dwordx4 v37, s[40:43], s61 offen offset:3072 lds
    s_mov_b32 s61, 462336
    s_add_u32 m0, s58, 114688
    s_nop 0
    buffer_load_dwordx4 v34, s[40:43], s61 offen offset:0 lds
    buffer_load_dwordx4 v35, s[40:43], s61 offen offset:1024 lds
    buffer_load_dwordx4 v36, s[40:43], s61 offen offset:2048 lds
    buffer_load_dwordx4 v37, s[40:43], s61 offen offset:3072 lds
    s_mov_b32 s61, 921088
    s_add_u32 m0, s58, 131072
    s_nop 0
    buffer_load_dwordx4 v34, s[40:43], s61 offen offset:0 lds
    buffer_load_dwordx4 v35, s[40:43], s61 offen offset:1024 lds
    buffer_load_dwordx4 v36, s[40:43], s61 offen offset:2048 lds
    buffer_load_dwordx4 v37, s[40:43], s61 offen offset:3072 lds
    s_mov_b32 s61, 1379840
    s_add_u32 m0, s58, 147456
    s_nop 0
    buffer_load_dwordx4 v34, s[40:43], s61 offen offset:0 lds
    buffer_load_dwordx4 v35, s[40:43], s61 offen offset:1024 lds
    buffer_load_dwordx4 v36, s[40:43], s61 offen offset:2048 lds
    buffer_load_dwordx4 v37, s[40:43], s61 offen offset:3072 lds
    s_waitcnt vmcnt(16)
    s_branch mega_kernel_join21
mega_kernel_idl22:
    s_waitcnt vmcnt(0)
mega_kernel_join21:
    s_barrier
    s_cmp_lg_u32 s48, 0
    s_cbranch_scc1 mega_kernel_skip23
    s_lshl_b32 s50, s26, 7
    s_lshl_b32 s51, s27, 2
    s_add_u32 s50, s50, s51
    s_add_u32 s50, s50, 27269120
    v_mov_b32 v6, s31
    v_mov_b32 v5, 0
    s_mov_b64 s[52:53], exec
    s_mov_b64 exec, 1
    buffer_store_dword v6, v5, s[32:35], s50 offen sc1
    s_mov_b64 exec, s[52:53]
mega_kernel_skip23:
    s_cmp_lg_u32 s48, 0
    s_cbranch_scc1 mega_kernel_skip24
    s_lshl_b32 s50, s27, 7
    s_lshl_b32 s51, s26, 2
    s_add_u32 s50, s50, s51
    s_add_u32 s50, s50, 27271168
    v_mov_b32 v6, s31
    v_mov_b32 v5, 0
    s_mov_b64 s[52:53], exec
    s_mov_b64 exec, 1
    buffer_store_dword v6, v5, s[32:35], s50 offen sc1
    s_mov_b64 exec, s[52:53]
mega_kernel_skip24:
    s_cmp_eq_u32 s29, 7
    s_cbranch_scc1 p_idle
    s_cmp_lg_u32 s48, 0
    s_cbranch_scc1 mega_kernel_skip25
    s_waitcnt vmcnt(16)
    v_cmp_eq_u32 vcc, s31, v9
    s_nop 3
    s_and_b32 s50, vcc_lo, 0xff
    s_xor_b32 s50, s50, 0xff
    s_lshl_b32 s51, 1, s27
    s_andn2_b32 s50, s50, s51
    s_cmp_eq_u32 s50, 0
    s_cbranch_scc1 mega_kernel_ok26
    s_mov_b32 s54, 0
mega_kernel_spin27:
    buffer_load_dword v9, v8, s[32:35], 0 offen sc1
    s_waitcnt vmcnt(0)
    v_cmp_eq_u32 vcc, s31, v9
    s_nop 3
    s_and_b32 s50, vcc_lo, 0xff
    s_xor_b32 s50, s50, 0xff
    s_lshl_b32 s51, 1, s27
    s_andn2_b32 s50, s50, s51
    s_cmp_eq_u32 s50, 0
    s_cbranch_scc1 mega_kernel_ok26
    s_sleep 1
    s_add_u32 s54, s54, 1
    s_cmp_lt_u32 s54, 30000
    s_cbranch_scc1 mega_kernel_spin27
mega_kernel_ok26:
mega_kernel_skip25:
    s_barrier
    s_mov_b32 s60, 4194304
    s_add_u32 m0, s58, 49152
    s_nop 0
    buffer_load_dwordx4 v30, s[32:35], s60 offen offset:0 sc1 lds
    buffer_load_dwordx4 v31, s[32:35], s60 offen offset:1024 sc1 lds
    buffer_load_dwordx4 v32, s[32:35], s60 offen offset:2048 sc1 lds
    buffer_load_dwordx4 v33, s[32:35], s60 offen offset:3072 sc1 lds
    s_mov_b32 s60, 4194432
    s_add_u32 m0, s58, 65536
    s_nop 0
    buffer_load_dwordx4 v30, s[32:35], s60 offen offset:0 sc1 lds
    buffer_load_dwordx4 v31, s[32:35], s60 offen offset:1024 sc1 lds
    buffer_load_dwordx4 v32, s[32:35], s60 offen offset:2048 sc1 lds
    buffer_load_dwordx4 v33, s[32:35], s60 offen offset:3072 sc1 lds
    s_mov_b32 s60, 4194560
    s_add_u32 m0, s58, 81920
    s_nop 0
    buffer_load_dwordx4 v30, s[32:35], s60 offen offset:0 sc1 lds
    buffer_load_dwordx4 v31, s[32:35], s60 offen offset:1024 sc1 lds
    buffer_load_dwordx4 v32, s[32:35], s60 offen offset:2048 sc1 lds
    buffer_load_dwordx4 v33, s[32:35], s60 offen offset:3072 sc1 lds
    s_waitcnt vmcnt(8)
    s_barrier
    s_waitcnt vmcnt(4)
    s_barrier
    s_mov_b32 s60, 4194688
    s_add_u32 m0, s58, 49152
    s_nop 0
    buffer_load_dwordx4 v30, s[32:35], s60 offen offset:0 sc1 lds
    buffer_load_dwordx4 v31, s[32:35], s60 offen offset:1024 sc1 lds
    buffer_load_dwordx4 v32, s[32:35], s60 offen offset:2048 sc1 lds
    buffer_load_dwordx4 v33, s[32:35], s60 offen offset:3072 sc1 lds
    s_mov_b32 s61, 1838592
    s_add_u32 m0, s58, 98304
    s_nop 0
    buffer_load_dwordx4 v34, s[40:43], s61 offen offset:0 lds
    buffer_load_dwordx4 v35, s[40:43], s61 offen offset:1024 lds
    buffer_load_dwordx4 v36, s[40:43], s61 offen offset:2048 lds
    buffer_load_dwordx4 v37, s[40:43], s61 offen offset:3072 lds
    s_waitcnt vmcnt(8)
    s_barrier
    s_mov_b32 s60, 4194816
    s_add_u32 m0, s58, 65536
    s_nop 0
    buffer_load_dwordx4 v30, s[32:35], s60 offen offset:0 sc1 lds
    buffer_load_dwordx4 v31, s[32:35], s60 offen offset:1024 sc1 lds
    buffer_load_dwordx4 v32, s[32:35], s60 offen offset:2048 sc1 lds
    buffer_load_dwordx4 v33, s[32:35], s60 offen offset:3072 sc1 lds
    s_mov_b32 s61, 2297344
    s_add_u32 m0, s58, 114688
    s_nop 0
    buffer_load_dwordx4 v34, s[40:43], s61 offen offset:0 lds
    buffer_load_dwordx4 v35, s[40:43], s61 offen offset:1024 lds
    buffer_load_dwordx4 v36, s[40:43], s61 offen offset:2048 lds
    buffer_load_dwordx4 v37, s[40:43], s61 offen offset:3072 lds
    s_waitcnt vmcnt(12)
    s_barrier
    s_mov_b32 s60, 4194944
    s_add_u32 m0, s58, 81920
    s_nop 0
    buffer_load_dwordx4 v30, s[32:35], s60 offen offset:0 sc1 lds
    buffer_load_dwordx4 v31, s[32:35], s60 offen offset:1024 sc1 lds
    buffer_load_dwordx4 v32, s[32:35], s60 offen offset:2048 sc1 lds
    buffer_load_dwordx4 v33, s[32:35], s60 offen offset:3072 sc1 lds
    s_mov_b32 s61, 2756096
    s_add_u32 m0, s58, 131072
    s_nop 0
    buffer_load_dwordx4 v34, s[40:43], s61 offen offset:0 lds
    buffer_load_dwordx4 v35, s[40:43], s61 offen offset:1024 lds
    buffer_load_dwordx4 v36, s[40:43], s61 offen offset:2048 lds
    buffer_load_dwordx4 v37, s[40:43], s61 offen offset:3072 lds
    s_cmp_lg_u32 s48, 0
    s_cbranch_scc1 mega_kernel_skip28
    v_and_b32 v8, 15, v1
    v_lshlrev_b32 v8, 2, v8
    s_lshl_b32 s50, s26, 7
    s_add_u32 s50, s50, 27269120
    v_mov_b32 v9, s50
    v_add_u32 v8, v8, v9
    buffer_load_dword v9, v8, s[32:35], 0 offen sc1
mega_kernel_skip28:
    s_waitcnt vmcnt(12)
    s_barrier
    s_mov_b32 s60, 4195072
    s_add_u32 m0, s58, 49152
    s_nop 0
    buffer_load_dwordx4 v30, s[32:35], s60 offen offset:0 sc1 lds
    buffer_load_dwordx4 v31, s[32:35], s60 offen offset:1024 sc1 lds
    buffer_load_dwordx4 v32, s[32:35], s60 offen offset:2048 sc1 lds
    buffer_load_dwordx4 v33, s[32:35], s60 offen offset:3072 sc1 lds
    s_mov_b32 s61, 3214848
    s_add_u32 m0, s58, 147456
    s_nop 0
    buffer_load_dwordx4 v34, s[40:43], s61 offen offset:0 lds
    buffer_load_dwordx4 v35, s[40:43], s61 offen offset:1024 lds
    buffer_load_dwordx4 v36, s[40:43], s61 offen offset:2048 lds
    buffer_load_dwordx4 v37, s[40:43], s61 offen offset:3072 lds
    s_waitcnt vmcnt(12)
    s_barrier
    s_mov_b32 s60, 4195200
    s_add_u32 m0, s58, 65536
    s_nop 0
    buffer_load_dwordx4 v30, s[32:35], s60 offen offset:0 sc1 lds
    buffer_load_dwordx4 v31, s[32:35], s60 offen offset:1024 sc1 lds
    buffer_load_dwordx4 v32, s[32:35], s60 offen offset:2048 sc1 lds
    buffer_load_dwordx4 v33, s[32:35], s60 offen offset:3072 sc1 lds
    s_mov_b32 s61, 3673600
    s_add_u32 m0, s58, 98304
    s_nop 0
    buffer_load_dwordx4 v34, s[40:43], s61 offen offset:0 lds
    buffer_load_dwordx4 v35, s[40:43], s61 offen offset:1024 lds
    buffer_load_dwordx4 v36, s[40:43], s61 offen offset:2048 lds
    buffer_load_dwordx4 v37, s[40:43], s61 offen offset:3072 lds
    s_waitcnt vmcnt(12)
    s_cmp_lg_u32 s48, 0
    s_cbranch_scc1 mega_kernel_skip29
    s_waitcnt vmcnt(12)
    v_cmp_eq_u32 vcc, s31, v9
    s_nop 3
    s_and_b32 s50, vcc_lo, 0xff00
    s_xor_b32 s50, s50, 0xff00
    s_lshl_b32 s51, 1, s27
    s_andn2_b32 s50, s50, s51
    s_cmp_eq_u32 s50, 0
    s_cbranch_scc1 mega_kernel_ok30
    s_mov_b32 s54, 0
mega_kernel_spin31:
    buffer_load_dword v9, v8, s[32:35], 0 offen sc1
    s_waitcnt vmcnt(0)
    v_cmp_eq_u32 vcc, s31, v9
    s_nop 3
    s_and_b32 s50, vcc_lo, 0xff00
    s_xor_b32 s50, s50, 0xff00
    s_lshl_b32 s51, 1, s27
    s_andn2_b32 s50, s50, s51
    s_cmp_eq_u32 s50, 0
    s_cbranch_scc1 mega_kernel_ok30
    s_sleep 1
    s_add_u32 s54, s54, 1
    s_cmp_lt_u32 s54, 30000
    s_cbranch_scc1 mega_kernel_spin31
mega_kernel_ok30:
mega_kernel_skip29:
    s_barrier
    s_mov_b32 s60, 4195328
    s_add_u32 m0, s58, 81920
    s_nop 0
    buffer_load_dwordx4 v30, s[32:35], s60 offen offset:0 sc1 lds
    buffer_load_dwordx4 v31, s[32:35], s60 offen offset:1024 sc1 lds
    buffer_load_dwordx4 v32, s[32:35], s60 offen offset:2048 sc1 lds
    buffer_load_dwordx4 v33, s[32:35], s60 offen offset:3072 sc1 lds
    s_mov_b32 s61, 4132352
    s_add_u32 m0, s58, 114688
    s_nop 0
    buffer_load_dwordx4 v34, s[40:43], s61 offen offset:0 lds
    buffer_load_dwordx4 v35, s[40:43], s61 offen offset:1024 lds
    buffer_load_dwordx4 v36, s[40:43], s61 offen offset:2048 lds
    buffer_load_dwordx4 v37, s[40:43], s61 offen offset:3072 lds
    s_lshl_b32 s52, s26, 7
    s_lshl_b32 s53, s48, 5
    s_add_u32 s52, s52, s53
    s_lshl_b32 s52, s52, 3
    s_add_u32 s52, s52, 25821184
    v_lshlrev_b32 v50, 14, v4
    v_and_b32 v51, 15, v1
    v_lshlrev_b32 v51, 4, v51
    v_add_u32 v50, v50, v51
    buffer_load_dwordx4 v[104:107], v50, s[32:35], s52 offen sc1
    s_add_u32 s52, s52, 65536
    buffer_load_dwordx4 v[108:111], v50, s[32:35], s52 offen sc1
    s_add_u32 s52, s52, 65536
    buffer_load_dwordx4 v[112:115], v50, s[32:35], s52 offen sc1
    s_add_u32 s52, s52, 65536
    buffer_load_dwordx4 v[116:119], v50, s[32:35], s52 offen sc1
    s_add_u32 s52, s52, 65536
    buffer_load_dwordx4 v[120:123], v50, s[32:35], s52 offen sc1
    s_add_u32 s52, s52, 65536
    buffer_load_dwordx4 v[124:127], v50, s[32:35], s52 offen sc1
    s_add_u32 s52, s52, 65536
    buffer_load_dwordx4 v[128:131], v50, s[32:35], s52 offen sc1
    s_add_u32 s52, s52, 65536
    buffer_load_dwordx4 v[132:135], v50, s[32:35], s52 offen sc1
    s_mov_b32 s44, s16
    s_and_b32 s45, s17, 0xffff
    s_mov_b32 s46, 4096
    s_mov_b32 s47, 0x20000
    s_lshl_b32 s52, s26, 7
    s_lshl_b32 s53, s48, 5
    s_add_u32 s52, s52, s53
    s_lshl_b32 s52, s52, 1
    v_lshlrev_b32 v53, 1, v1
    buffer_load_ushort v96, v53, s[44:47], s52 offen
    s_waitcnt vmcnt(21)
    s_barrier
    s_mov_b32 s60, 4195456
    s_add_u32 m0, s58, 49152
    s_nop 0
    buffer_load_dwordx4 v30, s[32:35], s60 offen offset:0 sc1 lds
    buffer_load_dwordx4 v31, s[32:35], s60 offen offset:1024 sc1 lds
    buffer_load_dwordx4 v32, s[32:35], s60 offen offset:2048 sc1 lds
    buffer_load_dwordx4 v33, s[32:35], s60 offen offset:3072 sc1 lds
    s_mov_b32 s61, 4591104
    s_add_u32 m0, s58, 131072
    s_nop 0
    buffer_load_dwordx4 v34, s[40:43], s61 offen offset:0 lds
    buffer_load_dwordx4 v35, s[40:43], s61 offen offset:1024 lds
    buffer_load_dwordx4 v36, s[40:43], s61 offen offset:2048 lds
    buffer_load_dwordx4 v37, s[40:43], s61 offen offset:3072 lds
    s_cmp_lg_u32 s48, 0
    s_cbranch_scc1 mega_kernel_skip32
    v_and_b32 v8, 15, v1
    v_lshlrev_b32 v8, 2, v8
    s_lshl_b32 s50, s27, 7
    s_add_u32 s50, s50, 27271168
    v_mov_b32 v9, s50
    v_add_u32 v8, v8, v9
    buffer_load_dword v9, v8, s[32:35], 0 offen sc1
mega_kernel_skip32:
    s_waitcnt vmcnt(21)
    s_barrier
    s_mov_b32 s60, 4195584
    s_add_u32 m0, s58, 65536
    s_nop 0
    buffer_load_dwordx4 v30, s[32:35], s60 offen offset:0 sc1 lds
    buffer_load_dwordx4 v31, s[32:35], s60 offen offset:1024 sc1 lds
    buffer_load_dwordx4 v32, s[32:35], s60 offen offset:2048 sc1 lds
    buffer_load_dwordx4 v33, s[32:35], s60 offen offset:3072 sc1 lds
    s_mov_b32 s61, 5049856
    s_add_u32 m0, s58, 147456
    s_nop 0
    buffer_load_dwordx4 v34, s[40:43], s61 offen offset:0 lds
    buffer_load_dwordx4 v35, s[40:43], s61 offen offset:1024 lds
    buffer_load_dwordx4 v36, s[40:43], s61 offen offset:2048 lds
    buffer_load_dwordx4 v37, s[40:43], s61 offen offset:3072 lds
    s_waitcnt vmcnt(12)
    s_barrier
    s_mov_b32 s60, 4195712
    s_add_u32 m0, s58, 81920
    s_nop 0
    buffer_load_dwordx4 v30, s[32:35], s60 offen offset:0 sc1 lds
    buffer_load_dwordx4 v31, s[32:35], s60 offen offset:1024 sc1 lds
    buffer_load_dwordx4 v32, s[32:35], s60 offen offset:2048 sc1 lds
    buffer_load_dwordx4 v33, s[32:35], s60 offen offset:3072 sc1 lds
    s_mov_b32 s61, 5508608
    s_add_u32 m0, s58, 98304
    s_nop 0
    buffer_load_dwordx4 v34, s[40:43], s61 offen offset:0 lds
    buffer_load_dwordx4 v35, s[40:43], s61 offen offset:1024 lds
    buffer_load_dwordx4 v36, s[40:43], s61 offen offset:2048 lds
    buffer_load_dwordx4 v37, s[40:43], s61 offen offset:3072 lds
    s_cmp_lg_u32 s48, 0
    s_cbranch_scc1 mega_kernel_skip33
    s_waitcnt vmcnt(16)
    v_cmp_eq_u32 vcc, s31, v9
    s_nop 3
    s_and_b32 s50, vcc_lo, 0xffff
    s_xor_b32 s50, s50, 0xffff
    s_cmp_eq_u32 s50, 0
    s_cbranch_scc1 mega_kernel_ok34
    s_mov_b32 s54, 0
mega_kernel_spin35:
    buffer_load_dword v9, v8, s[32:35], 0 offen sc1
    s_waitcnt vmcnt(0)
    v_cmp_eq_u32 vcc, s31, v9
    s_nop 3
    s_and_b32 s50, vcc_lo, 0xffff
    s_xor_b32 s50, s50, 0xffff
    s_cmp_eq_u32 s50, 0
    s_cbranch_scc1 mega_kernel_ok34
    s_sleep 1
    s_add_u32 s54, s54, 1
    s_cmp_lt_u32 s54, 30000
    s_cbranch_scc1 mega_kernel_spin35
mega_kernel_ok34:
mega_kernel_skip33:
    s_waitcnt vmcnt(12)
    s_barrier
    s_mov_b32 s60, 4195840
    s_add_u32 m0, s58, 49152
    s_nop 0
    buffer_load_dwordx4 v30, s[32:35], s60 offen offset:0 sc1 lds
    buffer_load_dwordx4 v31, s[32:35], s60 offen offset:1024 sc1 lds
    buffer_load_dwordx4 v32, s[32:35], s60 offen offset:2048 sc1 lds
    buffer_load_dwordx4 v33, s[32:35], s60 offen offset:3072 sc1 lds
    s_mov_b32 s61, 5967360
    s_add_u32 m0, s58, 114688
    s_nop 0
    buffer_load_dwordx4 v34, s[40:43], s61 offen offset:0 lds
    buffer_load_dwordx4 v35, s[40:43], s61 offen offset:1024 lds
    buffer_load_dwordx4 v36, s[40:43], s61 offen offset:2048 lds
    buffer_load_dwordx4 v37, s[40:43], s61 offen offset:3072 lds
    s_lshl_b32 s53, s27, 14
    s_lshl_b32 s54, s48, 8
    s_add_u32 s53, s53, s54
    s_add_u32 s53, s53, 25493504
    v_lshlrev_b32 v51, 10, v4
    v_and_b32 v52, 15, v1
    v_lshlrev_b32 v52, 4, v52
    v_add_u32 v51, v51, v52
    buffer_load_dwordx4 v[80:83], v51, s[32:35], s53 offen sc1
    s_add_u32 s53, s53, 4096
    buffer_load_dwordx4 v[84:87], v51, s[32:35], s53 offen sc1
    s_add_u32 s53, s53, 4096
    buffer_load_dwordx4 v[88:91], v51, s[32:35], s53 offen sc1
    s_add_u32 s53, s53, 4096
    buffer_load_dwordx4 v[92:95], v51, s[32:35], s53 offen sc1
    v_add_f32 v104, v104, v108
    v_add_f32 v105, v105, v109
    v_add_f32 v106, v106, v110
    v_add_f32 v107, v107, v111
    v_add_f32 v104, v104, v112
    v_add_f32 v105, v105, v113
    v_add_f32 v106, v106, v114
    v_add_f32 v107, v107, v115
    v_add_f32 v104, v104, v116
    v_add_f32 v105, v105, v117
    v_add_f32 v106, v106, v118
    v_add_f32 v107, v107, v119
    v_add_f32 v104, v104, v120
    v_add_f32 v105, v105, v121
    v_add_f32 v106, v106, v122
    v_add_f32 v107, v107, v123
    v_add_f32 v104, v104, v124
    v_add_f32 v105, v105, v125
    v_add_f32 v106, v106, v126
    v_add_f32 v107, v107, v127
    v_add_f32 v104, v104, v128
    v_add_f32 v105, v105, v129
    v_add_f32 v106, v106, v130
    v_add_f32 v107, v107, v131
    v_add_f32 v104, v104, v132
    v_add_f32 v105, v105, v133
    v_add_f32 v106, v106, v134
    v_add_f32 v107, v107, v135
    s_waitcnt vmcnt(16)
    s_barrier
    s_mov_b32 s60, 4195968
    s_add_u32 m0, s58, 65536
    s_nop 0
    buffer_load_dwordx4 v30, s[32:35], s60 offen offset:0 sc1 lds
    buffer_load_dwordx4 v31, s[32:35], s60 offen offset:1024 sc1 lds
    buffer_load_dwordx4 v32, s[32:35], s60 offen offset:2048 sc1 lds
    buffer_load_dwordx4 v33, s[32:35], s60 offen offset:3072 sc1 lds
    s_mov_b32 s61, 6426112
    s_add_u32 m0, s58, 131072
    s_nop 0
    buffer_load_dwordx4 v34, s[40:43], s61 offen offset:0 lds
    buffer_load_dwordx4 v35, s[40:43], s61 offen offset:1024 lds
    buffer_load_dwordx4 v36, s[40:43], s61 offen offset:2048 lds
    buffer_load_dwordx4 v37, s[40:43], s61 offen offset:3072 lds
    v_mov_b32 v108, v104
    v_mov_b32 v109, v105
    v_mov_b32 v110, v106
    v_mov_b32 v111, v107
    v_permlane32_swap_b32 v104, v108
    v_permlane32_swap_b32 v105, v109
    v_permlane32_swap_b32 v106, v110
    v_permlane32_swap_b32 v107, v111
    v_add_f32 v104, v104, v108
    v_add_f32 v105, v105, v109
    v_add_f32 v106, v106, v110
    v_add_f32 v107, v107, v111
    v_mov_b32 v108, v104
    v_mov_b32 v109, v105
    v_mov_b32 v110, v106
    v_mov_b32 v111, v107
    v_permlane16_swap_b32 v104, v108
    v_permlane16_swap_b32 v105, v109
    v_permlane16_swap_b32 v106, v110
    v_permlane16_swap_b32 v107, v111
    v_add_f32 v104, v104, v108
    v_add_f32 v105, v105, v109
    v_add_f32 v106, v106, v110
    v_add_f32 v107, v107, v111
    s_waitcnt vmcnt(16)
    s_barrier
    s_mov_b32 s60, 4196096
    s_add_u32 m0, s58, 81920
    s_nop 0
    buffer_load_dwordx4 v30, s[32:35], s60 offen offset:0 sc1 lds
    buffer_load_dwordx4 v31, s[32:35], s60 offen offset:1024 sc1 lds
    buffer_load_dwordx4 v32, s[32:35], s60 offen offset:2048 sc1 lds
    buffer_load_dwordx4 v33, s[32:35], s60 offen offset:3072 sc1 lds
    s_mov_b32 s61, 6884864
    s_add_u32 m0, s58, 147456
    s_nop 0
    buffer_load_dwordx4 v34, s[40:43], s61 offen offset:0 lds
    buffer_load_dwordx4 v35, s[40:43], s61 offen offset:1024 lds
    buffer_load_dwordx4 v36, s[40:43], s61 offen offset:2048 lds
    buffer_load_dwordx4 v37, s[40:43], s61 offen offset:3072 lds
    s_mov_b32 s52, 981467136
    s_mov_b32 s53, 925353388
    v_mul_f32 v104, s52, v104
    v_mul_f32 v105, s52, v105
    v_fma_f32 v105, -v104, v104, v105
    v_max_f32 v105, 0, v105
    v_add_f32 v105, s53, v105
    v_rsq_f32 v108, v105
    s_nop 0
    v_mul_f32 v110, v104, v108
    v_sub_f32 v110, 0, v110
    v_mul_f32 v106, s52, v106
    v_mul_f32 v107, s52, v107
    v_fma_f32 v107, -v106, v106, v107
    v_max_f32 v107, 0, v107
    v_add_f32 v107, s53, v107
    v_rsq_f32 v109, v107
    s_nop 0
    v_mul_f32 v111, v106, v109
    v_sub_f32 v111, 0, v111
    v_and_b32 v100, 15, v1
    v_lshlrev_b32 v100, 3, v100
    s_lshl_b32 s52, s48, 7
    v_add_u32 v100, s52, v100
    ds_write_b64 v100, v[108:109] offset:0
    ds_write_b64 v100, v[110:111] offset:512
    v_lshlrev_b32 v96, 16, v96
    v_lshlrev_b32 v53, 2, v1
    s_lshl_b32 s54, s48, 7
    v_add_u32 v53, s54, v53
    s_mov_b64 s[54:55], exec
    s_mov_b64 exec, 0xffffffff
    ds_write_b32 v53, v96 offset:3072
    s_mov_b64 exec, s[54:55]
    s_waitcnt lgkmcnt(0)
    s_waitcnt vmcnt(12)
    s_barrier
    s_mov_b32 s60, 4196224
    s_add_u32 m0, s58, 49152
    s_nop 0
    buffer_load_dwordx4 v30, s[32:35], s60 offen offset:0 sc1 lds
    buffer_load_dwordx4 v31, s[32:35], s60 offen offset:1024 sc1 lds
    buffer_load_dwordx4 v32, s[32:35], s60 offen offset:2048 sc1 lds
    buffer_load_dwordx4 v33, s[32:35], s60 offen offset:3072 sc1 lds
    s_mov_b32 s61, 0
    s_add_u32 m0, s58, 98304
    s_nop 0
    buffer_load_dwordx4 v34, s[40:43], s61 offen offset:0 lds
    buffer_load_dwordx4 v35, s[40:43], s61 offen offset:1024 lds
    buffer_load_dwordx4 v36, s[40:43], s61 offen offset:2048 lds
    buffer_load_dwordx4 v37, s[40:43], s61 offen offset:3072 lds
    v_add_f32 v80, v80, v84
    v_add_f32 v88, v88, v92
    v_add_f32 v81, v81, v85
    v_add_f32 v89, v89, v93
    v_add_f32 v82, v82, v86
    v_add_f32 v90, v90, v94
    v_add_f32 v83, v83, v87
    v_add_f32 v91, v91, v95
    v_add_f32 v80, v80, v88
    v_add_f32 v81, v81, v89
    v_add_f32 v82, v82, v90
    v_add_f32 v83, v83, v91
    s_waitcnt vmcnt(12)
    s_barrier
    s_mov_b32 s60, 4194304
    s_add_u32 m0, s58, 65536
    s_nop 0
    buffer_load_dwordx4 v30, s[32:35], s60 offen offset:0 sc1 lds
    buffer_load_dwordx4 v31, s[32:35], s60 offen offset:1024 sc1 lds
    buffer_load_dwordx4 v32, s[32:35], s60 offen offset:2048 sc1 lds
    buffer_load_dwordx4 v33, s[32:35], s60 offen offset:3072 sc1 lds
    s_mov_b32 s61, 458752
    s_add_u32 m0, s58, 114688
    s_nop 0
    buffer_load_dwordx4 v34, s[40:43], s61 offen offset:0 lds
    buffer_load_dwordx4 v35, s[40:43], s61 offen offset:1024 lds
    buffer_load_dwordx4 v36, s[40:43], s61 offen offset:2048 lds
    buffer_load_dwordx4 v37, s[40:43], s61 offen offset:3072 lds
    v_mov_b32 v84, v80
    v_mov_b32 v85, v81
    v_mov_b32 v86, v82
    v_mov_b32 v87, v83
    v_permlane32_swap_b32 v80, v84
    v_permlane32_swap_b32 v81, v85
    v_permlane32_swap_b32 v82, v86
    v_permlane32_swap_b32 v83, v87
    v_add_f32 v80, v80, v84
    v_add_f32 v81, v81, v85
    v_add_f32 v82, v82, v86
    v_add_f32 v83, v83, v87
    v_mov_b32 v84, v80
    v_mov_b32 v85, v81
    v_mov_b32 v86, v82
    v_mov_b32 v87, v83
    v_permlane16_swap_b32 v80, v84
    v_permlane16_swap_b32 v81, v85
    v_permlane16_swap_b32 v82, v86
    v_permlane16_swap_b32 v83, v87
    v_add_f32 v80, v80, v84
    v_add_f32 v81, v81, v85
    v_add_f32 v82, v82, v86
    v_add_f32 v83, v83, v87
    s_lshl_b32 s54, s48, 8
    v_and_b32 v52, 15, v1
    v_lshlrev_b32 v52, 4, v52
    v_add_u32 v52, s54, v52
    ds_write_b128 v52, v[80:83] offset:1024
    s_waitcnt lgkmcnt(0)
    s_waitcnt vmcnt(12)
    s_barrier
    s_mov_b32 s60, 4194432
    s_add_u32 m0, s58, 81920
    s_nop 0
    buffer_load_dwordx4 v30, s[32:35], s60 offen offset:0 sc1 lds
    buffer_load_dwordx4 v31, s[32:35], s60 offen offset:1024 sc1 lds
    buffer_load_dwordx4 v32, s[32:35], s60 offen offset:2048 sc1 lds
    buffer_load_dwordx4 v33, s[32:35], s60 offen offset:3072 sc1 lds
    s_mov_b32 s61, 917504
    s_add_u32 m0, s58, 131072
    s_nop 0
    buffer_load_dwordx4 v34, s[40:43], s61 offen offset:0 lds
    buffer_load_dwordx4 v35, s[40:43], s61 offen offset:1024 lds
    buffer_load_dwordx4 v36, s[40:43], s61 offen offset:2048 lds
    buffer_load_dwordx4 v37, s[40:43], s61 offen offset:3072 lds
    s_waitcnt vmcnt(12)
    s_barrier
    s_mov_b32 s60, 4194560
    s_add_u32 m0, s58, 49152
    s_nop 0
    buffer_load_dwordx4 v30, s[32:35], s60 offen offset:0 sc1 lds
    buffer_load_dwordx4 v31, s[32:35], s60 offen offset:1024 sc1 lds
    buffer_load_dwordx4 v32, s[32:35], s60 offen offset:2048 sc1 lds
    buffer_load_dwordx4 v33, s[32:35], s60 offen offset:3072 sc1 lds
    s_mov_b32 s61, 1376256
    s_add_u32 m0, s58, 147456
    s_nop 0
    buffer_load_dwordx4 v34, s[40:43], s61 offen offset:0 lds
    buffer_load_dwordx4 v35, s[40:43], s61 offen offset:1024 lds
    buffer_load_dwordx4 v36, s[40:43], s61 offen offset:2048 lds
    buffer_load_dwordx4 v37, s[40:43], s61 offen offset:3072 lds
    s_mov_b32 s52, 3222493025
    v_mov_b32 v46, s52
    s_mov_b32 s52, 3184710632
    v_mov_b32 v48, s52
    v_mov_b32 v50, 1.0
    s_and_b32 s52, s48, 1
    s_lshl_b32 s52, s52, 14
    s_add_u32 s52, s52, 24576
    s_lshr_b32 s53, s48, 1
    s_lshl_b32 s53, s53, 3
    v_or_b32 v62, s53, v3
    v_xor_b32 v62, v62, v2
    v_lshlrev_b32 v63, 8, v2
    v_add_u32 v63, s52, v63
    v_lshlrev_b32 v60, 4, v62
    v_add_u32 v60, v60, v63
    v_xor_b32 v61, 8, v62
    v_lshlrev_b32 v61, 4, v61
    v_add_u32 v61, v61, v63
    s_barrier
    ds_read_b128 v[64:67], v60 offset:0
    ds_read_b128 v[68:71], v61 offset:2048
    ds_read_b128 v[72:75], v60 offset:4096
    ds_read_b128 v[76:79], v61 offset:6144
    s_mov_b32 s54, 0x3f803f80
    s_waitcnt lgkmcnt(0)
    v_lshlrev_b32 v96, 16, v64
    v_and_b32 v97, 0xffff0000, v64
    v_lshlrev_b32 v98, 16, v65
    v_and_b32 v99, 0xffff0000, v65
    v_lshlrev_b32 v100, 16, v66
    v_and_b32 v101, 0xffff0000, v66
    v_lshlrev_b32 v102, 16, v67
    v_and_b32 v103, 0xffff0000, v67
    v_lshlrev_b32 v104, 16, v68
    v_and_b32 v105, 0xffff0000, v68
    v_lshlrev_b32 v106, 16, v69
    v_and_b32 v107, 0xffff0000, v69
    v_lshlrev_b32 v108, 16, v70
    v_and_b32 v109, 0xffff0000, v70
    v_lshlrev_b32 v110, 16, v71
    v_and_b32 v111, 0xffff0000, v71
    v_lshlrev_b32 v112, 16, v72
    v_and_b32 v113, 0xffff0000, v72
    v_lshlrev_b32 v114, 16, v73
    v_and_b32 v115, 0xffff0000, v73
    v_lshlrev_b32 v116, 16, v74
    v_and_b32 v117, 0xffff0000, v74
    v_lshlrev_b32 v118, 16, v75
    v_and_b32 v119, 0xffff0000, v75
    v_lshlrev_b32 v120, 16, v76
    v_and_b32 v121, 0xffff0000, v76
    v_lshlrev_b32 v122, 16, v77
    v_and_b32 v123, 0xffff0000, v77
    v_lshlrev_b32 v124, 16, v78
    v_and_b32 v125, 0xffff0000, v78
    v_lshlrev_b32 v126, 16, v79
    v_and_b32 v127, 0xffff0000, v79
    v_pk_mul_f32 v[128:129], v[96:97], v[96:97]
    v_pk_mul_f32 v[130:131], v[98:99], v[98:99]
    v_pk_mul_f32 v[132:133], v[100:101], v[100:101]
    v_pk_mul_f32 v[134:135], v[102:103], v[102:103]
    v_pk_mul_f32 v[136:137], v[104:105], v[104:105]
    v_pk_mul_f32 v[138:139], v[106:107], v[106:107]
    v_pk_mul_f32 v[140:141], v[108:109], v[108:109]
    v_pk_mul_f32 v[142:143], v[110:111], v[110:111]
    v_pk_fma_f32 v[128:129], v[128:129], v[48:49], v[46:47] op_sel_hi:[1,0,0]
    v_pk_fma_f32 v[130:131], v[130:131], v[48:49], v[46:47] op_sel_hi:[1,0,0]
    v_pk_fma_f32 v[132:133], v[132:133], v[48:49], v[46:47] op_sel_hi:[1,0,0]
    v_pk_fma_f32 v[134:135], v[134:135], v[48:49], v[46:47] op_sel_hi:[1,0,0]
    v_pk_fma_f32 v[136:137], v[136:137], v[48:49], v[46:47] op_sel_hi:[1,0,0]
    v_pk_fma_f32 v[138:139], v[138:139], v[48:49], v[46:47] op_sel_hi:[1,0,0]
    v_pk_fma_f32 v[140:141], v[140:141], v[48:49], v[46:47] op_sel_hi:[1,0,0]
    v_pk_fma_f32 v[142:143], v[142:143], v[48:49], v[46:47] op_sel_hi:[1,0,0]
    v_pk_mul_f32 v[128:129], v[128:129], v[96:97]
    v_pk_mul_f32 v[130:131], v[130:131], v[98:99]
    v_pk_mul_f32 v[132:133], v[132:133], v[100:101]
    v_pk_mul_f32 v[134:135], v[134:135], v[102:103]
    v_pk_mul_f32 v[136:137], v[136:137], v[104:105]
    v_pk_mul_f32 v[138:139], v[138:139], v[106:107]
    v_pk_mul_f32 v[140:141], v[140:141], v[108:109]
    v_pk_mul_f32 v[142:143], v[142:143], v[110:111]
    v_exp_f32 v128, v128
    v_exp_f32 v129, v129
    v_exp_f32 v130, v130
    v_exp_f32 v131, v131
    v_exp_f32 v132, v132
    v_exp_f32 v133, v133
    v_exp_f32 v134, v134
    v_exp_f32 v135, v135
    v_exp_f32 v136, v136
    v_exp_f32 v137, v137
    v_exp_f32 v138, v138
    v_exp_f32 v139, v139
    v_exp_f32 v140, v140
    v_exp_f32 v141, v141
    v_exp_f32 v142, v142
    v_exp_f32 v143, v143
    v_pk_add_f32 v[128:129], v[128:129], v[50:51] op_sel_hi:[1,0]
    v_pk_add_f32 v[130:131], v[130:131], v[50:51] op_sel_hi:[1,0]
    v_pk_add_f32 v[132:133], v[132:133], v[50:51] op_sel_hi:[1,0]
    v_pk_add_f32 v[134:135], v[134:135], v[50:51] op_sel_hi:[1,0]
    v_pk_add_f32 v[136:137], v[136:137], v[50:51] op_sel_hi:[1,0]
    v_pk_add_f32 v[138:139], v[138:139], v[50:51] op_sel_hi:[1,0]
    v_pk_add_f32 v[140:141], v[140:141], v[50:51] op_sel_hi:[1,0]
    v_pk_add_f32 v[142:143], v[142:143], v[50:51] op_sel_hi:[1,0]
    v_rcp_f32 v128, v128
    v_rcp_f32 v129, v129
    v_rcp_f32 v130, v130
    v_rcp_f32 v131, v131
    v_rcp_f32 v132, v132
    v_rcp_f32 v133, v133
    v_rcp_f32 v134, v134
    v_rcp_f32 v135, v135
    v_rcp_f32 v136, v136
    v_rcp_f32 v137, v137
    v_rcp_f32 v138, v138
    v_rcp_f32 v139, v139
    v_rcp_f32 v140, v140
    v_rcp_f32 v141, v141
    v_rcp_f32 v142, v142
    v_rcp_f32 v143, v143
    v_pk_mul_f32 v[96:97], v[96:97], v[128:129]
    v_pk_mul_f32 v[98:99], v[98:99], v[130:131]
    v_pk_mul_f32 v[100:101], v[100:101], v[132:133]
    v_pk_mul_f32 v[102:103], v[102:103], v[134:135]
    v_pk_mul_f32 v[104:105], v[104:105], v[136:137]
    v_pk_mul_f32 v[106:107], v[106:107], v[138:139]
    v_pk_mul_f32 v[108:109], v[108:109], v[140:141]
    v_pk_mul_f32 v[110:111], v[110:111], v[142:143]
    v_pk_mul_f32 v[128:129], v[112:113], v[112:113]
    v_pk_mul_f32 v[130:131], v[114:115], v[114:115]
    v_pk_mul_f32 v[132:133], v[116:117], v[116:117]
    v_pk_mul_f32 v[134:135], v[118:119], v[118:119]
    v_pk_mul_f32 v[136:137], v[120:121], v[120:121]
    v_pk_mul_f32 v[138:139], v[122:123], v[122:123]
    v_pk_mul_f32 v[140:141], v[124:125], v[124:125]
    v_pk_mul_f32 v[142:143], v[126:127], v[126:127]
    v_pk_fma_f32 v[128:129], v[128:129], v[48:49], v[46:47] op_sel_hi:[1,0,0]
    v_pk_fma_f32 v[130:131], v[130:131], v[48:49], v[46:47] op_sel_hi:[1,0,0]
    v_pk_fma_f32 v[132:133], v[132:133], v[48:49], v[46:47] op_sel_hi:[1,0,0]
    v_pk_fma_f32 v[134:135], v[134:135], v[48:49], v[46:47] op_sel_hi:[1,0,0]
    v_pk_fma_f32 v[136:137], v[136:137], v[48:49], v[46:47] op_sel_hi:[1,0,0]
    v_pk_fma_f32 v[138:139], v[138:139], v[48:49], v[46:47] op_sel_hi:[1,0,0]
    v_pk_fma_f32 v[140:141], v[140:141], v[48:49], v[46:47] op_sel_hi:[1,0,0]
    v_pk_fma_f32 v[142:143], v[142:143], v[48:49], v[46:47] op_sel_hi:[1,0,0]
    v_pk_mul_f32 v[128:129], v[128:129], v[112:113]
    v_pk_mul_f32 v[130:131], v[130:131], v[114:115]
    v_pk_mul_f32 v[132:133], v[132:133], v[116:117]
    v_pk_mul_f32 v[134:135], v[134:135], v[118:119]
    v_pk_mul_f32 v[136:137], v[136:137], v[120:121]
    v_pk_mul_f32 v[138:139], v[138:139], v[122:123]
    v_pk_mul_f32 v[140:141], v[140:141], v[124:125]
    v_pk_mul_f32 v[142:143], v[142:143], v[126:127]
    v_exp_f32 v128, v128
    v_exp_f32 v129, v129
    v_exp_f32 v130, v130
    v_exp_f32 v131, v131
    v_exp_f32 v132, v132
    v_exp_f32 v133, v133
    v_exp_f32 v134, v134
    v_exp_f32 v135, v135
    v_exp_f32 v136, v136
    v_exp_f32 v137, v137
    v_exp_f32 v138, v138
    v_exp_f32 v139, v139
    v_exp_f32 v140, v140
    v_exp_f32 v141, v141
    v_exp_f32 v142, v142
    v_exp_f32 v143, v143
    v_pk_add_f32 v[128:129], v[128:129], v[50:51] op_sel_hi:[1,0]
    v_pk_add_f32 v[130:131], v[130:131], v[50:51] op_sel_hi:[1,0]
    v_pk_add_f32 v[132:133], v[132:133], v[50:51] op_sel_hi:[1,0]
    v_pk_add_f32 v[134:135], v[134:135], v[50:51] op_sel_hi:[1,0]
    v_pk_add_f32 v[136:137], v[136:137], v[50:51] op_sel_hi:[1,0]
    v_pk_add_f32 v[138:139], v[138:139], v[50:51] op_sel_hi:[1,0]
    v_pk_add_f32 v[140:141], v[140:141], v[50:51] op_sel_hi:[1,0]
    v_pk_add_f32 v[142:143], v[142:143], v[50:51] op_sel_hi:[1,0]
    v_rcp_f32 v128, v128
    v_rcp_f32 v129, v129
    v_rcp_f32 v130, v130
    v_rcp_f32 v131, v131
    v_rcp_f32 v132, v132
    v_rcp_f32 v133, v133
    v_rcp_f32 v134, v134
    v_rcp_f32 v135, v135
    v_rcp_f32 v136, v136
    v_rcp_f32 v137, v137
    v_rcp_f32 v138, v138
    v_rcp_f32 v139, v139
    v_rcp_f32 v140, v140
    v_rcp_f32 v141, v141
    v_rcp_f32 v142, v142
    v_rcp_f32 v143, v143
    v_pk_mul_f32 v[112:113], v[112:113], v[128:129]
    v_pk_mul_f32 v[114:115], v[114:115], v[130:131]
    v_pk_mul_f32 v[116:117], v[116:117], v[132:133]
    v_pk_mul_f32 v[118:119], v[118:119], v[134:135]
    v_pk_mul_f32 v[120:121], v[120:121], v[136:137]
    v_pk_mul_f32 v[122:123], v[122:123], v[138:139]
    v_pk_mul_f32 v[124:125], v[124:125], v[140:141]
    v_pk_mul_f32 v[126:127], v[126:127], v[142:143]
    v_cvt_pk_bf16_f32 v64, v96, v97
    v_cvt_pk_bf16_f32 v65, v98, v99
    v_cvt_pk_bf16_f32 v66, v100, v101
    v_cvt_pk_bf16_f32 v67, v102, v103
    ds_write_b128 v60, v[64:67] offset:0
    v_mov_b32 v80, 0
    v_mov_b32 v81, 0
    v_dot2c_f32_bf16 v80, s54, v64
    v_dot2c_f32_bf16 v81, v64, v64
    v_dot2c_f32_bf16 v80, s54, v65
    v_dot2c_f32_bf16 v81, v65, v65
    v_dot2c_f32_bf16 v80, s54, v66
    v_dot2c_f32_bf16 v81, v66, v66
    v_dot2c_f32_bf16 v80, s54, v67
    v_dot2c_f32_bf16 v81, v67, v67
    v_cvt_pk_bf16_f32 v68, v104, v105
    v_cvt_pk_bf16_f32 v69, v106, v107
    v_cvt_pk_bf16_f32 v70, v108, v109
    v_cvt_pk_bf16_f32 v71, v110, v111
    ds_write_b128 v61, v[68:71] offset:2048
    v_mov_b32 v82, 0
    v_mov_b32 v83, 0
    v_dot2c_f32_bf16 v82, s54, v68
    v_dot2c_f32_bf16 v83, v68, v68
    v_dot2c_f32_bf16 v82, s54, v69
    v_dot2c_f32_bf16 v83, v69, v69
    v_dot2c_f32_bf16 v82, s54, v70
    v_dot2c_f32_bf16 v83, v70, v70
    v_dot2c_f32_bf16 v82, s54, v71
    v_dot2c_f32_bf16 v83, v71, v71
    v_cvt_pk_bf16_f32 v72, v112, v113
    v_cvt_pk_bf16_f32 v73, v114, v115
    v_cvt_pk_bf16_f32 v74, v116, v117
    v_cvt_pk_bf16_f32 v75, v118, v119
    ds_write_b128 v60, v[72:75] offset:4096
    v_mov_b32 v84, 0
    v_mov_b32 v85, 0
    v_dot2c_f32_bf16 v84, s54, v72
    v_dot2c_f32_bf16 v85, v72, v72
    v_dot2c_f32_bf16 v84, s54, v73
    v_dot2c_f32_bf16 v85, v73, v73
    v_dot2c_f32_bf16 v84, s54, v74
    v_dot2c_f32_bf16 v85, v74, v74
    v_dot2c_f32_bf16 v84, s54, v75
    v_dot2c_f32_bf16 v85, v75, v75
    v_cvt_pk_bf16_f32 v76, v120, v121
    v_cvt_pk_bf16_f32 v77, v122, v123
    v_cvt_pk_bf16_f32 v78, v124, v125
    v_cvt_pk_bf16_f32 v79, v126, v127
    ds_write_b128 v61, v[76:79] offset:6144
    v_mov_b32 v86, 0
    v_mov_b32 v87, 0
    v_dot2c_f32_bf16 v86, s54, v76
    v_dot2c_f32_bf16 v87, v76, v76
    v_dot2c_f32_bf16 v86, s54, v77
    v_dot2c_f32_bf16 v87, v77, v77
    v_dot2c_f32_bf16 v86, s54, v78
    v_dot2c_f32_bf16 v87, v78, v78
    v_dot2c_f32_bf16 v86, s54, v79
    v_dot2c_f32_bf16 v87, v79, v79
    v_add_f32_dpp v80, v80, v80 quad_perm:[1,0,3,2] row_mask:0xf bank_mask:0xf
    v_add_f32_dpp v81, v81, v81 quad_perm:[1,0,3,2] row_mask:0xf bank_mask:0xf
    v_add_f32_dpp v82, v82, v82 quad_perm:[1,0,3,2] row_mask:0xf bank_mask:0xf
    v_add_f32_dpp v83, v83, v83 quad_perm:[1,0,3,2] row_mask:0xf bank_mask:0xf
    v_add_f32_dpp v84, v84, v84 quad_perm:[1,0,3,2] row_mask:0xf bank_mask:0xf
    v_add_f32_dpp v85, v85, v85 quad_perm:[1,0,3,2] row_mask:0xf bank_mask:0xf
    v_add_f32_dpp v86, v86, v86 quad_perm:[1,0,3,2] row_mask:0xf bank_mask:0xf
    v_add_f32_dpp v87, v87, v87 quad_perm:[1,0,3,2] row_mask:0xf bank_mask:0xf
    v_add_f32_dpp v80, v80, v80 quad_perm:[2,3,0,1] row_mask:0xf bank_mask:0xf
    v_add_f32_dpp v81, v81, v81 quad_perm:[2,3,0,1] row_mask:0xf bank_mask:0xf
    v_add_f32_dpp v82, v82, v82 quad_perm:[2,3,0,1] row_mask:0xf bank_mask:0xf
    v_add_f32_dpp v83, v83, v83 quad_perm:[2,3,0,1] row_mask:0xf bank_mask:0xf
    v_add_f32_dpp v84, v84, v84 quad_perm:[2,3,0,1] row_mask:0xf bank_mask:0xf
    v_add_f32_dpp v85, v85, v85 quad_perm:[2,3,0,1] row_mask:0xf bank_mask:0xf
    v_add_f32_dpp v86, v86, v86 quad_perm:[2,3,0,1] row_mask:0xf bank_mask:0xf
    v_add_f32_dpp v87, v87, v87 quad_perm:[2,3,0,1] row_mask:0xf bank_mask:0xf
    v_add_f32_dpp v80, v80, v80 row_half_mirror row_mask:0xf bank_mask:0xf
    v_add_f32_dpp v81, v81, v81 row_half_mirror row_mask:0xf bank_mask:0xf
    v_add_f32_dpp v82, v82, v82 row_half_mirror row_mask:0xf bank_mask:0xf
    v_add_f32_dpp v83, v83, v83 row_half_mirror row_mask:0xf bank_mask:0xf
    v_add_f32_dpp v84, v84, v84 row_half_mirror row_mask:0xf bank_mask:0xf
    v_add_f32_dpp v85, v85, v85 row_half_mirror row_mask:0xf bank_mask:0xf
    v_add_f32_dpp v86, v86, v86 row_half_mirror row_mask:0xf bank_mask:0xf
    v_add_f32_dpp v87, v87, v87 row_half_mirror row_mask:0xf bank_mask:0xf
    s_and_b32 s52, s48, 1
    s_lshl_b32 s52, s52, 10
    s_lshr_b32 s53, s48, 1
    s_lshl_b32 s53, s53, 3
    s_add_u32 s52, s52, s53
    v_lshlrev_b32 v62, 4, v2
    v_add_u32 v62, s52, v62
    v_cmp_eq_u32 vcc, 0, v3
    s_nop 3
    s_and_saveexec_b64 s[54:55], vcc
    ds_write_b64 v62, v[80:81] offset:4608
    ds_write_b64 v62, v[82:83] offset:4736
    ds_write_b64 v62, v[84:85] offset:4864
    ds_write_b64 v62, v[86:87] offset:4992
    s_mov_b64 exec, s[54:55]
    s_waitcnt lgkmcnt(0)
    s_waitcnt vmcnt(12)
    s_barrier
    s_mov_b32 s60, 4194688
    s_add_u32 m0, s58, 65536
    s_nop 0
    buffer_load_dwordx4 v30, s[32:35], s60 offen offset:0 sc1 lds
    buffer_load_dwordx4 v31, s[32:35], s60 offen offset:1024 sc1 lds
    buffer_load_dwordx4 v32, s[32:35], s60 offen offset:2048 sc1 lds
    buffer_load_dwordx4 v33, s[32:35], s60 offen offset:3072 sc1 lds
    s_mov_b32 s61, 1835008
    s_add_u32 m0, s58, 98304
    s_nop 0
    buffer_load_dwordx4 v34, s[40:43], s61 offen offset:0 lds
    buffer_load_dwordx4 v35, s[40:43], s61 offen offset:1024 lds
    buffer_load_dwordx4 v36, s[40:43], s61 offen offset:2048 lds
    buffer_load_dwordx4 v37, s[40:43], s61 offen offset:3072 lds
    s_lshl_b32 s52, s48, 9
    v_lshrrev_b32 v62, 1, v1
    v_lshlrev_b32 v62, 4, v62
    v_and_b32 v63, 1, v1
    v_lshlrev_b32 v63, 2, v63
    v_add3_u32 v62, v62, v63, s52
    ds_read_b32 v64, v62 offset:4096
    ds_read_b32 v65, v62 offset:4104
    s_lshl_b32 s52, s26, 7
    s_lshl_b32 s53, s48, 5
    s_add_u32 s52, s52, s53
    s_lshl_b32 s52, s52, 3
    s_add_u32 s99, s52, 26476544
    s_lshl_b32 s53, s49, 14
    s_add_u32 s52, s99, s53
    v_lshlrev_b32 v63, 2, v1
    v_lshlrev_b32 v55, 14, v4
    v_and_b32 v62, 15, v1
    v_lshlrev_b32 v62, 4, v62
    v_add_u32 v55, v55, v62
    s_waitcnt lgkmcnt(0)
    v_add_f32 v64, v64, v65
    buffer_store_dword v64, v63, s[32:35], s52 offen sc1
    s_waitcnt vmcnt(13)
    s_barrier
    s_mov_b32 s60, 4194816
    s_add_u32 m0, s58, 81920
    s_nop 0
    buffer_load_dwordx4 v30, s[32:35], s60 offen offset:0 sc1 lds
    buffer_load_dwordx4 v31, s[32:35], s60 offen offset:1024 sc1 lds
    buffer_load_dwordx4 v32, s[32:35], s60 offen offset:2048 sc1 lds
    buffer_load_dwordx4 v33, s[32:35], s60 offen offset:3072 sc1 lds
    s_mov_b32 s61, 2293760
    s_add_u32 m0, s58, 114688
    s_nop 0
    buffer_load_dwordx4 v34, s[40:43], s61 offen offset:0 lds
    buffer_load_dwordx4 v35, s[40:43], s61 offen offset:1024 lds
    buffer_load_dwordx4 v36, s[40:43], s61 offen offset:2048 lds
    buffer_load_dwordx4 v37, s[40:43], s61 offen offset:3072 lds
    s_waitcnt vmcnt(13)
    s_barrier
    s_mov_b32 s60, 4194944
    s_add_u32 m0, s58, 49152
    s_nop 0
    buffer_load_dwordx4 v30, s[32:35], s60 offen offset:0 sc1 lds
    buffer_load_dwordx4 v31, s[32:35], s60 offen offset:1024 sc1 lds
    buffer_load_dwordx4 v32, s[32:35], s60 offen offset:2048 sc1 lds
    buffer_load_dwordx4 v33, s[32:35], s60 offen offset:3072 sc1 lds
    s_mov_b32 s61, 2752512
    s_add_u32 m0, s58, 131072
    s_nop 0
    buffer_load_dwordx4 v34, s[40:43], s61 offen offset:0 lds
    buffer_load_dwordx4 v35, s[40:43], s61 offen offset:1024 lds
    buffer_load_dwordx4 v36, s[40:43], s61 offen offset:2048 lds
    buffer_load_dwordx4 v37, s[40:43], s61 offen offset:3072 lds
    s_add_u32 s53, s99, 0
    buffer_load_dwordx4 v[64:67], v55, s[32:35], s53 offen sc1
    s_add_u32 s53, s99, 65536
    buffer_load_dwordx4 v[68:71], v55, s[32:35], s53 offen sc1
    s_add_u32 s53, s99, 131072
    buffer_load_dwordx4 v[72:75], v55, s[32:35], s53 offen sc1
    s_add_u32 s53, s99, 196608
    buffer_load_dwordx4 v[76:79], v55, s[32:35], s53 offen sc1
    s_waitcnt vmcnt(16)
    s_barrier
    s_mov_b32 s60, 4195072
    s_add_u32 m0, s58, 65536
    s_nop 0
    buffer_load_dwordx4 v30, s[32:35], s60 offen offset:0 sc1 lds
    buffer_load_dwordx4 v31, s[32:35], s60 offen offset:1024 sc1 lds
    buffer_load_dwordx4 v32, s[32:35], s60 offen offset:2048 sc1 lds
    buffer_load_dwordx4 v33, s[32:35], s60 offen offset:3072 sc1 lds
    s_mov_b32 s61, 3211264
    s_add_u32 m0, s58, 147456
    s_nop 0
    buffer_load_dwordx4 v34, s[40:43], s61 offen offset:0 lds
    buffer_load_dwordx4 v35, s[40:43], s61 offen offset:1024 lds
    buffer_load_dwordx4 v36, s[40:43], s61 offen offset:2048 lds
    buffer_load_dwordx4 v37, s[40:43], s61 offen offset:3072 lds
    s_waitcnt vmcnt(16)
    s_barrier
    s_mov_b32 s60, 4195200
    s_add_u32 m0, s58, 81920
    s_nop 0
    buffer_load_dwordx4 v30, s[32:35], s60 offen offset:0 sc1 lds
    buffer_load_dwordx4 v31, s[32:35], s60 offen offset:1024 sc1 lds
    buffer_load_dwordx4 v32, s[32:35], s60 offen offset:2048 sc1 lds
    buffer_load_dwordx4 v33, s[32:35], s60 offen offset:3072 sc1 lds
    s_mov_b32 s61, 3670016
    s_add_u32 m0, s58, 98304
    s_nop 0
    buffer_load_dwordx4 v34, s[40:43], s61 offen offset:0 lds
    buffer_load_dwordx4 v35, s[40:43], s61 offen offset:1024 lds
    buffer_load_dwordx4 v36, s[40:43], s61 offen offset:2048 lds
    buffer_load_dwordx4 v37, s[40:43], s61 offen offset:3072 lds
    s_waitcnt vmcnt(16)
    s_mov_b32 s52, 0
mega_kernel_zspin37:
    v_mov_b32 v81, 0
    v_cmp_lt_u32 vcc, 31, v1
    s_nop 1
    v_cndmask_b32 v76, v76, v81, vcc
    v_cndmask_b32 v77, v77, v81, vcc
    v_cndmask_b32 v78, v78, v81, vcc
    v_cndmask_b32 v79, v79, v81, vcc
    v_max3_u32 v80, v64, v65, v66
    v_max3_u32 v80, v80, v67, v68
    v_max3_u32 v80, v80, v69, v70
    v_max3_u32 v80, v80, v71, v72
    v_max3_u32 v80, v80, v73, v74
    v_max3_u32 v80, v80, v75, v76
    v_max3_u32 v80, v80, v77, v78
    v_max_u32 v80, v80, v79
    v_cmp_eq_u32 vcc, -1, v80
    s_nop 3
    s_cmp_eq_u64 vcc, 0
    s_cbranch_scc1 mega_kernel_zok36
    s_sleep 1
    s_add_u32 s53, s99, 0
    buffer_load_dwordx4 v[64:67], v55, s[32:35], s53 offen sc1
    s_add_u32 s53, s99, 65536
    buffer_load_dwordx4 v[68:71], v55, s[32:35], s53 offen sc1
    s_add_u32 s53, s99, 131072
    buffer_load_dwordx4 v[72:75], v55, s[32:35], s53 offen sc1
    s_add_u32 s53, s99, 196608
    buffer_load_dwordx4 v[76:79], v55, s[32:35], s53 offen sc1
    s_waitcnt vmcnt(0)
    s_add_u32 s52, s52, 1
    s_cmp_lt_u32 s52, 30000
    s_cbranch_scc1 mega_kernel_zspin37
mega_kernel_zok36:
    v_add_f32 v64, v64, v68
    v_add_f32 v65, v65, v69
    v_add_f32 v66, v66, v70
    v_add_f32 v67, v67, v71
    v_add_f32 v64, v64, v72
    v_add_f32 v65, v65, v73
    v_add_f32 v66, v66, v74
    v_add_f32 v67, v67, v75
    v_add_f32 v64, v64, v76
    v_add_f32 v65, v65, v77
    v_add_f32 v66, v66, v78
    v_add_f32 v67, v67, v79
    v_mov_b32 v68, v64
    v_mov_b32 v69, v65
    v_mov_b32 v70, v66
    v_mov_b32 v71, v67
    v_permlane32_swap_b32 v64, v68
    v_permlane32_swap_b32 v65, v69
    v_permlane32_swap_b32 v66, v70
    v_permlane32_swap_b32 v67, v71
    v_add_f32 v64, v64, v68
    v_add_f32 v65, v65, v69
    v_add_f32 v66, v66, v70
    v_add_f32 v67, v67, v71
    v_mov_b32 v68, v64
    v_mov_b32 v69, v65
    v_mov_b32 v70, v66
    v_mov_b32 v71, v67
    v_permlane16_swap_b32 v64, v68
    v_permlane16_swap_b32 v65, v69
    v_permlane16_swap_b32 v66, v70
    v_permlane16_swap_b32 v67, v71
    v_add_f32 v64, v64, v68
    v_add_f32 v65, v65, v69
    v_add_f32 v66, v66, v70
    v_add_f32 v67, v67, v71
    s_mov_b32 s52, 974276901
    s_mov_b32 s53, 925353388
    v_mul_f32 v64, s52, v64
    v_mul_f32 v65, s52, v65
    v_fma_f32 v65, -v64, v64, v65
    v_max_f32 v65, 0, v65
    v_add_f32 v65, s53, v65
    v_rsq_f32 v68, v65
    s_nop 0
    v_mul_f32 v69, v64, v68
    v_sub_f32 v69, 0, v69
    v_mul_f32 v66, s52, v66
    v_mul_f32 v67, s52, v67
    v_fma_f32 v67, -v66, v66, v67
    v_max_f32 v67, 0, v67
    v_add_f32 v67, s53, v67
    v_rsq_f32 v70, v67
    s_nop 0
    v_mul_f32 v71, v66, v70
    v_sub_f32 v71, 0, v71
    v_and_b32 v63, 15, v1
    v_lshlrev_b32 v63, 4, v63
    s_lshl_b32 s52, s48, 8
    v_add_u32 v63, s52, v63
    ds_write_b128 v63, v[68:71] offset:2048
    v_and_b32 v62, 15, v1
    v_xor_b32 v62, v62, v4
    s_lshl_b32 s52, s48, 13
    s_add_u32 s52, s52, 16384
    v_lshlrev_b32 v63, 8, v4
    v_add_u32 v63, s52, v63
    v_xor_b32 v56, 0, v62
    v_lshlrev_b32 v56, 4, v56
    v_add_u32 v56, v56, v63
    v_xor_b32 v57, 4, v62
    v_lshlrev_b32 v57, 4, v57
    v_add_u32 v57, v57, v63
    v_xor_b32 v58, 8, v62
    v_lshlrev_b32 v58, 4, v58
    v_add_u32 v58, v58, v63
    v_xor_b32 v59, 12, v62
    v_lshlrev_b32 v59, 4, v59
    v_add_u32 v59, v59, v63
    s_lshl_b32 s52, s48, 8
    v_lshlrev_b32 v60, 3, v4
    v_add_u32 v60, s52, v60
    s_lshl_b32 s52, s26, 7
    s_lshl_b32 s53, s48, 5
    s_add_u32 s52, s52, s53
    v_add_u32 v61, s52, v4
    s_mov_b32 s53, 3584
    v_mul_lo_u32 v61, v61, s53
    v_and_b32 v62, 15, v1
    v_lshlrev_b32 v62, 4, v62
    v_add_u32 v61, v61, v62
    s_lshl_b32 s63, s49, 8
    s_add_u32 s63, s63, 8388608
    s_waitcnt lgkmcnt(0)
    s_waitcnt vmcnt(12)
    s_barrier
    s_mov_b32 s60, 4195328
    s_add_u32 m0, s58, 49152
    s_nop 0
    buffer_load_dwordx4 v30, s[32:35], s60 offen offset:0 sc1 lds
    buffer_load_dwordx4 v31, s[32:35], s60 offen offset:1024 sc1 lds
    buffer_load_dwordx4 v32, s[32:35], s60 offen offset:2048 sc1 lds
    buffer_load_dwordx4 v33, s[32:35], s60 offen offset:3072 sc1 lds
    s_mov_b32 s61, 4128768
    s_add_u32 m0, s58, 114688
    s_nop 0
    buffer_load_dwordx4 v34, s[40:43], s61 offen offset:0 lds
    buffer_load_dwordx4 v35, s[40:43], s61 offen offset:1024 lds
    buffer_load_dwordx4 v36, s[40:43], s61 offen offset:2048 lds
    buffer_load_dwordx4 v37, s[40:43], s61 offen offset:3072 lds
    ds_read_b128 v[64:67], v56 offset:0
    ds_read_b64 v[68:69], v60 offset:2048
    ds_read_b128 v[80:83], v57 offset:1024
    ds_read_b64 v[84:85], v60 offset:2080
    ds_read_b128 v[96:99], v58 offset:2048
    ds_read_b64 v[100:101], v60 offset:2112
    s_waitcnt lgkmcnt(0)
    v_lshlrev_b32 v70, 16, v64
    v_and_b32 v71, 0xffff0000, v64
    v_lshlrev_b32 v72, 16, v65
    v_and_b32 v73, 0xffff0000, v65
    v_lshlrev_b32 v74, 16, v66
    v_and_b32 v75, 0xffff0000, v66
    v_lshlrev_b32 v76, 16, v67
    v_and_b32 v77, 0xffff0000, v67
    v_fma_f32 v70, v70, v68, v69
    v_fma_f32 v71, v71, v68, v69
    v_fma_f32 v72, v72, v68, v69
    v_fma_f32 v73, v73, v68, v69
    v_fma_f32 v74, v74, v68, v69
    v_fma_f32 v75, v75, v68, v69
    v_fma_f32 v76, v76, v68, v69
    v_fma_f32 v77, v77, v68, v69
    v_cvt_pk_bf16_f32 v64, v70, v71
    v_cvt_pk_bf16_f32 v65, v72, v73
    v_cvt_pk_bf16_f32 v66, v74, v75
    v_cvt_pk_bf16_f32 v67, v76, v77
    s_add_u32 s53, s63, 0
    buffer_store_dwordx4 v[64:67], v61, s[32:35], s53 offen sc1
    v_lshlrev_b32 v86, 16, v80
    v_and_b32 v87, 0xffff0000, v80
    v_lshlrev_b32 v88, 16, v81
    v_and_b32 v89, 0xffff0000, v81
    v_lshlrev_b32 v90, 16, v82
    v_and_b32 v91, 0xffff0000, v82
    v_lshlrev_b32 v92, 16, v83
    v_and_b32 v93, 0xffff0000, v83
    v_fma_f32 v86, v86, v84, v85
    v_fma_f32 v87, v87, v84, v85
    v_fma_f32 v88, v88, v84, v85
    v_fma_f32 v89, v89, v84, v85
    v_fma_f32 v90, v90, v84, v85
    v_fma_f32 v91, v91, v84, v85
    v_fma_f32 v92, v92, v84, v85
    v_fma_f32 v93, v93, v84, v85
    v_cvt_pk_bf16_f32 v80, v86, v87
    v_cvt_pk_bf16_f32 v81, v88, v89
    v_cvt_pk_bf16_f32 v82, v90, v91
    v_cvt_pk_bf16_f32 v83, v92, v93
    s_add_u32 s53, s63, 14336
    buffer_store_dwordx4 v[80:83], v61, s[32:35], s53 offen sc1
    v_lshlrev_b32 v102, 16, v96
    v_and_b32 v103, 0xffff0000, v96
    v_lshlrev_b32 v104, 16, v97
    v_and_b32 v105, 0xffff0000, v97
    v_lshlrev_b32 v106, 16, v98
    v_and_b32 v107, 0xffff0000, v98
    v_lshlrev_b32 v108, 16, v99
    v_and_b32 v109, 0xffff0000, v99
    v_fma_f32 v102, v102, v100, v101
    v_fma_f32 v103, v103, v100, v101
    v_fma_f32 v104, v104, v100, v101
    v_fma_f32 v105, v105, v100, v101
    v_fma_f32 v106, v106, v100, v101
    v_fma_f32 v107, v107, v100, v101
    v_fma_f32 v108, v108, v100, v101
    v_fma_f32 v109, v109, v100, v101
    v_cvt_pk_bf16_f32 v96, v102, v103
    v_cvt_pk_bf16_f32 v97, v104, v105
    v_cvt_pk_bf16_f32 v98, v106, v107
    v_cvt_pk_bf16_f32 v99, v108, v109
    s_add_u32 s53, s63, 28672
    buffer_store_dwordx4 v[96:99], v61, s[32:35], s53 offen sc1
    s_waitcnt vmcnt(15)
    s_barrier
    s_mov_b32 s60, 4195456
    s_add_u32 m0, s58, 65536
    s_nop 0
    buffer_load_dwordx4 v30, s[32:35], s60 offen offset:0 sc1 lds
    buffer_load_dwordx4 v31, s[32:35], s60 offen offset:1024 sc1 lds
    buffer_load_dwordx4 v32, s[32:35], s60 offen offset:2048 sc1 lds
    buffer_load_dwordx4 v33, s[32:35], s60 offen offset:3072 sc1 lds
    s_mov_b32 s61, 4587520
    s_add_u32 m0, s58, 131072
    s_nop 0
    buffer_load_dwordx4 v34, s[40:43], s61 offen offset:0 lds
    buffer_load_dwordx4 v35, s[40:43], s61 offen offset:1024 lds
    buffer_load_dwordx4 v36, s[40:43], s61 offen offset:2048 lds
    buffer_load_dwordx4 v37, s[40:43], s61 offen offset:3072 lds
    ds_read_b128 v[64:67], v59 offset:3072
    ds_read_b64 v[68:69], v60 offset:2144
    ds_read_b128 v[80:83], v56 offset:4096
    ds_read_b64 v[84:85], v60 offset:2176
    ds_read_b128 v[96:99], v57 offset:5120
    ds_read_b64 v[100:101], v60 offset:2208
    s_waitcnt lgkmcnt(0)
    v_lshlrev_b32 v70, 16, v64
    v_and_b32 v71, 0xffff0000, v64
    v_lshlrev_b32 v72, 16, v65
    v_and_b32 v73, 0xffff0000, v65
    v_lshlrev_b32 v74, 16, v66
    v_and_b32 v75, 0xffff0000, v66
    v_lshlrev_b32 v76, 16, v67
    v_and_b32 v77, 0xffff0000, v67
    v_fma_f32 v70, v70, v68, v69
    v_fma_f32 v71, v71, v68, v69
    v_fma_f32 v72, v72, v68, v69
    v_fma_f32 v73, v73, v68, v69
    v_fma_f32 v74, v74, v68, v69
    v_fma_f32 v75, v75, v68, v69
    v_fma_f32 v76, v76, v68, v69
    v_fma_f32 v77, v77, v68, v69
    v_cvt_pk_bf16_f32 v64, v70, v71
    v_cvt_pk_bf16_f32 v65, v72, v73
    v_cvt_pk_bf16_f32 v66, v74, v75
    v_cvt_pk_bf16_f32 v67, v76, v77
    s_add_u32 s53, s63, 43008
    buffer_store_dwordx4 v[64:67], v61, s[32:35], s53 offen sc1
    v_lshlrev_b32 v86, 16, v80
    v_and_b32 v87, 0xffff0000, v80
    v_lshlrev_b32 v88, 16, v81
    v_and_b32 v89, 0xffff0000, v81
    v_lshlrev_b32 v90, 16, v82
    v_and_b32 v91, 0xffff0000, v82
    v_lshlrev_b32 v92, 16, v83
    v_and_b32 v93, 0xffff0000, v83
    v_fma_f32 v86, v86, v84, v85
    v_fma_f32 v87, v87, v84, v85
    v_fma_f32 v88, v88, v84, v85
    v_fma_f32 v89, v89, v84, v85
    v_fma_f32 v90, v90, v84, v85
    v_fma_f32 v91, v91, v84, v85
    v_fma_f32 v92, v92, v84, v85
    v_fma_f32 v93, v93, v84, v85
    v_cvt_pk_bf16_f32 v80, v86, v87
    v_cvt_pk_bf16_f32 v81, v88, v89
    v_cvt_pk_bf16_f32 v82, v90, v91
    v_cvt_pk_bf16_f32 v83, v92, v93
    s_add_u32 s53, s63, 57344
    buffer_store_dwordx4 v[80:83], v61, s[32:35], s53 offen sc1
    v_lshlrev_b32 v102, 16, v96
    v_and_b32 v103, 0xffff0000, v96
    v_lshlrev_b32 v104, 16, v97
    v_and_b32 v105, 0xffff0000, v97
    v_lshlrev_b32 v106, 16, v98
    v_and_b32 v107, 0xffff0000, v98
    v_lshlrev_b32 v108, 16, v99
    v_and_b32 v109, 0xffff0000, v99
    v_fma_f32 v102, v102, v100, v101
    v_fma_f32 v103, v103, v100, v101
    v_fma_f32 v104, v104, v100, v101
    v_fma_f32 v105, v105, v100, v101
    v_fma_f32 v106, v106, v100, v101
    v_fma_f32 v107, v107, v100, v101
    v_fma_f32 v108, v108, v100, v101
    v_fma_f32 v109, v109, v100, v101
    v_cvt_pk_bf16_f32 v96, v102, v103
    v_cvt_pk_bf16_f32 v97, v104, v105
    v_cvt_pk_bf16_f32 v98, v106, v107
    v_cvt_pk_bf16_f32 v99, v108, v109
    s_add_u32 s53, s63, 71680
    buffer_store_dwordx4 v[96:99], v61, s[32:35], s53 offen sc1
    s_waitcnt vmcnt(18)
    s_barrier
    s_mov_b32 s60, 4195584
    s_add_u32 m0, s58, 81920
    s_nop 0
    buffer_load_dwordx4 v30, s[32:35], s60 offen offset:0 sc1 lds
    buffer_load_dwordx4 v31, s[32:35], s60 offen offset:1024 sc1 lds
    buffer_load_dwordx4 v32, s[32:35], s60 offen offset:2048 sc1 lds
    buffer_load_dwordx4 v33, s[32:35], s60 offen offset:3072 sc1 lds
    s_mov_b32 s61, 5046272
    s_add_u32 m0, s58, 147456
    s_nop 0
    buffer_load_dwordx4 v34, s[40:43], s61 offen offset:0 lds
    buffer_load_dwordx4 v35, s[40:43], s61 offen offset:1024 lds
    buffer_load_dwordx4 v36, s[40:43], s61 offen offset:2048 lds
    buffer_load_dwordx4 v37, s[40:43], s61 offen offset:3072 lds
    ds_read_b128 v[64:67], v58 offset:6144
    ds_read_b64 v[68:69], v60 offset:2240
    ds_read_b128 v[80:83], v59 offset:7168
    ds_read_b64 v[84:85], v60 offset:2272
    s_waitcnt lgkmcnt(0)
    v_lshlrev_b32 v70, 16, v64
    v_and_b32 v71, 0xffff0000, v64
    v_lshlrev_b32 v72, 16, v65
    v_and_b32 v73, 0xffff0000, v65
    v_lshlrev_b32 v74, 16, v66
    v_and_b32 v75, 0xffff0000, v66
    v_lshlrev_b32 v76, 16, v67
    v_and_b32 v77, 0xffff0000, v67
    v_fma_f32 v70, v70, v68, v69
    v_fma_f32 v71, v71, v68, v69
    v_fma_f32 v72, v72, v68, v69
    v_fma_f32 v73, v73, v68, v69
    v_fma_f32 v74, v74, v68, v69
    v_fma_f32 v75, v75, v68, v69
    v_fma_f32 v76, v76, v68, v69
    v_fma_f32 v77, v77, v68, v69
    v_cvt_pk_bf16_f32 v64, v70, v71
    v_cvt_pk_bf16_f32 v65, v72, v73
    v_cvt_pk_bf16_f32 v66, v74, v75
    v_cvt_pk_bf16_f32 v67, v76, v77
    s_add_u32 s53, s63, 86016
    buffer_store_dwordx4 v[64:67], v61, s[32:35], s53 offen sc1
    v_lshlrev_b32 v86, 16, v80
    v_and_b32 v87, 0xffff0000, v80
    v_lshlrev_b32 v88, 16, v81
    v_and_b32 v89, 0xffff0000, v81
    v_lshlrev_b32 v90, 16, v82
    v_and_b32 v91, 0xffff0000, v82
    v_lshlrev_b32 v92, 16, v83
    v_and_b32 v93, 0xffff0000, v83
    v_fma_f32 v86, v86, v84, v85
    v_fma_f32 v87, v87, v84, v85
    v_fma_f32 v88, v88, v84, v85
    v_fma_f32 v89, v89, v84, v85
    v_fma_f32 v90, v90, v84, v85
    v_fma_f32 v91, v91, v84, v85
    v_fma_f32 v92, v92, v84, v85
    v_fma_f32 v93, v93, v84, v85
    v_cvt_pk_bf16_f32 v80, v86, v87
    v_cvt_pk_bf16_f32 v81, v88, v89
    v_cvt_pk_bf16_f32 v82, v90, v91
    v_cvt_pk_bf16_f32 v83, v92, v93
    s_add_u32 s53, s63, 100352
    buffer_store_dwordx4 v[80:83], v61, s[32:35], s53 offen sc1
    s_waitcnt vmcnt(17)
    s_barrier
    s_mov_b32 s60, 4195712
    s_add_u32 m0, s58, 49152
    s_nop 0
    buffer_load_dwordx4 v30, s[32:35], s60 offen offset:0 sc1 lds
    buffer_load_dwordx4 v31, s[32:35], s60 offen offset:1024 sc1 lds
    buffer_load_dwordx4 v32, s[32:35], s60 offen offset:2048 sc1 lds
    buffer_load_dwordx4 v33, s[32:35], s60 offen offset:3072 sc1 lds
    s_mov_b32 s61, 5505024
    s_add_u32 m0, s58, 98304
    s_nop 0
    buffer_load_dwordx4 v34, s[40:43], s61 offen offset:0 lds
    buffer_load_dwordx4 v35, s[40:43], s61 offen offset:1024 lds
    buffer_load_dwordx4 v36, s[40:43], s61 offen offset:2048 lds
    buffer_load_dwordx4 v37, s[40:43], s61 offen offset:3072 lds
    s_waitcnt vmcnt(14)
    s_barrier
    s_mov_b32 s60, 4195840
    s_add_u32 m0, s58, 65536
    s_nop 0
    buffer_load_dwordx4 v30, s[32:35], s60 offen offset:0 sc1 lds
    buffer_load_dwordx4 v31, s[32:35], s60 offen offset:1024 sc1 lds
    buffer_load_dwordx4 v32, s[32:35], s60 offen offset:2048 sc1 lds
    buffer_load_dwordx4 v33, s[32:35], s60 offen offset:3072 sc1 lds
    s_mov_b32 s61, 5963776
    s_add_u32 m0, s58, 114688
    s_nop 0
    buffer_load_dwordx4 v34, s[40:43], s61 offen offset:0 lds
    buffer_load_dwordx4 v35, s[40:43], s61 offen offset:1024 lds
    buffer_load_dwordx4 v36, s[40:43], s61 offen offset:2048 lds
    buffer_load_dwordx4 v37, s[40:43], s61 offen offset:3072 lds
    s_waitcnt vmcnt(16)
    s_lshl_b32 s50, s27, 8
    s_lshl_b32 s51, s26, 4
    s_add_u32 s50, s50, s51
    s_lshl_b32 s51, s48, 2
    s_add_u32 s50, s50, s51
    s_add_u32 s50, s50, 27279360
    v_mov_b32 v6, s31
    v_mov_b32 v5, 0
    s_mov_b64 s[52:53], exec
    s_mov_b64 exec, 1
    buffer_store_dword v6, v5, s[32:35], s50 offen sc1
    s_mov_b64 exec, s[52:53]
    s_waitcnt vmcnt(13)
    s_barrier
    s_mov_b32 s60, 4195968
    s_add_u32 m0, s58, 81920
    s_nop 0
    buffer_load_dwordx4 v30, s[32:35], s60 offen offset:0 sc1 lds
    buffer_load_dwordx4 v31, s[32:35], s60 offen offset:1024 sc1 lds
    buffer_load_dwordx4 v32, s[32:35], s60 offen offset:2048 sc1 lds
    buffer_load_dwordx4 v33, s[32:35], s60 offen offset:3072 sc1 lds
    s_mov_b32 s61, 6422528
    s_add_u32 m0, s58, 131072
    s_nop 0
    buffer_load_dwordx4 v34, s[40:43], s61 offen offset:0 lds
    buffer_load_dwordx4 v35, s[40:43], s61 offen offset:1024 lds
    buffer_load_dwordx4 v36, s[40:43], s61 offen offset:2048 lds
    buffer_load_dwordx4 v37, s[40:43], s61 offen offset:3072 lds
    s_waitcnt vmcnt(13)
    s_barrier
    s_mov_b32 s60, 4196096
    s_add_u32 m0, s58, 49152
    s_nop 0
    buffer_load_dwordx4 v30, s[32:35], s60 offen offset:0 sc1 lds
    buffer_load_dwordx4 v31, s[32:35], s60 offen offset:1024 sc1 lds
    buffer_load_dwordx4 v32, s[32:35], s60 offen offset:2048 sc1 lds
    buffer_load_dwordx4 v33, s[32:35], s60 offen offset:3072 sc1 lds
    s_mov_b32 s61, 6881280
    s_add_u32 m0, s58, 147456
    s_nop 0
    buffer_load_dwordx4 v34, s[40:43], s61 offen offset:0 lds
    buffer_load_dwordx4 v35, s[40:43], s61 offen offset:1024 lds
    buffer_load_dwordx4 v36, s[40:43], s61 offen offset:2048 lds
    buffer_load_dwordx4 v37, s[40:43], s61 offen offset:3072 lds
    s_cmp_lg_u32 s48, 0
    s_cbranch_scc1 mega_kernel_skip38
    s_lshl_b32 s50, s27, 8
    s_add_u32 s50, s50, 27279360
    v_lshlrev_b32 v8, 2, v1
    v_add_u32 v8, s50, v8
    buffer_load_dword v9, v8, s[32:35], 0 offen sc1
mega_kernel_skip38:
    s_waitcnt vmcnt(12)
    s_barrier
    s_mov_b32 s60, 4196224
    s_add_u32 m0, s58, 65536
    s_nop 0
    buffer_load_dwordx4 v30, s[32:35], s60 offen offset:0 sc1 lds
    buffer_load_dwordx4 v31, s[32:35], s60 offen offset:1024 sc1 lds
    buffer_load_dwordx4 v32, s[32:35], s60 offen offset:2048 sc1 lds
    buffer_load_dwordx4 v33, s[32:35], s60 offen offset:3072 sc1 lds
    s_waitcnt vmcnt(8)
    s_cmp_lg_u32 s48, 0
    s_cbranch_scc1 mega_kernel_skip39
    s_waitcnt vmcnt(4)
    v_cmp_eq_u32 vcc, s31, v9
    s_nop 3
    s_and_b32 s50, vcc_lo, 0xffffffff
    s_xor_b32 s50, s50, 0xffffffff
    s_and_b32 s51, vcc_hi, 0xffffffff
    s_xor_b32 s51, s51, 0xffffffff
    s_or_b32 s50, s50, s51
    s_cmp_eq_u32 s50, 0
    s_cbranch_scc1 mega_kernel_ok40
    s_mov_b32 s54, 0
mega_kernel_spin41:
    buffer_load_dword v9, v8, s[32:35], 0 offen sc1
    s_waitcnt vmcnt(0)
    v_cmp_eq_u32 vcc, s31, v9
    s_nop 3
    s_and_b32 s50, vcc_lo, 0xffffffff
    s_xor_b32 s50, s50, 0xffffffff
    s_and_b32 s51, vcc_hi, 0xffffffff
    s_xor_b32 s51, s51, 0xffffffff
    s_or_b32 s50, s50, s51
    s_cmp_eq_u32 s50, 0
    s_cbranch_scc1 mega_kernel_ok40
    s_sleep 1
    s_add_u32 s54, s54, 1
    s_cmp_lt_u32 s54, 30000
    s_cbranch_scc1 mega_kernel_spin41
mega_kernel_ok40:
mega_kernel_skip39:
    s_barrier
    s_mov_b32 s36, s14
    s_and_b32 s37, s15, 0xffff
    s_mov_b32 s38, 8388608
    s_mov_b32 s39, 0x20000
    s_mov_b32 s60, 0
    s_add_u32 m0, s58, 81920
    s_nop 0
    buffer_load_dwordx4 v38, s[36:39], s60 offen offset:0 lds
    buffer_load_dwordx4 v39, s[36:39], s60 offen offset:1024 lds
    buffer_load_dwordx4 v40, s[36:39], s60 offen offset:2048 lds
    buffer_load_dwordx4 v41, s[36:39], s60 offen offset:3072 lds
    s_mov_b32 s61, 8388608
    s_add_u32 m0, s58, 98304
    s_nop 0
    buffer_load_dwordx4 v42, s[32:35], s61 offen offset:0 sc1 lds
    buffer_load_dwordx4 v43, s[32:35], s61 offen offset:1024 sc1 lds
    buffer_load_dwordx4 v44, s[32:35], s61 offen offset:2048 sc1 lds
    buffer_load_dwordx4 v45, s[32:35], s61 offen offset:3072 sc1 lds
    s_mov_b32 s61, 8617984
    s_add_u32 m0, s58, 114688
    s_nop 0
    buffer_load_dwordx4 v42, s[32:35], s61 offen offset:0 sc1 lds
    buffer_load_dwordx4 v43, s[32:35], s61 offen offset:1024 sc1 lds
    buffer_load_dwordx4 v44, s[32:35], s61 offen offset:2048 sc1 lds
    buffer_load_dwordx4 v45, s[32:35], s61 offen offset:3072 sc1 lds
    s_waitcnt vmcnt(12)
    s_barrier
    s_mov_b32 s60, 128
    s_add_u32 m0, s58, 49152
    s_nop 0
    buffer_load_dwordx4 v38, s[36:39], s60 offen offset:0 lds
    buffer_load_dwordx4 v39, s[36:39], s60 offen offset:1024 lds
    buffer_load_dwordx4 v40, s[36:39], s60 offen offset:2048 lds
    buffer_load_dwordx4 v41, s[36:39], s60 offen offset:3072 lds
    s_mov_b32 s61, 8847360
    s_add_u32 m0, s58, 131072
    s_nop 0
    buffer_load_dwordx4 v42, s[32:35], s61 offen offset:0 sc1 lds
    buffer_load_dwordx4 v43, s[32:35], s61 offen offset:1024 sc1 lds
    buffer_load_dwordx4 v44, s[32:35], s61 offen offset:2048 sc1 lds
    buffer_load_dwordx4 v45, s[32:35], s61 offen offset:3072 sc1 lds
    s_waitcnt vmcnt(16)
    s_waitcnt vmcnt(12)
    s_barrier
    s_mov_b32 s60, 256
    s_add_u32 m0, s58, 65536
    s_nop 0
    buffer_load_dwordx4 v38, s[36:39], s60 offen offset:0 lds
    buffer_load_dwordx4 v39, s[36:39], s60 offen offset:1024 lds
    buffer_load_dwordx4 v40, s[36:39], s60 offen offset:2048 lds
    buffer_load_dwordx4 v41, s[36:39], s60 offen offset:3072 lds
    s_mov_b32 s61, 9076736
    s_add_u32 m0, s58, 147456
    s_nop 0
    buffer_load_dwordx4 v42, s[32:35], s61 offen offset:0 sc1 lds
    buffer_load_dwordx4 v43, s[32:35], s61 offen offset:1024 sc1 lds
    buffer_load_dwordx4 v44, s[32:35], s61 offen offset:2048 sc1 lds
    buffer_load_dwordx4 v45, s[32:35], s61 offen offset:3072 sc1 lds
    s_waitcnt vmcnt(12)
    s_barrier
    s_mov_b32 s60, 384
    s_add_u32 m0, s58, 81920
    s_nop 0
    buffer_load_dwordx4 v38, s[36:39], s60 offen offset:0 lds
    buffer_load_dwordx4 v39, s[36:39], s60 offen offset:1024 lds
    buffer_load_dwordx4 v40, s[36:39], s60 offen offset:2048 lds
    buffer_load_dwordx4 v41, s[36:39], s60 offen offset:3072 lds
    s_mov_b32 s61, 9306112
    s_add_u32 m0, s58, 98304
    s_nop 0
    buffer_load_dwordx4 v42, s[32:35], s61 offen offset:0 sc1 lds
    buffer_load_dwordx4 v43, s[32:35], s61 offen offset:1024 sc1 lds
    buffer_load_dwordx4 v44, s[32:35], s61 offen offset:2048 sc1 lds
    buffer_load_dwordx4 v45, s[32:35], s61 offen offset:3072 sc1 lds
    s_waitcnt vmcnt(12)
    s_barrier
    s_mov_b32 s60, 512
    s_add_u32 m0, s58, 49152
    s_nop 0
    buffer_load_dwordx4 v38, s[36:39], s60 offen offset:0 lds
    buffer_load_dwordx4 v39, s[36:39], s60 offen offset:1024 lds
    buffer_load_dwordx4 v40, s[36:39], s60 offen offset:2048 lds
    buffer_load_dwordx4 v41, s[36:39], s60 offen offset:3072 lds
    s_mov_b32 s61, 9535488
    s_add_u32 m0, s58, 114688
    s_nop 0
    buffer_load_dwordx4 v42, s[32:35], s61 offen offset:0 sc1 lds
    buffer_load_dwordx4 v43, s[32:35], s61 offen offset:1024 sc1 lds
    buffer_load_dwordx4 v44, s[32:35], s61 offen offset:2048 sc1 lds
    buffer_load_dwordx4 v45, s[32:35], s61 offen offset:3072 sc1 lds
    s_waitcnt vmcnt(12)
    s_barrier
    s_mov_b32 s60, 640
    s_add_u32 m0, s58, 65536
    s_nop 0
    buffer_load_dwordx4 v38, s[36:39], s60 offen offset:0 lds
    buffer_load_dwordx4 v39, s[36:39], s60 offen offset:1024 lds
    buffer_load_dwordx4 v40, s[36:39], s60 offen offset:2048 lds
    buffer_load_dwordx4 v41, s[36:39], s60 offen offset:3072 lds
    s_mov_b32 s61, 9764864
    s_add_u32 m0, s58, 131072
    s_nop 0
    buffer_load_dwordx4 v42, s[32:35], s61 offen offset:0 sc1 lds
    buffer_load_dwordx4 v43, s[32:35], s61 offen offset:1024 sc1 lds
    buffer_load_dwordx4 v44, s[32:35], s61 offen offset:2048 sc1 lds
    buffer_load_dwordx4 v45, s[32:35], s61 offen offset:3072 sc1 lds
    s_lshl_b32 s52, s48, 13
    s_add_u32 s52, s52, 16384
    v_lshlrev_b32 v60, 3, v1
    v_add_u32 v60, s52, v60
    ds_read_b64 v[64:65], v60 offset:0
    s_waitcnt lgkmcnt(0)
    ds_read_b64 v[66:67], v60 offset:512
    v_lshlrev_b32 v96, 16, v64
    v_and_b32 v97, 0xffff0000, v64
    v_lshlrev_b32 v98, 16, v65
    v_and_b32 v99, 0xffff0000, v65
    v_mul_f32 v12, v96, v96
    v_mul_f32 v13, v97, v97
    v_mul_f32 v14, v98, v98
    v_mul_f32 v15, v99, v99
    v_fma_f32 v12, v12, v48, v46
    v_fma_f32 v13, v13, v48, v46
    v_fma_f32 v14, v14, v48, v46
    v_fma_f32 v15, v15, v48, v46
    v_mul_f32 v12, v12, v96
    v_mul_f32 v13, v13, v97
    v_mul_f32 v14, v14, v98
    v_mul_f32 v15, v15, v99
    v_exp_f32 v12, v12
    v_exp_f32 v13, v13
    v_exp_f32 v14, v14
    v_exp_f32 v15, v15
    v_add_f32 v12, 1.0, v12
    v_add_f32 v13, 1.0, v13
    v_add_f32 v14, 1.0, v14
    v_add_f32 v15, 1.0, v15
    v_rcp_f32 v12, v12
    v_rcp_f32 v13, v13
    v_rcp_f32 v14, v14
    v_rcp_f32 v15, v15
    v_mul_f32 v96, v96, v12
    v_mul_f32 v97, v97, v13
    v_mul_f32 v98, v98, v14
    v_mul_f32 v99, v99, v15
    v_cvt_pk_bf16_f32 v68, v96, v97
    v_cvt_pk_bf16_f32 v69, v98, v99
    ds_write_b64 v60, v[68:69] offset:0
    s_waitcnt vmcnt(12)
    s_barrier
    s_mov_b32 s60, 768
    s_add_u32 m0, s58, 81920
    s_nop 0
    buffer_load_dwordx4 v38, s[36:39], s60 offen offset:0 lds
    buffer_load_dwordx4 v39, s[36:39], s60 offen offset:1024 lds
    buffer_load_dwordx4 v40, s[36:39], s60 offen offset:2048 lds
    buffer_load_dwordx4 v41, s[36:39], s60 offen offset:3072 lds
    s_mov_b32 s61, 9994240
    s_add_u32 m0, s58, 147456
    s_nop 0
    buffer_load_dwordx4 v42, s[32:35], s61 offen offset:0 sc1 lds
    buffer_load_dwordx4 v43, s[32:35], s61 offen offset:1024 sc1 lds
    buffer_load_dwordx4 v44, s[32:35], s61 offen offset:2048 sc1 lds
    buffer_load_dwordx4 v45, s[32:35], s61 offen offset:3072 sc1 lds
    s_waitcnt lgkmcnt(0)
    ds_read_b64 v[64:65], v60 offset:1024
    v_lshlrev_b32 v96, 16, v66
    v_and_b32 v97, 0xffff0000, v66
    v_lshlrev_b32 v98, 16, v67
    v_and_b32 v99, 0xffff0000, v67
    v_mul_f32 v12, v96, v96
    v_mul_f32 v13, v97, v97
    v_mul_f32 v14, v98, v98
    v_mul_f32 v15, v99, v99
    v_fma_f32 v12, v12, v48, v46
    v_fma_f32 v13, v13, v48, v46
    v_fma_f32 v14, v14, v48, v46
    v_fma_f32 v15, v15, v48, v46
    v_mul_f32 v12, v12, v96
    v_mul_f32 v13, v13, v97
    v_mul_f32 v14, v14, v98
    v_mul_f32 v15, v15, v99
    v_exp_f32 v12, v12
    v_exp_f32 v13, v13
    v_exp_f32 v14, v14
    v_exp_f32 v15, v15
    v_add_f32 v12, 1.0, v12
    v_add_f32 v13, 1.0, v13
    v_add_f32 v14, 1.0, v14
    v_add_f32 v15, 1.0, v15
    v_rcp_f32 v12, v12
    v_rcp_f32 v13, v13
    v_rcp_f32 v14, v14
    v_rcp_f32 v15, v15
    v_mul_f32 v96, v96, v12
    v_mul_f32 v97, v97, v13
    v_mul_f32 v98, v98, v14
    v_mul_f32 v99, v99, v15
    v_cvt_pk_bf16_f32 v68, v96, v97
    v_cvt_pk_bf16_f32 v69, v98, v99
    ds_write_b64 v60, v[68:69] offset:512
    s_waitcnt vmcnt(12)
    s_barrier
    s_mov_b32 s60, 896
    s_add_u32 m0, s58, 49152
    s_nop 0
    buffer_load_dwordx4 v38, s[36:39], s60 offen offset:0 lds
    buffer_load_dwordx4 v39, s[36:39], s60 offen offset:1024 lds
    buffer_load_dwordx4 v40, s[36:39], s60 offen offset:2048 lds
    buffer_load_dwordx4 v41, s[36:39], s60 offen offset:3072 lds
    s_mov_b32 s61, 10223616
    s_add_u32 m0, s58, 98304
    s_nop 0
    buffer_load_dwordx4 v42, s[32:35], s61 offen offset:0 sc1 lds
    buffer_load_dwordx4 v43, s[32:35], s61 offen offset:1024 sc1 lds
    buffer_load_dwordx4 v44, s[32:35], s61 offen offset:2048 sc1 lds
    buffer_load_dwordx4 v45, s[32:35], s61 offen offset:3072 sc1 lds
    s_waitcnt lgkmcnt(0)
    ds_read_b64 v[66:67], v60 offset:1536
    v_lshlrev_b32 v96, 16, v64
    v_and_b32 v97, 0xffff0000, v64
    v_lshlrev_b32 v98, 16, v65
    v_and_b32 v99, 0xffff0000, v65
    v_mul_f32 v12, v96, v96
    v_mul_f32 v13, v97, v97
    v_mul_f32 v14, v98, v98
    v_mul_f32 v15, v99, v99
    v_fma_f32 v12, v12, v48, v46
    v_fma_f32 v13, v13, v48, v46
    v_fma_f32 v14, v14, v48, v46
    v_fma_f32 v15, v15, v48, v46
    v_mul_f32 v12, v12, v96
    v_mul_f32 v13, v13, v97
    v_mul_f32 v14, v14, v98
    v_mul_f32 v15, v15, v99
    v_exp_f32 v12, v12
    v_exp_f32 v13, v13
    v_exp_f32 v14, v14
    v_exp_f32 v15, v15
    v_add_f32 v12, 1.0, v12
    v_add_f32 v13, 1.0, v13
    v_add_f32 v14, 1.0, v14
    v_add_f32 v15, 1.0, v15
    v_rcp_f32 v12, v12
    v_rcp_f32 v13, v13
    v_rcp_f32 v14, v14
    v_rcp_f32 v15, v15
    v_mul_f32 v96, v96, v12
    v_mul_f32 v97, v97, v13
    v_mul_f32 v98, v98, v14
    v_mul_f32 v99, v99, v15
    v_cvt_pk_bf16_f32 v68, v96, v97
    v_cvt_pk_bf16_f32 v69, v98, v99
    ds_write_b64 v60, v[68:69] offset:1024
    s_waitcnt vmcnt(12)
    s_barrier
    s_mov_b32 s60, 1024
    s_add_u32 m0, s58, 65536
    s_nop 0
    buffer_load_dwordx4 v38, s[36:39], s60 offen offset:0 lds
    buffer_load_dwordx4 v39, s[36:39], s60 offen offset:1024 lds
    buffer_load_dwordx4 v40, s[36:39], s60 offen offset:2048 lds
    buffer_load_dwordx4 v41, s[36:39], s60 offen offset:3072 lds
    s_mov_b32 s61, 10452992
    s_add_u32 m0, s58, 114688
    s_nop 0
    buffer_load_dwordx4 v42, s[32:35], s61 offen offset:0 sc1 lds
    buffer_load_dwordx4 v43, s[32:35], s61 offen offset:1024 sc1 lds
    buffer_load_dwordx4 v44, s[32:35], s61 offen offset:2048 sc1 lds
    buffer_load_dwordx4 v45, s[32:35], s61 offen offset:3072 sc1 lds
    s_waitcnt lgkmcnt(0)
    ds_read_b64 v[64:65], v60 offset:2048
    v_lshlrev_b32 v96, 16, v66
    v_and_b32 v97, 0xffff0000, v66
    v_lshlrev_b32 v98, 16, v67
    v_and_b32 v99, 0xffff0000, v67
    v_mul_f32 v12, v96, v96
    v_mul_f32 v13, v97, v97
    v_mul_f32 v14, v98, v98
    v_mul_f32 v15, v99, v99
    v_fma_f32 v12, v12, v48, v46
    v_fma_f32 v13, v13, v48, v46
    v_fma_f32 v14, v14, v48, v46
    v_fma_f32 v15, v15, v48, v46
    v_mul_f32 v12, v12, v96
    v_mul_f32 v13, v13, v97
    v_mul_f32 v14, v14, v98
    v_mul_f32 v15, v15, v99
    v_exp_f32 v12, v12
    v_exp_f32 v13, v13
    v_exp_f32 v14, v14
    v_exp_f32 v15, v15
    v_add_f32 v12, 1.0, v12
    v_add_f32 v13, 1.0, v13
    v_add_f32 v14, 1.0, v14
    v_add_f32 v15, 1.0, v15
    v_rcp_f32 v12, v12
    v_rcp_f32 v13, v13
    v_rcp_f32 v14, v14
    v_rcp_f32 v15, v15
    v_mul_f32 v96, v96, v12
    v_mul_f32 v97, v97, v13
    v_mul_f32 v98, v98, v14
    v_mul_f32 v99, v99, v15
    v_cvt_pk_bf16_f32 v68, v96, v97
    v_cvt_pk_bf16_f32 v69, v98, v99
    ds_write_b64 v60, v[68:69] offset:1536
    s_waitcnt vmcnt(12)
    s_barrier
    s_mov_b32 s60, 1152
    s_add_u32 m0, s58, 81920
    s_nop 0
    buffer_load_dwordx4 v38, s[36:39], s60 offen offset:0 lds
    buffer_load_dwordx4 v39, s[36:39], s60 offen offset:1024 lds
    buffer_load_dwordx4 v40, s[36:39], s60 offen offset:2048 lds
    buffer_load_dwordx4 v41, s[36:39], s60 offen offset:3072 lds
    s_mov_b32 s61, 10682368
    s_add_u32 m0, s58, 131072
    s_nop 0
    buffer_load_dwordx4 v42, s[32:35], s61 offen offset:0 sc1 lds
    buffer_load_dwordx4 v43, s[32:35], s61 offen offset:1024 sc1 lds
    buffer_load_dwordx4 v44, s[32:35], s61 offen offset:2048 sc1 lds
    buffer_load_dwordx4 v45, s[32:35], s61 offen offset:3072 sc1 lds
    s_waitcnt lgkmcnt(0)
    ds_read_b64 v[66:67], v60 offset:2560
    v_lshlrev_b32 v96, 16, v64
    v_and_b32 v97, 0xffff0000, v64
    v_lshlrev_b32 v98, 16, v65
    v_and_b32 v99, 0xffff0000, v65
    v_mul_f32 v12, v96, v96
    v_mul_f32 v13, v97, v97
    v_mul_f32 v14, v98, v98
    v_mul_f32 v15, v99, v99
    v_fma_f32 v12, v12, v48, v46
    v_fma_f32 v13, v13, v48, v46
    v_fma_f32 v14, v14, v48, v46
    v_fma_f32 v15, v15, v48, v46
    v_mul_f32 v12, v12, v96
    v_mul_f32 v13, v13, v97
    v_mul_f32 v14, v14, v98
    v_mul_f32 v15, v15, v99
    v_exp_f32 v12, v12
    v_exp_f32 v13, v13
    v_exp_f32 v14, v14
    v_exp_f32 v15, v15
    v_add_f32 v12, 1.0, v12
    v_add_f32 v13, 1.0, v13
    v_add_f32 v14, 1.0, v14
    v_add_f32 v15, 1.0, v15
    v_rcp_f32 v12, v12
    v_rcp_f32 v13, v13
    v_rcp_f32 v14, v14
    v_rcp_f32 v15, v15
    v_mul_f32 v96, v96, v12
    v_mul_f32 v97, v97, v13
    v_mul_f32 v98, v98, v14
    v_mul_f32 v99, v99, v15
    v_cvt_pk_bf16_f32 v68, v96, v97
    v_cvt_pk_bf16_f32 v69, v98, v99
    ds_write_b64 v60, v[68:69] offset:2048
    s_waitcnt vmcnt(12)
    s_barrier
    s_mov_b32 s60, 1280
    s_add_u32 m0, s58, 49152
    s_nop 0
    buffer_load_dwordx4 v38, s[36:39], s60 offen offset:0 lds
    buffer_load_dwordx4 v39, s[36:39], s60 offen offset:1024 lds
    buffer_load_dwordx4 v40, s[36:39], s60 offen offset:2048 lds
    buffer_load_dwordx4 v41, s[36:39], s60 offen offset:3072 lds
    s_mov_b32 s61, 10911744
    s_add_u32 m0, s58, 147456
    s_nop 0
    buffer_load_dwordx4 v42, s[32:35], s61 offen offset:0 sc1 lds
    buffer_load_dwordx4 v43, s[32:35], s61 offen offset:1024 sc1 lds
    buffer_load_dwordx4 v44, s[32:35], s61 offen offset:2048 sc1 lds
    buffer_load_dwordx4 v45, s[32:35], s61 offen offset:3072 sc1 lds
    s_waitcnt lgkmcnt(0)
    ds_read_b64 v[64:65], v60 offset:3072
    v_lshlrev_b32 v96, 16, v66
    v_and_b32 v97, 0xffff0000, v66
    v_lshlrev_b32 v98, 16, v67
    v_and_b32 v99, 0xffff0000, v67
    v_mul_f32 v12, v96, v96
    v_mul_f32 v13, v97, v97
    v_mul_f32 v14, v98, v98
    v_mul_f32 v15, v99, v99
    v_fma_f32 v12, v12, v48, v46
    v_fma_f32 v13, v13, v48, v46
    v_fma_f32 v14, v14, v48, v46
    v_fma_f32 v15, v15, v48, v46
    v_mul_f32 v12, v12, v96
    v_mul_f32 v13, v13, v97
    v_mul_f32 v14, v14, v98
    v_mul_f32 v15, v15, v99
    v_exp_f32 v12, v12
    v_exp_f32 v13, v13
    v_exp_f32 v14, v14
    v_exp_f32 v15, v15
    v_add_f32 v12, 1.0, v12
    v_add_f32 v13, 1.0, v13
    v_add_f32 v14, 1.0, v14
    v_add_f32 v15, 1.0, v15
    v_rcp_f32 v12, v12
    v_rcp_f32 v13, v13
    v_rcp_f32 v14, v14
    v_rcp_f32 v15, v15
    v_mul_f32 v96, v96, v12
    v_mul_f32 v97, v97, v13
    v_mul_f32 v98, v98, v14
    v_mul_f32 v99, v99, v15
    v_cvt_pk_bf16_f32 v68, v96, v97
    v_cvt_pk_bf16_f32 v69, v98, v99
    ds_write_b64 v60, v[68:69] offset:2560
    s_waitcnt vmcnt(12)
    s_barrier
    s_mov_b32 s60, 1408
    s_add_u32 m0, s58, 65536
    s_nop 0
    buffer_load_dwordx4 v38, s[36:39], s60 offen offset:0 lds
    buffer_load_dwordx4 v39, s[36:39], s60 offen offset:1024 lds
    buffer_load_dwordx4 v40, s[36:39], s60 offen offset:2048 lds
    buffer_load_dwordx4 v41, s[36:39], s60 offen offset:3072 lds
    s_mov_b32 s61, 11141120
    s_add_u32 m0, s58, 98304
    s_nop 0
    buffer_load_dwordx4 v42, s[32:35], s61 offen offset:0 sc1 lds
    buffer_load_dwordx4 v43, s[32:35], s61 offen offset:1024 sc1 lds
    buffer_load_dwordx4 v44, s[32:35], s61 offen offset:2048 sc1 lds
    buffer_load_dwordx4 v45, s[32:35], s61 offen offset:3072 sc1 lds
    s_waitcnt lgkmcnt(0)
    ds_read_b64 v[66:67], v60 offset:3584
    v_lshlrev_b32 v96, 16, v64
    v_and_b32 v97, 0xffff0000, v64
    v_lshlrev_b32 v98, 16, v65
    v_and_b32 v99, 0xffff0000, v65
    v_mul_f32 v12, v96, v96
    v_mul_f32 v13, v97, v97
    v_mul_f32 v14, v98, v98
    v_mul_f32 v15, v99, v99
    v_fma_f32 v12, v12, v48, v46
    v_fma_f32 v13, v13, v48, v46
    v_fma_f32 v14, v14, v48, v46
    v_fma_f32 v15, v15, v48, v46
    v_mul_f32 v12, v12, v96
    v_mul_f32 v13, v13, v97
    v_mul_f32 v14, v14, v98
    v_mul_f32 v15, v15, v99
    v_exp_f32 v12, v12
    v_exp_f32 v13, v13
    v_exp_f32 v14, v14
    v_exp_f32 v15, v15
    v_add_f32 v12, 1.0, v12
    v_add_f32 v13, 1.0, v13
    v_add_f32 v14, 1.0, v14
    v_add_f32 v15, 1.0, v15
    v_rcp_f32 v12, v12
    v_rcp_f32 v13, v13
    v_rcp_f32 v14, v14
    v_rcp_f32 v15, v15
    v_mul_f32 v96, v96, v12
    v_mul_f32 v97, v97, v13
    v_mul_f32 v98, v98, v14
    v_mul_f32 v99, v99, v15
    v_cvt_pk_bf16_f32 v68, v96, v97
    v_cvt_pk_bf16_f32 v69, v98, v99
    ds_write_b64 v60, v[68:69] offset:3072
    s_waitcnt vmcnt(12)
    s_barrier
    s_mov_b32 s60, 1536
    s_add_u32 m0, s58, 81920
    s_nop 0
    buffer_load_dwordx4 v38, s[36:39], s60 offen offset:0 lds
    buffer_load_dwordx4 v39, s[36:39], s60 offen offset:1024 lds
    buffer_load_dwordx4 v40, s[36:39], s60 offen offset:2048 lds
    buffer_load_dwordx4 v41, s[36:39], s60 offen offset:3072 lds
    s_mov_b32 s61, 11370496
    s_add_u32 m0, s58, 114688
    s_nop 0
    buffer_load_dwordx4 v42, s[32:35], s61 offen offset:0 sc1 lds
    buffer_load_dwordx4 v43, s[32:35], s61 offen offset:1024 sc1 lds
    buffer_load_dwordx4 v44, s[32:35], s61 offen offset:2048 sc1 lds
    buffer_load_dwordx4 v45, s[32:35], s61 offen offset:3072 sc1 lds
    s_waitcnt lgkmcnt(0)
    ds_read_b64 v[64:65], v60 offset:4096
    v_lshlrev_b32 v96, 16, v66
    v_and_b32 v97, 0xffff0000, v66
    v_lshlrev_b32 v98, 16, v67
    v_and_b32 v99, 0xffff0000, v67
    v_mul_f32 v12, v96, v96
    v_mul_f32 v13, v97, v97
    v_mul_f32 v14, v98, v98
    v_mul_f32 v15, v99, v99
    v_fma_f32 v12, v12, v48, v46
    v_fma_f32 v13, v13, v48, v46
    v_fma_f32 v14, v14, v48, v46
    v_fma_f32 v15, v15, v48, v46
    v_mul_f32 v12, v12, v96
    v_mul_f32 v13, v13, v97
    v_mul_f32 v14, v14, v98
    v_mul_f32 v15, v15, v99
    v_exp_f32 v12, v12
    v_exp_f32 v13, v13
    v_exp_f32 v14, v14
    v_exp_f32 v15, v15
    v_add_f32 v12, 1.0, v12
    v_add_f32 v13, 1.0, v13
    v_add_f32 v14, 1.0, v14
    v_add_f32 v15, 1.0, v15
    v_rcp_f32 v12, v12
    v_rcp_f32 v13, v13
    v_rcp_f32 v14, v14
    v_rcp_f32 v15, v15
    v_mul_f32 v96, v96, v12
    v_mul_f32 v97, v97, v13
    v_mul_f32 v98, v98, v14
    v_mul_f32 v99, v99, v15
    v_cvt_pk_bf16_f32 v68, v96, v97
    v_cvt_pk_bf16_f32 v69, v98, v99
    ds_write_b64 v60, v[68:69] offset:3584
    s_waitcnt vmcnt(12)
    s_barrier
    s_mov_b32 s60, 1664
    s_add_u32 m0, s58, 49152
    s_nop 0
    buffer_load_dwordx4 v38, s[36:39], s60 offen offset:0 lds
    buffer_load_dwordx4 v39, s[36:39], s60 offen offset:1024 lds
    buffer_load_dwordx4 v40, s[36:39], s60 offen offset:2048 lds
    buffer_load_dwordx4 v41, s[36:39], s60 offen offset:3072 lds
    s_mov_b32 s61, 11599872
    s_add_u32 m0, s58, 131072
    s_nop 0
    buffer_load_dwordx4 v42, s[32:35], s61 offen offset:0 sc1 lds
    buffer_load_dwordx4 v43, s[32:35], s61 offen offset:1024 sc1 lds
    buffer_load_dwordx4 v44, s[32:35], s61 offen offset:2048 sc1 lds
    buffer_load_dwordx4 v45, s[32:35], s61 offen offset:3072 sc1 lds
    s_waitcnt lgkmcnt(0)
    ds_read_b64 v[66:67], v60 offset:4608
    v_lshlrev_b32 v96, 16, v64
    v_and_b32 v97, 0xffff0000, v64
    v_lshlrev_b32 v98, 16, v65
    v_and_b32 v99, 0xffff0000, v65
    v_mul_f32 v12, v96, v96
    v_mul_f32 v13, v97, v97
    v_mul_f32 v14, v98, v98
    v_mul_f32 v15, v99, v99
    v_fma_f32 v12, v12, v48, v46
    v_fma_f32 v13, v13, v48, v46
    v_fma_f32 v14, v14, v48, v46
    v_fma_f32 v15, v15, v48, v46
    v_mul_f32 v12, v12, v96
    v_mul_f32 v13, v13, v97
    v_mul_f32 v14, v14, v98
    v_mul_f32 v15, v15, v99
    v_exp_f32 v12, v12
    v_exp_f32 v13, v13
    v_exp_f32 v14, v14
    v_exp_f32 v15, v15
    v_add_f32 v12, 1.0, v12
    v_add_f32 v13, 1.0, v13
    v_add_f32 v14, 1.0, v14
    v_add_f32 v15, 1.0, v15
    v_rcp_f32 v12, v12
    v_rcp_f32 v13, v13
    v_rcp_f32 v14, v14
    v_rcp_f32 v15, v15
    v_mul_f32 v96, v96, v12
    v_mul_f32 v97, v97, v13
    v_mul_f32 v98, v98, v14
    v_mul_f32 v99, v99, v15
    v_cvt_pk_bf16_f32 v68, v96, v97
    v_cvt_pk_bf16_f32 v69, v98, v99
    ds_write_b64 v60, v[68:69] offset:4096
    s_waitcnt vmcnt(12)
    s_barrier
    s_mov_b32 s60, 1792
    s_add_u32 m0, s58, 65536
    s_nop 0
    buffer_load_dwordx4 v38, s[36:39], s60 offen offset:0 lds
    buffer_load_dwordx4 v39, s[36:39], s60 offen offset:1024 lds
    buffer_load_dwordx4 v40, s[36:39], s60 offen offset:2048 lds
    buffer_load_dwordx4 v41, s[36:39], s60 offen offset:3072 lds
    s_mov_b32 s61, 11829248
    s_add_u32 m0, s58, 147456
    s_nop 0
    buffer_load_dwordx4 v42, s[32:35], s61 offen offset:0 sc1 lds
    buffer_load_dwordx4 v43, s[32:35], s61 offen offset:1024 sc1 lds
    buffer_load_dwordx4 v44, s[32:35], s61 offen offset:2048 sc1 lds
    buffer_load_dwordx4 v45, s[32:35], s61 offen offset:3072 sc1 lds
    s_waitcnt lgkmcnt(0)
    ds_read_b64 v[64:65], v60 offset:5120
    v_lshlrev_b32 v96, 16, v66
    v_and_b32 v97, 0xffff0000, v66
    v_lshlrev_b32 v98, 16, v67
    v_and_b32 v99, 0xffff0000, v67
    v_mul_f32 v12, v96, v96
    v_mul_f32 v13, v97, v97
    v_mul_f32 v14, v98, v98
    v_mul_f32 v15, v99, v99
    v_fma_f32 v12, v12, v48, v46
    v_fma_f32 v13, v13, v48, v46
    v_fma_f32 v14, v14, v48, v46
    v_fma_f32 v15, v15, v48, v46
    v_mul_f32 v12, v12, v96
    v_mul_f32 v13, v13, v97
    v_mul_f32 v14, v14, v98
    v_mul_f32 v15, v15, v99
    v_exp_f32 v12, v12
    v_exp_f32 v13, v13
    v_exp_f32 v14, v14
    v_exp_f32 v15, v15
    v_add_f32 v12, 1.0, v12
    v_add_f32 v13, 1.0, v13
    v_add_f32 v14, 1.0, v14
    v_add_f32 v15, 1.0, v15
    v_rcp_f32 v12, v12
    v_rcp_f32 v13, v13
    v_rcp_f32 v14, v14
    v_rcp_f32 v15, v15
    v_mul_f32 v96, v96, v12
    v_mul_f32 v97, v97, v13
    v_mul_f32 v98, v98, v14
    v_mul_f32 v99, v99, v15
    v_cvt_pk_bf16_f32 v68, v96, v97
    v_cvt_pk_bf16_f32 v69, v98, v99
    ds_write_b64 v60, v[68:69] offset:4608
    s_waitcnt vmcnt(12)
    s_barrier
    s_mov_b32 s60, 1920
    s_add_u32 m0, s58, 81920
    s_nop 0
    buffer_load_dwordx4 v38, s[36:39], s60 offen offset:0 lds
    buffer_load_dwordx4 v39, s[36:39], s60 offen offset:1024 lds
    buffer_load_dwordx4 v40, s[36:39], s60 offen offset:2048 lds
    buffer_load_dwordx4 v41, s[36:39], s60 offen offset:3072 lds
    s_mov_b32 s61, 12058624
    s_add_u32 m0, s58, 98304
    s_nop 0
    buffer_load_dwordx4 v42, s[32:35], s61 offen offset:0 sc1 lds
    buffer_load_dwordx4 v43, s[32:35], s61 offen offset:1024 sc1 lds
    buffer_load_dwordx4 v44, s[32:35], s61 offen offset:2048 sc1 lds
    buffer_load_dwordx4 v45, s[32:35], s61 offen offset:3072 sc1 lds
    s_waitcnt lgkmcnt(0)
    ds_read_b64 v[66:67], v60 offset:5632
    v_lshlrev_b32 v96, 16, v64
    v_and_b32 v97, 0xffff0000, v64
    v_lshlrev_b32 v98, 16, v65
    v_and_b32 v99, 0xffff0000, v65
    v_mul_f32 v12, v96, v96
    v_mul_f32 v13, v97, v97
    v_mul_f32 v14, v98, v98
    v_mul_f32 v15, v99, v99
    v_fma_f32 v12, v12, v48, v46
    v_fma_f32 v13, v13, v48, v46
    v_fma_f32 v14, v14, v48, v46
    v_fma_f32 v15, v15, v48, v46
    v_mul_f32 v12, v12, v96
    v_mul_f32 v13, v13, v97
    v_mul_f32 v14, v14, v98
    v_mul_f32 v15, v15, v99
    v_exp_f32 v12, v12
    v_exp_f32 v13, v13
    v_exp_f32 v14, v14
    v_exp_f32 v15, v15
    v_add_f32 v12, 1.0, v12
    v_add_f32 v13, 1.0, v13
    v_add_f32 v14, 1.0, v14
    v_add_f32 v15, 1.0, v15
    v_rcp_f32 v12, v12
    v_rcp_f32 v13, v13
    v_rcp_f32 v14, v14
    v_rcp_f32 v15, v15
    v_mul_f32 v96, v96, v12
    v_mul_f32 v97, v97, v13
    v_mul_f32 v98, v98, v14
    v_mul_f32 v99, v99, v15
    v_cvt_pk_bf16_f32 v68, v96, v97
    v_cvt_pk_bf16_f32 v69, v98, v99
    ds_write_b64 v60, v[68:69] offset:5120
    s_waitcnt vmcnt(12)
    s_barrier
    s_mov_b32 s60, 2048
    s_add_u32 m0, s58, 49152
    s_nop 0
    buffer_load_dwordx4 v38, s[36:39], s60 offen offset:0 lds
    buffer_load_dwordx4 v39, s[36:39], s60 offen offset:1024 lds
    buffer_load_dwordx4 v40, s[36:39], s60 offen offset:2048 lds
    buffer_load_dwordx4 v41, s[36:39], s60 offen offset:3072 lds
    s_mov_b32 s61, 12288000
    s_add_u32 m0, s58, 114688
    s_nop 0
    buffer_load_dwordx4 v42, s[32:35], s61 offen offset:0 sc1 lds
    buffer_load_dwordx4 v43, s[32:35], s61 offen offset:1024 sc1 lds
    buffer_load_dwordx4 v44, s[32:35], s61 offen offset:2048 sc1 lds
    buffer_load_dwordx4 v45, s[32:35], s61 offen offset:3072 sc1 lds
    s_waitcnt lgkmcnt(0)
    ds_read_b64 v[64:65], v60 offset:6144
    v_lshlrev_b32 v96, 16, v66
    v_and_b32 v97, 0xffff0000, v66
    v_lshlrev_b32 v98, 16, v67
    v_and_b32 v99, 0xffff0000, v67
    v_mul_f32 v12, v96, v96
    v_mul_f32 v13, v97, v97
    v_mul_f32 v14, v98, v98
    v_mul_f32 v15, v99, v99
    v_fma_f32 v12, v12, v48, v46
    v_fma_f32 v13, v13, v48, v46
    v_fma_f32 v14, v14, v48, v46
    v_fma_f32 v15, v15, v48, v46
    v_mul_f32 v12, v12, v96
    v_mul_f32 v13, v13, v97
    v_mul_f32 v14, v14, v98
    v_mul_f32 v15, v15, v99
    v_exp_f32 v12, v12
    v_exp_f32 v13, v13
    v_exp_f32 v14, v14
    v_exp_f32 v15, v15
    v_add_f32 v12, 1.0, v12
    v_add_f32 v13, 1.0, v13
    v_add_f32 v14, 1.0, v14
    v_add_f32 v15, 1.0, v15
    v_rcp_f32 v12, v12
    v_rcp_f32 v13, v13
    v_rcp_f32 v14, v14
    v_rcp_f32 v15, v15
    v_mul_f32 v96, v96, v12
    v_mul_f32 v97, v97, v13
    v_mul_f32 v98, v98, v14
    v_mul_f32 v99, v99, v15
    v_cvt_pk_bf16_f32 v68, v96, v97
    v_cvt_pk_bf16_f32 v69, v98, v99
    ds_write_b64 v60, v[68:69] offset:5632
    s_waitcnt vmcnt(12)
    s_barrier
    s_mov_b32 s60, 2176
    s_add_u32 m0, s58, 65536
    s_nop 0
    buffer_load_dwordx4 v38, s[36:39], s60 offen offset:0 lds
    buffer_load_dwordx4 v39, s[36:39], s60 offen offset:1024 lds
    buffer_load_dwordx4 v40, s[36:39], s60 offen offset:2048 lds
    buffer_load_dwordx4 v41, s[36:39], s60 offen offset:3072 lds
    s_mov_b32 s61, 12517376
    s_add_u32 m0, s58, 131072
    s_nop 0
    buffer_load_dwordx4 v42, s[32:35], s61 offen offset:0 sc1 lds
    buffer_load_dwordx4 v43, s[32:35], s61 offen offset:1024 sc1 lds
    buffer_load_dwordx4 v44, s[32:35], s61 offen offset:2048 sc1 lds
    buffer_load_dwordx4 v45, s[32:35], s61 offen offset:3072 sc1 lds
    s_waitcnt lgkmcnt(0)
    ds_read_b64 v[66:67], v60 offset:6656
    v_lshlrev_b32 v96, 16, v64
    v_and_b32 v97, 0xffff0000, v64
    v_lshlrev_b32 v98, 16, v65
    v_and_b32 v99, 0xffff0000, v65
    v_mul_f32 v12, v96, v96
    v_mul_f32 v13, v97, v97
    v_mul_f32 v14, v98, v98
    v_mul_f32 v15, v99, v99
    v_fma_f32 v12, v12, v48, v46
    v_fma_f32 v13, v13, v48, v46
    v_fma_f32 v14, v14, v48, v46
    v_fma_f32 v15, v15, v48, v46
    v_mul_f32 v12, v12, v96
    v_mul_f32 v13, v13, v97
    v_mul_f32 v14, v14, v98
    v_mul_f32 v15, v15, v99
    v_exp_f32 v12, v12
    v_exp_f32 v13, v13
    v_exp_f32 v14, v14
    v_exp_f32 v15, v15
    v_add_f32 v12, 1.0, v12
    v_add_f32 v13, 1.0, v13
    v_add_f32 v14, 1.0, v14
    v_add_f32 v15, 1.0, v15
    v_rcp_f32 v12, v12
    v_rcp_f32 v13, v13
    v_rcp_f32 v14, v14
    v_rcp_f32 v15, v15
    v_mul_f32 v96, v96, v12
    v_mul_f32 v97, v97, v13
    v_mul_f32 v98, v98, v14
    v_mul_f32 v99, v99, v15
    v_cvt_pk_bf16_f32 v68, v96, v97
    v_cvt_pk_bf16_f32 v69, v98, v99
    ds_write_b64 v60, v[68:69] offset:6144
    s_waitcnt vmcnt(12)
    s_barrier
    s_mov_b32 s60, 2304
    s_add_u32 m0, s58, 81920
    s_nop 0
    buffer_load_dwordx4 v38, s[36:39], s60 offen offset:0 lds
    buffer_load_dwordx4 v39, s[36:39], s60 offen offset:1024 lds
    buffer_load_dwordx4 v40, s[36:39], s60 offen offset:2048 lds
    buffer_load_dwordx4 v41, s[36:39], s60 offen offset:3072 lds
    s_mov_b32 s61, 12746752
    s_add_u32 m0, s58, 147456
    s_nop 0
    buffer_load_dwordx4 v42, s[32:35], s61 offen offset:0 sc1 lds
    buffer_load_dwordx4 v43, s[32:35], s61 offen offset:1024 sc1 lds
    buffer_load_dwordx4 v44, s[32:35], s61 offen offset:2048 sc1 lds
    buffer_load_dwordx4 v45, s[32:35], s61 offen offset:3072 sc1 lds
    s_waitcnt lgkmcnt(0)
    ds_read_b64 v[64:65], v60 offset:7168
    v_lshlrev_b32 v96, 16, v66
    v_and_b32 v97, 0xffff0000, v66
    v_lshlrev_b32 v98, 16, v67
    v_and_b32 v99, 0xffff0000, v67
    v_mul_f32 v12, v96, v96
    v_mul_f32 v13, v97, v97
    v_mul_f32 v14, v98, v98
    v_mul_f32 v15, v99, v99
    v_fma_f32 v12, v12, v48, v46
    v_fma_f32 v13, v13, v48, v46
    v_fma_f32 v14, v14, v48, v46
    v_fma_f32 v15, v15, v48, v46
    v_mul_f32 v12, v12, v96
    v_mul_f32 v13, v13, v97
    v_mul_f32 v14, v14, v98
    v_mul_f32 v15, v15, v99
    v_exp_f32 v12, v12
    v_exp_f32 v13, v13
    v_exp_f32 v14, v14
    v_exp_f32 v15, v15
    v_add_f32 v12, 1.0, v12
    v_add_f32 v13, 1.0, v13
    v_add_f32 v14, 1.0, v14
    v_add_f32 v15, 1.0, v15
    v_rcp_f32 v12, v12
    v_rcp_f32 v13, v13
    v_rcp_f32 v14, v14
    v_rcp_f32 v15, v15
    v_mul_f32 v96, v96, v12
    v_mul_f32 v97, v97, v13
    v_mul_f32 v98, v98, v14
    v_mul_f32 v99, v99, v15
    v_cvt_pk_bf16_f32 v68, v96, v97
    v_cvt_pk_bf16_f32 v69, v98, v99
    ds_write_b64 v60, v[68:69] offset:6656
    s_waitcnt vmcnt(12)
    s_barrier
    s_mov_b32 s60, 2432
    s_add_u32 m0, s58, 49152
    s_nop 0
    buffer_load_dwordx4 v38, s[36:39], s60 offen offset:0 lds
    buffer_load_dwordx4 v39, s[36:39], s60 offen offset:1024 lds
    buffer_load_dwordx4 v40, s[36:39], s60 offen offset:2048 lds
    buffer_load_dwordx4 v41, s[36:39], s60 offen offset:3072 lds
    s_mov_b32 s61, 12976128
    s_add_u32 m0, s58, 98304
    s_nop 0
    buffer_load_dwordx4 v42, s[32:35], s61 offen offset:0 sc1 lds
    buffer_load_dwordx4 v43, s[32:35], s61 offen offset:1024 sc1 lds
    buffer_load_dwordx4 v44, s[32:35], s61 offen offset:2048 sc1 lds
    buffer_load_dwordx4 v45, s[32:35], s61 offen offset:3072 sc1 lds
    s_waitcnt lgkmcnt(0)
    ds_read_b64 v[66:67], v60 offset:7680
    v_lshlrev_b32 v96, 16, v64
    v_and_b32 v97, 0xffff0000, v64
    v_lshlrev_b32 v98, 16, v65
    v_and_b32 v99, 0xffff0000, v65
    v_mul_f32 v12, v96, v96
    v_mul_f32 v13, v97, v97
    v_mul_f32 v14, v98, v98
    v_mul_f32 v15, v99, v99
    v_fma_f32 v12, v12, v48, v46
    v_fma_f32 v13, v13, v48, v46
    v_fma_f32 v14, v14, v48, v46
    v_fma_f32 v15, v15, v48, v46
    v_mul_f32 v12, v12, v96
    v_mul_f32 v13, v13, v97
    v_mul_f32 v14, v14, v98
    v_mul_f32 v15, v15, v99
    v_exp_f32 v12, v12
    v_exp_f32 v13, v13
    v_exp_f32 v14, v14
    v_exp_f32 v15, v15
    v_add_f32 v12, 1.0, v12
    v_add_f32 v13, 1.0, v13
    v_add_f32 v14, 1.0, v14
    v_add_f32 v15, 1.0, v15
    v_rcp_f32 v12, v12
    v_rcp_f32 v13, v13
    v_rcp_f32 v14, v14
    v_rcp_f32 v15, v15
    v_mul_f32 v96, v96, v12
    v_mul_f32 v97, v97, v13
    v_mul_f32 v98, v98, v14
    v_mul_f32 v99, v99, v15
    v_cvt_pk_bf16_f32 v68, v96, v97
    v_cvt_pk_bf16_f32 v69, v98, v99
    ds_write_b64 v60, v[68:69] offset:7168
    s_waitcnt vmcnt(12)
    s_barrier
    s_mov_b32 s60, 2560
    s_add_u32 m0, s58, 65536
    s_nop 0
    buffer_load_dwordx4 v38, s[36:39], s60 offen offset:0 lds
    buffer_load_dwordx4 v39, s[36:39], s60 offen offset:1024 lds
    buffer_load_dwordx4 v40, s[36:39], s60 offen offset:2048 lds
    buffer_load_dwordx4 v41, s[36:39], s60 offen offset:3072 lds
    s_mov_b32 s61, 13205504
    s_add_u32 m0, s58, 114688
    s_nop 0
    buffer_load_dwordx4 v42, s[32:35], s61 offen offset:0 sc1 lds
    buffer_load_dwordx4 v43, s[32:35], s61 offen offset:1024 sc1 lds
    buffer_load_dwordx4 v44, s[32:35], s61 offen offset:2048 sc1 lds
    buffer_load_dwordx4 v45, s[32:35], s61 offen offset:3072 sc1 lds
    s_waitcnt lgkmcnt(0)
    v_lshlrev_b32 v96, 16, v66
    v_and_b32 v97, 0xffff0000, v66
    v_lshlrev_b32 v98, 16, v67
    v_and_b32 v99, 0xffff0000, v67
    v_mul_f32 v12, v96, v96
    v_mul_f32 v13, v97, v97
    v_mul_f32 v14, v98, v98
    v_mul_f32 v15, v99, v99
    v_fma_f32 v12, v12, v48, v46
    v_fma_f32 v13, v13, v48, v46
    v_fma_f32 v14, v14, v48, v46
    v_fma_f32 v15, v15, v48, v46
    v_mul_f32 v12, v12, v96
    v_mul_f32 v13, v13, v97
    v_mul_f32 v14, v14, v98
    v_mul_f32 v15, v15, v99
    v_exp_f32 v12, v12
    v_exp_f32 v13, v13
    v_exp_f32 v14, v14
    v_exp_f32 v15, v15
    v_add_f32 v12, 1.0, v12
    v_add_f32 v13, 1.0, v13
    v_add_f32 v14, 1.0, v14
    v_add_f32 v15, 1.0, v15
    v_rcp_f32 v12, v12
    v_rcp_f32 v13, v13
    v_rcp_f32 v14, v14
    v_rcp_f32 v15, v15
    v_mul_f32 v96, v96, v12
    v_mul_f32 v97, v97, v13
    v_mul_f32 v98, v98, v14
    v_mul_f32 v99, v99, v15
    v_cvt_pk_bf16_f32 v68, v96, v97
    v_cvt_pk_bf16_f32 v69, v98, v99
    ds_write_b64 v60, v[68:69] offset:7680
    s_waitcnt lgkmcnt(0)
    s_waitcnt vmcnt(12)
    s_barrier
    s_mov_b32 s60, 2688
    s_add_u32 m0, s58, 81920
    s_nop 0
    buffer_load_dwordx4 v38, s[36:39], s60 offen offset:0 lds
    buffer_load_dwordx4 v39, s[36:39], s60 offen offset:1024 lds
    buffer_load_dwordx4 v40, s[36:39], s60 offen offset:2048 lds
    buffer_load_dwordx4 v41, s[36:39], s60 offen offset:3072 lds
    s_mov_b32 s61, 13434880
    s_add_u32 m0, s58, 131072
    s_nop 0
    buffer_load_dwordx4 v42, s[32:35], s61 offen offset:0 sc1 lds
    buffer_load_dwordx4 v43, s[32:35], s61 offen offset:1024 sc1 lds
    buffer_load_dwordx4 v44, s[32:35], s61 offen offset:2048 sc1 lds
    buffer_load_dwordx4 v45, s[32:35], s61 offen offset:3072 sc1 lds
    s_waitcnt vmcnt(12)
    s_barrier
    s_mov_b32 s60, 2816
    s_add_u32 m0, s58, 49152
    s_nop 0
    buffer_load_dwordx4 v38, s[36:39], s60 offen offset:0 lds
    buffer_load_dwordx4 v39, s[36:39], s60 offen offset:1024 lds
    buffer_load_dwordx4 v40, s[36:39], s60 offen offset:2048 lds
    buffer_load_dwordx4 v41, s[36:39], s60 offen offset:3072 lds
    s_mov_b32 s61, 13664256
    s_add_u32 m0, s58, 147456
    s_nop 0
    buffer_load_dwordx4 v42, s[32:35], s61 offen offset:0 sc1 lds
    buffer_load_dwordx4 v43, s[32:35], s61 offen offset:1024 sc1 lds
    buffer_load_dwordx4 v44, s[32:35], s61 offen offset:2048 sc1 lds
    buffer_load_dwordx4 v45, s[32:35], s61 offen offset:3072 sc1 lds
    s_waitcnt vmcnt(12)
    s_barrier
    s_mov_b32 s60, 2944
    s_add_u32 m0, s58, 65536
    s_nop 0
    buffer_load_dwordx4 v38, s[36:39], s60 offen offset:0 lds
    buffer_load_dwordx4 v39, s[36:39], s60 offen offset:1024 lds
    buffer_load_dwordx4 v40, s[36:39], s60 offen offset:2048 lds
    buffer_load_dwordx4 v41, s[36:39], s60 offen offset:3072 lds
    s_mov_b32 s61, 13893632
    s_add_u32 m0, s58, 98304
    s_nop 0
    buffer_load_dwordx4 v42, s[32:35], s61 offen offset:0 sc1 lds
    buffer_load_dwordx4 v43, s[32:35], s61 offen offset:1024 sc1 lds
    buffer_load_dwordx4 v44, s[32:35], s61 offen offset:2048 sc1 lds
    buffer_load_dwordx4 v45, s[32:35], s61 offen offset:3072 sc1 lds
    s_waitcnt vmcnt(12)
    s_barrier
    s_mov_b32 s60, 3072
    s_add_u32 m0, s58, 81920
    s_nop 0
    buffer_load_dwordx4 v38, s[36:39], s60 offen offset:0 lds
    buffer_load_dwordx4 v39, s[36:39], s60 offen offset:1024 lds
    buffer_load_dwordx4 v40, s[36:39], s60 offen offset:2048 lds
    buffer_load_dwordx4 v41, s[36:39], s60 offen offset:3072 lds
    s_mov_b32 s61, 14123008
    s_add_u32 m0, s58, 114688
    s_nop 0
    buffer_load_dwordx4 v42, s[32:35], s61 offen offset:0 sc1 lds
    buffer_load_dwordx4 v43, s[32:35], s61 offen offset:1024 sc1 lds
    buffer_load_dwordx4 v44, s[32:35], s61 offen offset:2048 sc1 lds
    buffer_load_dwordx4 v45, s[32:35], s61 offen offset:3072 sc1 lds
    s_waitcnt vmcnt(12)
    s_barrier
    s_mov_b32 s60, 3200
    s_add_u32 m0, s58, 49152
    s_nop 0
    buffer_load_dwordx4 v38, s[36:39], s60 offen offset:0 lds
    buffer_load_dwordx4 v39, s[36:39], s60 offen offset:1024 lds
    buffer_load_dwordx4 v40, s[36:39], s60 offen offset:2048 lds
    buffer_load_dwordx4 v41, s[36:39], s60 offen offset:3072 lds
    s_mov_b32 s61, 14352384
    s_add_u32 m0, s58, 131072
    s_nop 0
    buffer_load_dwordx4 v42, s[32:35], s61 offen offset:0 sc1 lds
    buffer_load_dwordx4 v43, s[32:35], s61 offen offset:1024 sc1 lds
    buffer_load_dwordx4 v44, s[32:35], s61 offen offset:2048 sc1 lds
    buffer_load_dwordx4 v45, s[32:35], s61 offen offset:3072 sc1 lds
    s_waitcnt vmcnt(12)
    s_barrier
    s_mov_b32 s60, 3328
    s_add_u32 m0, s58, 65536
    s_nop 0
    buffer_load_dwordx4 v38, s[36:39], s60 offen offset:0 lds
    buffer_load_dwordx4 v39, s[36:39], s60 offen offset:1024 lds
    buffer_load_dwordx4 v40, s[36:39], s60 offen offset:2048 lds
    buffer_load_dwordx4 v41, s[36:39], s60 offen offset:3072 lds
    s_mov_b32 s61, 14581760
    s_add_u32 m0, s58, 147456
    s_nop 0
    buffer_load_dwordx4 v42, s[32:35], s61 offen offset:0 sc1 lds
    buffer_load_dwordx4 v43, s[32:35], s61 offen offset:1024 sc1 lds
    buffer_load_dwordx4 v44, s[32:35], s61 offen offset:2048 sc1 lds
    buffer_load_dwordx4 v45, s[32:35], s61 offen offset:3072 sc1 lds
    s_waitcnt vmcnt(12)
    s_barrier
    s_mov_b32 s60, 3456
    s_add_u32 m0, s58, 81920
    s_nop 0
    buffer_load_dwordx4 v38, s[36:39], s60 offen offset:0 lds
    buffer_load_dwordx4 v39, s[36:39], s60 offen offset:1024 lds
    buffer_load_dwordx4 v40, s[36:39], s60 offen offset:2048 lds
    buffer_load_dwordx4 v41, s[36:39], s60 offen offset:3072 lds
    s_mov_b32 s61, 14811136
    s_add_u32 m0, s58, 98304
    s_nop 0
    buffer_load_dwordx4 v42, s[32:35], s61 offen offset:0 sc1 lds
    buffer_load_dwordx4 v43, s[32:35], s61 offen offset:1024 sc1 lds
    buffer_load_dwordx4 v44, s[32:35], s61 offen offset:2048 sc1 lds
    buffer_load_dwordx4 v45, s[32:35], s61 offen offset:3072 sc1 lds
    s_waitcnt vmcnt(12)
    s_barrier
    s_mov_b32 s60, 3584
    s_add_u32 m0, s58, 49152
    s_nop 0
    buffer_load_dwordx4 v38, s[36:39], s60 offen offset:0 lds
    buffer_load_dwordx4 v39, s[36:39], s60 offen offset:1024 lds
    buffer_load_dwordx4 v40, s[36:39], s60 offen offset:2048 lds
    buffer_load_dwordx4 v41, s[36:39], s60 offen offset:3072 lds
    s_mov_b32 s61, 15040512
    s_add_u32 m0, s58, 114688
    s_nop 0
    buffer_load_dwordx4 v42, s[32:35], s61 offen offset:0 sc1 lds
    buffer_load_dwordx4 v43, s[32:35], s61 offen offset:1024 sc1 lds
    buffer_load_dwordx4 v44, s[32:35], s61 offen offset:2048 sc1 lds
    buffer_load_dwordx4 v45, s[32:35], s61 offen offset:3072 sc1 lds
    s_waitcnt vmcnt(12)
    s_barrier
    s_mov_b32 s60, 3712
    s_add_u32 m0, s58, 65536
    s_nop 0
    buffer_load_dwordx4 v38, s[36:39], s60 offen offset:0 lds
    buffer_load_dwordx4 v39, s[36:39], s60 offen offset:1024 lds
    buffer_load_dwordx4 v40, s[36:39], s60 offen offset:2048 lds
    buffer_load_dwordx4 v41, s[36:39], s60 offen offset:3072 lds
    s_mov_b32 s61, 15269888
    s_add_u32 m0, s58, 131072
    s_nop 0
    buffer_load_dwordx4 v42, s[32:35], s61 offen offset:0 sc1 lds
    buffer_load_dwordx4 v43, s[32:35], s61 offen offset:1024 sc1 lds
    buffer_load_dwordx4 v44, s[32:35], s61 offen offset:2048 sc1 lds
    buffer_load_dwordx4 v45, s[32:35], s61 offen offset:3072 sc1 lds
    s_waitcnt vmcnt(12)
    s_barrier
    s_mov_b32 s60, 3840
    s_add_u32 m0, s58, 81920
    s_nop 0
    buffer_load_dwordx4 v38, s[36:39], s60 offen offset:0 lds
    buffer_load_dwordx4 v39, s[36:39], s60 offen offset:1024 lds
    buffer_load_dwordx4 v40, s[36:39], s60 offen offset:2048 lds
    buffer_load_dwordx4 v41, s[36:39], s60 offen offset:3072 lds
    s_mov_b32 s61, 15499264
    s_add_u32 m0, s58, 147456
    s_nop 0
    buffer_load_dwordx4 v42, s[32:35], s61 offen offset:0 sc1 lds
    buffer_load_dwordx4 v43, s[32:35], s61 offen offset:1024 sc1 lds
    buffer_load_dwordx4 v44, s[32:35], s61 offen offset:2048 sc1 lds
    buffer_load_dwordx4 v45, s[32:35], s61 offen offset:3072 sc1 lds
    s_waitcnt vmcnt(12)
    s_barrier
    s_mov_b32 s60, 3968
    s_add_u32 m0, s58, 49152
    s_nop 0
    buffer_load_dwordx4 v38, s[36:39], s60 offen offset:0 lds
    buffer_load_dwordx4 v39, s[36:39], s60 offen offset:1024 lds
    buffer_load_dwordx4 v40, s[36:39], s60 offen offset:2048 lds
    buffer_load_dwordx4 v41, s[36:39], s60 offen offset:3072 lds
    s_waitcnt vmcnt(8)
    s_barrier
    s_waitcnt vmcnt(0)
    s_barrier
    s_barrier
    s_mov_b32 s44, s18
    s_and_b32 s45, s19, 0xffff
    s_mov_b32 s46, 3670016
    s_mov_b32 s47, 0x20000
    s_and_b32 s52, s29, 1
    s_lshl_b32 s52, s52, 6
    s_lshl_b32 s53, s26, 7
    s_add_u32 s52, s52, s53
    s_lshl_b32 s53, s48, 4
    s_add_u32 s52, s52, s53
    s_mov_b32 s55, 3584
    v_or_b32 v5, 0, v4
    v_xor_b32 v5, v5, v3
    v_lshlrev_b32 v5, 4, v5
    v_add_u32 v6, s52, v2
    v_mul_lo_u32 v6, v6, s55
    v_add_u32 v30, v6, v5
    v_or_b32 v5, 4, v4
    v_xor_b32 v5, v5, v3
    v_lshlrev_b32 v5, 4, v5
    v_add_u32 v6, s52, v2
    v_add_u32 v6, 8, v6
    v_mul_lo_u32 v6, v6, s55
    v_add_u32 v31, v6, v5
    s_lshr_b32 s53, s29, 1
    s_lshl_b32 s54, s28, 2
    s_add_u32 s53, s53, s54
    s_lshl_b32 s53, s53, 8
    s_lshr_b32 s54, s48, 1
    s_lshl_b32 s54, s54, 7
    s_add_u32 s53, s53, s54
    s_mov_b32 s55, 2048
    s_and_b32 s56, s48, 1
    s_lshl_b32 s56, s56, 16
    s_add_u32 s53, s53, s56
    v_add_u32 v6, 0, v2
    v_mul_lo_u32 v6, v6, s55
    v_add_u32 v6, s53, v6
    v_and_b32 v7, 1, v4
    v_or_b32 v7, 0, v7
    v_lshlrev_b32 v7, 1, v7
    v_xor_b32 v7, v7, v3
    v_lshlrev_b32 v7, 4, v7
    v_add_u32 v32, v6, v7
    v_add_u32 v6, 8, v2
    v_mul_lo_u32 v6, v6, s55
    v_add_u32 v6, s53, v6
    v_and_b32 v7, 1, v4
    v_or_b32 v7, 2, v7
    v_lshlrev_b32 v7, 1, v7
    v_xor_b32 v7, v7, v3
    v_lshlrev_b32 v7, 4, v7
    v_add_u32 v33, v6, v7
    v_add_u32 v6, 16, v2
    v_mul_lo_u32 v6, v6, s55
    v_add_u32 v6, s53, v6
    v_and_b32 v7, 1, v4
    v_or_b32 v7, 0, v7
    v_lshlrev_b32 v7, 1, v7
    v_xor_b32 v7, v7, v3
    v_lshlrev_b32 v7, 4, v7
    v_add_u32 v34, v6, v7
    v_add_u32 v6, 24, v2
    v_mul_lo_u32 v6, v6, s55
    v_add_u32 v6, s53, v6
    v_and_b32 v7, 1, v4
    v_or_b32 v7, 2, v7
    v_lshlrev_b32 v7, 1, v7
    v_xor_b32 v7, v7, v3
    v_lshlrev_b32 v7, 4, v7
    v_add_u32 v35, v6, v7
    s_lshl_b32 s58, s48, 11
    s_lshl_b32 s59, s48, 12
    v_subrev_u32 v31, 1024, v31
    v_subrev_u32 v33, 1024, v33
    v_subrev_u32 v34, 2048, v34
    v_subrev_u32 v35, 3072, v35
    s_barrier
    s_cmp_lg_u32 s48, 0
    s_cbranch_scc1 mega_kernel_skip42
    v_and_b32 v8, 15, v1
    v_lshlrev_b32 v8, 2, v8
    s_lshl_b32 s50, s26, 7
    s_add_u32 s50, s50, 27277312
    v_mov_b32 v9, s50
    v_add_u32 v8, v8, v9
    buffer_load_dword v9, v8, s[32:35], 0 offen sc1
mega_kernel_skip42:
    s_mov_b32 s61, 0
    s_add_u32 m0, s59, 49152
    s_nop 0
    buffer_load_dwordx4 v32, s[44:47], s61 offen offset:0 lds
    buffer_load_dwordx4 v33, s[44:47], s61 offen offset:1024 lds
    buffer_load_dwordx4 v34, s[44:47], s61 offen offset:2048 lds
    buffer_load_dwordx4 v35, s[44:47], s61 offen offset:3072 lds
    s_mov_b32 s61, 131072
    s_add_u32 m0, s59, 65536
    s_nop 0
    buffer_load_dwordx4 v32, s[44:47], s61 offen offset:0 lds
    buffer_load_dwordx4 v33, s[44:47], s61 offen offset:1024 lds
    buffer_load_dwordx4 v34, s[44:47], s61 offen offset:2048 lds
    buffer_load_dwordx4 v35, s[44:47], s61 offen offset:3072 lds
    s_mov_b32 s61, 262144
    s_add_u32 m0, s59, 81920
    s_nop 0
    buffer_load_dwordx4 v32, s[44:47], s61 offen offset:0 lds
    buffer_load_dwordx4 v33, s[44:47], s61 offen offset:1024 lds
    buffer_load_dwordx4 v34, s[44:47], s61 offen offset:2048 lds
    buffer_load_dwordx4 v35, s[44:47], s61 offen offset:3072 lds
    s_mov_b32 s61, 393216
    s_add_u32 m0, s59, 98304
    s_nop 0
    buffer_load_dwordx4 v32, s[44:47], s61 offen offset:0 lds
    buffer_load_dwordx4 v33, s[44:47], s61 offen offset:1024 lds
    buffer_load_dwordx4 v34, s[44:47], s61 offen offset:2048 lds
    buffer_load_dwordx4 v35, s[44:47], s61 offen offset:3072 lds
    s_mov_b32 s61, 524288
    s_add_u32 m0, s59, 114688
    s_nop 0
    buffer_load_dwordx4 v32, s[44:47], s61 offen offset:0 lds
    buffer_load_dwordx4 v33, s[44:47], s61 offen offset:1024 lds
    buffer_load_dwordx4 v34, s[44:47], s61 offen offset:2048 lds
    buffer_load_dwordx4 v35, s[44:47], s61 offen offset:3072 lds
    s_barrier
    s_cmp_lg_u32 s48, 0
    s_cbranch_scc1 mega_kernel_skip43
    s_lshl_b32 s50, s26, 7
    s_lshl_b32 s51, s27, 2
    s_add_u32 s50, s50, s51
    s_add_u32 s50, s50, 27277312
    v_mov_b32 v6, s31
    v_mov_b32 v5, 0
    s_mov_b64 s[52:53], exec
    s_mov_b64 exec, 1
    buffer_store_dword v6, v5, s[32:35], s50 offen sc1
    s_mov_b64 exec, s[52:53]
mega_kernel_skip43:
    s_cmp_lg_u32 s48, 0
    s_cbranch_scc1 mega_kernel_skip44
    s_waitcnt vmcnt(20)
    v_cmp_eq_u32 vcc, s31, v9
    s_nop 3
    s_and_b32 s50, vcc_lo, 0x7f
    s_xor_b32 s50, s50, 0x7f
    s_lshl_b32 s51, 1, s27
    s_andn2_b32 s50, s50, s51
    s_cmp_eq_u32 s50, 0
    s_cbranch_scc1 mega_kernel_ok45
    s_mov_b32 s54, 0
mega_kernel_spin46:
    buffer_load_dword v9, v8, s[32:35], 0 offen sc1
    s_waitcnt vmcnt(0)
    v_cmp_eq_u32 vcc, s31, v9
    s_nop 3
    s_and_b32 s50, vcc_lo, 0x7f
    s_xor_b32 s50, s50, 0x7f
    s_lshl_b32 s51, 1, s27
    s_andn2_b32 s50, s50, s51
    s_cmp_eq_u32 s50, 0
    s_cbranch_scc1 mega_kernel_ok45
    s_sleep 1
    s_add_u32 s54, s54, 1
    s_cmp_lt_u32 s54, 30000
    s_cbranch_scc1 mega_kernel_spin46
mega_kernel_ok45:
mega_kernel_skip44:
    s_branch p_g5
p_idle:
    s_waitcnt vmcnt(0)
    s_lshl_b32 s52, s26, 1
    s_add_u32 s52, s52, s28
    s_mov_b32 s36, s14
    s_and_b32 s37, s15, 0xffff
    s_mov_b32 s38, 8388608
    s_mov_b32 s39, 0x20000
    s_lshl_b32 s53, s52, 18
    s_lshl_b32 s54, s48, 16
    s_add_u32 s53, s53, s54
    v_lshlrev_b32 v12, 7, v1
    buffer_load_dword v13, v12, s[36:39], s53 offen
    s_add_u32 s53, s53, 8192
    buffer_load_dword v13, v12, s[36:39], s53 offen
    s_add_u32 s53, s53, 8192
    s_waitcnt vmcnt(0)
    buffer_load_dword v13, v12, s[36:39], s53 offen
    s_add_u32 s53, s53, 8192
    buffer_load_dword v13, v12, s[36:39], s53 offen
    s_add_u32 s53, s53, 8192
    s_waitcnt vmcnt(0)
    buffer_load_dword v13, v12, s[36:39], s53 offen
    s_add_u32 s53, s53, 8192
    buffer_load_dword v13, v12, s[36:39], s53 offen
    s_add_u32 s53, s53, 8192
    s_waitcnt vmcnt(0)
    buffer_load_dword v13, v12, s[36:39], s53 offen
    s_add_u32 s53, s53, 8192
    buffer_load_dword v13, v12, s[36:39], s53 offen
    s_add_u32 s53, s53, 8192
    s_waitcnt vmcnt(0)
    s_mov_b32 s36, s18
    s_and_b32 s37, s19, 0xffff
    s_mov_b32 s38, 3670016
    s_mov_b32 s39, 0x20000
    s_mul_i32 s53, s52, 114688
    s_mul_i32 s54, s48, 28672
    s_add_u32 s53, s53, s54
    buffer_load_dword v13, v12, s[36:39], s53 offen
    s_add_u32 s53, s53, 8192
    buffer_load_dword v13, v12, s[36:39], s53 offen
    s_add_u32 s53, s53, 8192
    buffer_load_dword v13, v12, s[36:39], s53 offen
    s_add_u32 s53, s53, 8192
    buffer_load_dword v13, v12, s[36:39], s53 offen
    s_add_u32 s53, s53, 8192
    s_waitcnt vmcnt(0)
    s_mov_b32 s44, s18
    s_and_b32 s45, s19, 0xffff
    s_mov_b32 s46, 3670016
    s_mov_b32 s47, 0x20000
    s_and_b32 s52, s29, 1
    s_lshl_b32 s52, s52, 6
    s_lshl_b32 s53, s26, 7
    s_add_u32 s52, s52, s53
    s_lshl_b32 s53, s48, 4
    s_add_u32 s52, s52, s53
    s_mov_b32 s55, 3584
    v_or_b32 v5, 0, v4
    v_xor_b32 v5, v5, v3
    v_lshlrev_b32 v5, 4, v5
    v_add_u32 v6, s52, v2
    v_mul_lo_u32 v6, v6, s55
    v_add_u32 v30, v6, v5
    v_or_b32 v5, 4, v4
    v_xor_b32 v5, v5, v3
    v_lshlrev_b32 v5, 4, v5
    v_add_u32 v6, s52, v2
    v_add_u32 v6, 8, v6
    v_mul_lo_u32 v6, v6, s55
    v_add_u32 v31, v6, v5
    s_lshr_b32 s53, s29, 1
    s_lshl_b32 s54, s28, 2
    s_add_u32 s53, s53, s54
    s_lshl_b32 s53, s53, 8
    s_lshr_b32 s54, s48, 1
    s_lshl_b32 s54, s54, 7
    s_add_u32 s53, s53, s54
    s_mov_b32 s55, 2048
    s_and_b32 s56, s48, 1
    s_lshl_b32 s56, s56, 16
    s_add_u32 s53, s53, s56
    v_add_u32 v6, 0, v2
    v_mul_lo_u32 v6, v6, s55
    v_add_u32 v6, s53, v6
    v_and_b32 v7, 1, v4
    v_or_b32 v7, 0, v7
    v_lshlrev_b32 v7, 1, v7
    v_xor_b32 v7, v7, v3
    v_lshlrev_b32 v7, 4, v7
    v_add_u32 v32, v6, v7
    v_add_u32 v6, 8, v2
    v_mul_lo_u32 v6, v6, s55
    v_add_u32 v6, s53, v6
    v_and_b32 v7, 1, v4
    v_or_b32 v7, 2, v7
    v_lshlrev_b32 v7, 1, v7
    v_xor_b32 v7, v7, v3
    v_lshlrev_b32 v7, 4, v7
    v_add_u32 v33, v6, v7
    v_add_u32 v6, 16, v2
    v_mul_lo_u32 v6, v6, s55
    v_add_u32 v6, s53, v6
    v_and_b32 v7, 1, v4
    v_or_b32 v7, 0, v7
    v_lshlrev_b32 v7, 1, v7
    v_xor_b32 v7, v7, v3
    v_lshlrev_b32 v7, 4, v7
    v_add_u32 v34, v6, v7
    v_add_u32 v6, 24, v2
    v_mul_lo_u32 v6, v6, s55
    v_add_u32 v6, s53, v6
    v_and_b32 v7, 1, v4
    v_or_b32 v7, 2, v7
    v_lshlrev_b32 v7, 1, v7
    v_xor_b32 v7, v7, v3
    v_lshlrev_b32 v7, 4, v7
    v_add_u32 v35, v6, v7
    s_lshl_b32 s58, s48, 11
    s_lshl_b32 s59, s48, 12
    v_subrev_u32 v31, 1024, v31
    v_subrev_u32 v33, 1024, v33
    v_subrev_u32 v34, 2048, v34
    v_subrev_u32 v35, 3072, v35
    s_mov_b32 s61, 0
    s_add_u32 m0, s59, 49152
    s_nop 0
    buffer_load_dwordx4 v32, s[44:47], s61 offen offset:0 lds
    buffer_load_dwordx4 v33, s[44:47], s61 offen offset:1024 lds
    buffer_load_dwordx4 v34, s[44:47], s61 offen offset:2048 lds
    buffer_load_dwordx4 v35, s[44:47], s61 offen offset:3072 lds
    s_mov_b32 s61, 131072
    s_add_u32 m0, s59, 65536
    s_nop 0
    buffer_load_dwordx4 v32, s[44:47], s61 offen offset:0 lds
    buffer_load_dwordx4 v33, s[44:47], s61 offen offset:1024 lds
    buffer_load_dwordx4 v34, s[44:47], s61 offen offset:2048 lds
    buffer_load_dwordx4 v35, s[44:47], s61 offen offset:3072 lds
    s_mov_b32 s61, 262144
    s_add_u32 m0, s59, 81920
    s_nop 0
    buffer_load_dwordx4 v32, s[44:47], s61 offen offset:0 lds
    buffer_load_dwordx4 v33, s[44:47], s61 offen offset:1024 lds
    buffer_load_dwordx4 v34, s[44:47], s61 offen offset:2048 lds
    buffer_load_dwordx4 v35, s[44:47], s61 offen offset:3072 lds
    s_mov_b32 s61, 393216
    s_add_u32 m0, s59, 98304
    s_nop 0
    buffer_load_dwordx4 v32, s[44:47], s61 offen offset:0 lds
    buffer_load_dwordx4 v33, s[44:47], s61 offen offset:1024 lds
    buffer_load_dwordx4 v34, s[44:47], s61 offen offset:2048 lds
    buffer_load_dwordx4 v35, s[44:47], s61 offen offset:3072 lds
    s_mov_b32 s61, 524288
    s_add_u32 m0, s59, 114688
    s_nop 0
    buffer_load_dwordx4 v32, s[44:47], s61 offen offset:0 lds
    buffer_load_dwordx4 v33, s[44:47], s61 offen offset:1024 lds
    buffer_load_dwordx4 v34, s[44:47], s61 offen offset:2048 lds
    buffer_load_dwordx4 v35, s[44:47], s61 offen offset:3072 lds
    s_cmp_lg_u32 s48, 0
    s_cbranch_scc1 mega_kernel_skip47
    v_and_b32 v8, 15, v1
    v_lshlrev_b32 v8, 2, v8
    s_lshl_b32 s50, s26, 7
    s_add_u32 s50, s50, 27277312
    v_mov_b32 v9, s50
    v_add_u32 v8, v8, v9
    s_mov_b32 s54, 0
mega_kernel_spin49:
    buffer_load_dword v9, v8, s[32:35], 0 offen sc1
    s_waitcnt vmcnt(0)
    v_cmp_eq_u32 vcc, s31, v9
    s_nop 3
    s_and_b32 s50, vcc_lo, 0x7f
    s_xor_b32 s50, s50, 0x7f
    s_cmp_eq_u32 s50, 0
    s_cbranch_scc1 mega_kernel_ok48
    s_sleep 1
    s_add_u32 s54, s54, 1
    s_cmp_lt_u32 s54, 30000
    s_cbranch_scc1 mega_kernel_spin49
mega_kernel_ok48:
mega_kernel_skip47:
p_g5:
    s_barrier
    s_mov_b32 s60, 16777216
    s_add_u32 m0, s58, 16384
    s_nop 0
    buffer_load_dwordx4 v30, s[32:35], s60 offen offset:0 sc1 lds
    buffer_load_dwordx4 v31, s[32:35], s60 offen offset:1024 sc1 lds
    s_mov_b32 s60, 16777344
    s_add_u32 m0, s58, 24576
    s_nop 0
    buffer_load_dwordx4 v30, s[32:35], s60 offen offset:0 sc1 lds
    buffer_load_dwordx4 v31, s[32:35], s60 offen offset:1024 sc1 lds
    s_mov_b32 s60, 16777472
    s_add_u32 m0, s58, 32768
    s_nop 0
    buffer_load_dwordx4 v30, s[32:35], s60 offen offset:0 sc1 lds
    buffer_load_dwordx4 v31, s[32:35], s60 offen offset:1024 sc1 lds
    s_mov_b32 s60, 16777600
    s_add_u32 m0, s58, 40960
    s_nop 0
    buffer_load_dwordx4 v30, s[32:35], s60 offen offset:0 sc1 lds
    buffer_load_dwordx4 v31, s[32:35], s60 offen offset:1024 sc1 lds
    s_mov_b32 s61, 655360
    s_add_u32 m0, s59, 131072
    s_nop 0
    buffer_load_dwordx4 v32, s[44:47], s61 offen offset:0 lds
    buffer_load_dwordx4 v33, s[44:47], s61 offen offset:1024 lds
    buffer_load_dwordx4 v34, s[44:47], s61 offen offset:2048 lds
    buffer_load_dwordx4 v35, s[44:47], s61 offen offset:3072 lds
    s_mov_b32 s61, 786432
    s_add_u32 m0, s59, 147456
    s_nop 0
    buffer_load_dwordx4 v32, s[44:47], s61 offen offset:0 lds
    buffer_load_dwordx4 v33, s[44:47], s61 offen offset:1024 lds
    buffer_load_dwordx4 v34, s[44:47], s61 offen offset:2048 lds
    buffer_load_dwordx4 v35, s[44:47], s61 offen offset:3072 lds
    s_waitcnt vmcnt(14)
    s_barrier
    s_waitcnt vmcnt(12)
    s_barrier
    s_mov_b32 s60, 16777728
    s_add_u32 m0, s58, 16384
    s_nop 0
    buffer_load_dwordx4 v30, s[32:35], s60 offen offset:0 sc1 lds
    buffer_load_dwordx4 v31, s[32:35], s60 offen offset:1024 sc1 lds
    s_mov_b32 s61, 917504
    s_add_u32 m0, s59, 49152
    s_nop 0
    buffer_load_dwordx4 v32, s[44:47], s61 offen offset:0 lds
    buffer_load_dwordx4 v33, s[44:47], s61 offen offset:1024 lds
    buffer_load_dwordx4 v34, s[44:47], s61 offen offset:2048 lds
    buffer_load_dwordx4 v35, s[44:47], s61 offen offset:3072 lds
    s_waitcnt vmcnt(16)
    s_barrier
    s_mov_b32 s60, 16777856
    s_add_u32 m0, s58, 24576
    s_nop 0
    buffer_load_dwordx4 v30, s[32:35], s60 offen offset:0 sc1 lds
    buffer_load_dwordx4 v31, s[32:35], s60 offen offset:1024 sc1 lds
    s_mov_b32 s61, 1048576
    s_add_u32 m0, s59, 65536
    s_nop 0
    buffer_load_dwordx4 v32, s[44:47], s61 offen offset:0 lds
    buffer_load_dwordx4 v33, s[44:47], s61 offen offset:1024 lds
    buffer_load_dwordx4 v34, s[44:47], s61 offen offset:2048 lds
    buffer_load_dwordx4 v35, s[44:47], s61 offen offset:3072 lds
    s_waitcnt vmcnt(20)
    s_barrier
    s_mov_b32 s60, 16777984
    s_add_u32 m0, s58, 32768
    s_nop 0
    buffer_load_dwordx4 v30, s[32:35], s60 offen offset:0 sc1 lds
    buffer_load_dwordx4 v31, s[32:35], s60 offen offset:1024 sc1 lds
    s_mov_b32 s61, 1179648
    s_add_u32 m0, s59, 81920
    s_nop 0
    buffer_load_dwordx4 v32, s[44:47], s61 offen offset:0 lds
    buffer_load_dwordx4 v33, s[44:47], s61 offen offset:1024 lds
    buffer_load_dwordx4 v34, s[44:47], s61 offen offset:2048 lds
    buffer_load_dwordx4 v35, s[44:47], s61 offen offset:3072 lds
    s_waitcnt vmcnt(16)
    s_barrier
    s_mov_b32 s60, 16778112
    s_add_u32 m0, s58, 40960
    s_nop 0
    buffer_load_dwordx4 v30, s[32:35], s60 offen offset:0 sc1 lds
    buffer_load_dwordx4 v31, s[32:35], s60 offen offset:1024 sc1 lds
    s_mov_b32 s61, 1310720
    s_add_u32 m0, s59, 98304
    s_nop 0
    buffer_load_dwordx4 v32, s[44:47], s61 offen offset:0 lds
    buffer_load_dwordx4 v33, s[44:47], s61 offen offset:1024 lds
    buffer_load_dwordx4 v34, s[44:47], s61 offen offset:2048 lds
    buffer_load_dwordx4 v35, s[44:47], s61 offen offset:3072 lds
    s_waitcnt vmcnt(16)
    s_barrier
    s_mov_b32 s60, 16778240
    s_add_u32 m0, s58, 16384
    s_nop 0
    buffer_load_dwordx4 v30, s[32:35], s60 offen offset:0 sc1 lds
    buffer_load_dwordx4 v31, s[32:35], s60 offen offset:1024 sc1 lds
    s_mov_b32 s61, 1441792
    s_add_u32 m0, s59, 114688
    s_nop 0
    buffer_load_dwordx4 v32, s[44:47], s61 offen offset:0 lds
    buffer_load_dwordx4 v33, s[44:47], s61 offen offset:1024 lds
    buffer_load_dwordx4 v34, s[44:47], s61 offen offset:2048 lds
    buffer_load_dwordx4 v35, s[44:47], s61 offen offset:3072 lds
    s_waitcnt vmcnt(16)
    s_barrier
    s_mov_b32 s60, 16778368
    s_add_u32 m0, s58, 24576
    s_nop 0
    buffer_load_dwordx4 v30, s[32:35], s60 offen offset:0 sc1 lds
    buffer_load_dwordx4 v31, s[32:35], s60 offen offset:1024 sc1 lds
    s_mov_b32 s61, 1572864
    s_add_u32 m0, s59, 131072
    s_nop 0
    buffer_load_dwordx4 v32, s[44:47], s61 offen offset:0 lds
    buffer_load_dwordx4 v33, s[44:47], s61 offen offset:1024 lds
    buffer_load_dwordx4 v34, s[44:47], s61 offen offset:2048 lds
    buffer_load_dwordx4 v35, s[44:47], s61 offen offset:3072 lds
    s_waitcnt vmcnt(16)
    s_barrier
    s_mov_b32 s60, 16778496
    s_add_u32 m0, s58, 32768
    s_nop 0
    buffer_load_dwordx4 v30, s[32:35], s60 offen offset:0 sc1 lds
    buffer_load_dwordx4 v31, s[32:35], s60 offen offset:1024 sc1 lds
    s_mov_b32 s61, 1703936
    s_add_u32 m0, s59, 147456
    s_nop 0
    buffer_load_dwordx4 v32, s[44:47], s61 offen offset:0 lds
    buffer_load_dwordx4 v33, s[44:47], s61 offen offset:1024 lds
    buffer_load_dwordx4 v34, s[44:47], s61 offen offset:2048 lds
    buffer_load_dwordx4 v35, s[44:47], s61 offen offset:3072 lds
    s_waitcnt vmcnt(16)
    s_barrier
    s_mov_b32 s60, 16778624
    s_add_u32 m0, s58, 40960
    s_nop 0
    buffer_load_dwordx4 v30, s[32:35], s60 offen offset:0 sc1 lds
    buffer_load_dwordx4 v31, s[32:35], s60 offen offset:1024 sc1 lds
    s_mov_b32 s61, 1835008
    s_add_u32 m0, s59, 49152
    s_nop 0
    buffer_load_dwordx4 v32, s[44:47], s61 offen offset:0 lds
    buffer_load_dwordx4 v33, s[44:47], s61 offen offset:1024 lds
    buffer_load_dwordx4 v34, s[44:47], s61 offen offset:2048 lds
    buffer_load_dwordx4 v35, s[44:47], s61 offen offset:3072 lds
    s_waitcnt vmcnt(16)
    s_barrier
    s_mov_b32 s60, 16778752
    s_add_u32 m0, s58, 16384
    s_nop 0
    buffer_load_dwordx4 v30, s[32:35], s60 offen offset:0 sc1 lds
    buffer_load_dwordx4 v31, s[32:35], s60 offen offset:1024 sc1 lds
    s_mov_b32 s61, 1966080
    s_add_u32 m0, s59, 65536
    s_nop 0
    buffer_load_dwordx4 v32, s[44:47], s61 offen offset:0 lds
    buffer_load_dwordx4 v33, s[44:47], s61 offen offset:1024 lds
    buffer_load_dwordx4 v34, s[44:47], s61 offen offset:2048 lds
    buffer_load_dwordx4 v35, s[44:47], s61 offen offset:3072 lds
    s_cmp_lg_u32 s48, 0
    s_cbranch_scc1 mega_kernel_skip50
    v_and_b32 v8, 15, v1
    v_lshlrev_b32 v8, 2, v8
    s_lshl_b32 s50, s26, 7
    s_add_u32 s50, s50, 27277312
    v_mov_b32 v9, s50
    v_add_u32 v8, v8, v9
    buffer_load_dword v9, v8, s[32:35], 0 offen sc1
mega_kernel_skip50:
    s_waitcnt vmcnt(16)
    s_barrier
    s_mov_b32 s60, 16778880
    s_add_u32 m0, s58, 24576
    s_nop 0
    buffer_load_dwordx4 v30, s[32:35], s60 offen offset:0 sc1 lds
    buffer_load_dwordx4 v31, s[32:35], s60 offen offset:1024 sc1 lds
    s_mov_b32 s61, 2097152
    s_add_u32 m0, s59, 81920
    s_nop 0
    buffer_load_dwordx4 v32, s[44:47], s61 offen offset:0 lds
    buffer_load_dwordx4 v33, s[44:47], s61 offen offset:1024 lds
    buffer_load_dwordx4 v34, s[44:47], s61 offen offset:2048 lds
    buffer_load_dwordx4 v35, s[44:47], s61 offen offset:3072 lds
    s_waitcnt vmcnt(16)
    s_cmp_lg_u32 s48, 0
    s_cbranch_scc1 mega_kernel_skip51
    s_waitcnt vmcnt(6)
    v_cmp_eq_u32 vcc, s31, v9
    s_nop 3
    s_and_b32 s50, vcc_lo, 0x7f00
    s_xor_b32 s50, s50, 0x7f00
    s_lshl_b32 s51, 1, s27
    s_andn2_b32 s50, s50, s51
    s_cmp_eq_u32 s50, 0
    s_cbranch_scc1 mega_kernel_ok52
    s_mov_b32 s54, 0
mega_kernel_spin53:
    buffer_load_dword v9, v8, s[32:35], 0 offen sc1
    s_waitcnt vmcnt(0)
    v_cmp_eq_u32 vcc, s31, v9
    s_nop 3
    s_and_b32 s50, vcc_lo, 0x7f00
    s_xor_b32 s50, s50, 0x7f00
    s_lshl_b32 s51, 1, s27
    s_andn2_b32 s50, s50, s51
    s_cmp_eq_u32 s50, 0
    s_cbranch_scc1 mega_kernel_ok52
    s_sleep 1
    s_add_u32 s54, s54, 1
    s_cmp_lt_u32 s54, 30000
    s_cbranch_scc1 mega_kernel_spin53
mega_kernel_ok52:
mega_kernel_skip51:
    s_barrier
    s_mov_b32 s60, 16779008
    s_add_u32 m0, s58, 32768
    s_nop 0
    buffer_load_dwordx4 v30, s[32:35], s60 offen offset:0 sc1 lds
    buffer_load_dwordx4 v31, s[32:35], s60 offen offset:1024 sc1 lds
    s_mov_b32 s61, 2228224
    s_add_u32 m0, s59, 98304
    s_nop 0
    buffer_load_dwordx4 v32, s[44:47], s61 offen offset:0 lds
    buffer_load_dwordx4 v33, s[44:47], s61 offen offset:1024 lds
    buffer_load_dwordx4 v34, s[44:47], s61 offen offset:2048 lds
    buffer_load_dwordx4 v35, s[44:47], s61 offen offset:3072 lds
    s_waitcnt vmcnt(16)
    s_barrier
    s_mov_b32 s60, 16779136
    s_add_u32 m0, s58, 40960
    s_nop 0
    buffer_load_dwordx4 v30, s[32:35], s60 offen offset:0 sc1 lds
    buffer_load_dwordx4 v31, s[32:35], s60 offen offset:1024 sc1 lds
    s_mov_b32 s61, 2359296
    s_add_u32 m0, s59, 114688
    s_nop 0
    buffer_load_dwordx4 v32, s[44:47], s61 offen offset:0 lds
    buffer_load_dwordx4 v33, s[44:47], s61 offen offset:1024 lds
    buffer_load_dwordx4 v34, s[44:47], s61 offen offset:2048 lds
    buffer_load_dwordx4 v35, s[44:47], s61 offen offset:3072 lds
    s_waitcnt vmcnt(16)
    s_barrier
    s_mov_b32 s60, 16779264
    s_add_u32 m0, s58, 16384
    s_nop 0
    buffer_load_dwordx4 v30, s[32:35], s60 offen offset:0 sc1 lds
    buffer_load_dwordx4 v31, s[32:35], s60 offen offset:1024 sc1 lds
    s_mov_b32 s61, 2490368
    s_add_u32 m0, s59, 131072
    s_nop 0
    buffer_load_dwordx4 v32, s[44:47], s61 offen offset:0 lds
    buffer_load_dwordx4 v33, s[44:47], s61 offen offset:1024 lds
    buffer_load_dwordx4 v34, s[44:47], s61 offen offset:2048 lds
    buffer_load_dwordx4 v35, s[44:47], s61 offen offset:3072 lds
    s_waitcnt vmcnt(16)
    s_barrier
    s_mov_b32 s60, 16779392
    s_add_u32 m0, s58, 24576
    s_nop 0
    buffer_load_dwordx4 v30, s[32:35], s60 offen offset:0 sc1 lds
    buffer_load_dwordx4 v31, s[32:35], s60 offen offset:1024 sc1 lds
    s_mov_b32 s61, 2621440
    s_add_u32 m0, s59, 147456
    s_nop 0
    buffer_load_dwordx4 v32, s[44:47], s61 offen offset:0 lds
    buffer_load_dwordx4 v33, s[44:47], s61 offen offset:1024 lds
    buffer_load_dwordx4 v34, s[44:47], s61 offen offset:2048 lds
    buffer_load_dwordx4 v35, s[44:47], s61 offen offset:3072 lds
    s_waitcnt vmcnt(16)
    s_barrier
    s_mov_b32 s60, 16779520
    s_add_u32 m0, s58, 32768
    s_nop 0
    buffer_load_dwordx4 v30, s[32:35], s60 offen offset:0 sc1 lds
    buffer_load_dwordx4 v31, s[32:35], s60 offen offset:1024 sc1 lds
    s_mov_b32 s61, 2752512
    s_add_u32 m0, s59, 49152
    s_nop 0
    buffer_load_dwordx4 v32, s[44:47], s61 offen offset:0 lds
    buffer_load_dwordx4 v33, s[44:47], s61 offen offset:1024 lds
    buffer_load_dwordx4 v34, s[44:47], s61 offen offset:2048 lds
    buffer_load_dwordx4 v35, s[44:47], s61 offen offset:3072 lds
    s_waitcnt vmcnt(16)
    s_barrier
    s_mov_b32 s60, 16779648
    s_add_u32 m0, s58, 40960
    s_nop 0
    buffer_load_dwordx4 v30, s[32:35], s60 offen offset:0 sc1 lds
    buffer_load_dwordx4 v31, s[32:35], s60 offen offset:1024 sc1 lds
    s_mov_b32 s61, 2883584
    s_add_u32 m0, s59, 65536
    s_nop 0
    buffer_load_dwordx4 v32, s[44:47], s61 offen offset:0 lds
    buffer_load_dwordx4 v33, s[44:47], s61 offen offset:1024 lds
    buffer_load_dwordx4 v34, s[44:47], s61 offen offset:2048 lds
    buffer_load_dwordx4 v35, s[44:47], s61 offen offset:3072 lds
    s_waitcnt vmcnt(16)
    s_barrier
    s_mov_b32 s60, 16779776
    s_add_u32 m0, s58, 16384
    s_nop 0
    buffer_load_dwordx4 v30, s[32:35], s60 offen offset:0 sc1 lds
    buffer_load_dwordx4 v31, s[32:35], s60 offen offset:1024 sc1 lds
    s_mov_b32 s61, 3014656
    s_add_u32 m0, s59, 81920
    s_nop 0
    buffer_load_dwordx4 v32, s[44:47], s61 offen offset:0 lds
    buffer_load_dwordx4 v33, s[44:47], s61 offen offset:1024 lds
    buffer_load_dwordx4 v34, s[44:47], s61 offen offset:2048 lds
    buffer_load_dwordx4 v35, s[44:47], s61 offen offset:3072 lds
    s_waitcnt vmcnt(16)
    s_barrier
    s_mov_b32 s60, 16779904
    s_add_u32 m0, s58, 24576
    s_nop 0
    buffer_load_dwordx4 v30, s[32:35], s60 offen offset:0 sc1 lds
    buffer_load_dwordx4 v31, s[32:35], s60 offen offset:1024 sc1 lds
    s_mov_b32 s61, 3145728
    s_add_u32 m0, s59, 98304
    s_nop 0
    buffer_load_dwordx4 v32, s[44:47], s61 offen offset:0 lds
    buffer_load_dwordx4 v33, s[44:47], s61 offen offset:1024 lds
    buffer_load_dwordx4 v34, s[44:47], s61 offen offset:2048 lds
    buffer_load_dwordx4 v35, s[44:47], s61 offen offset:3072 lds
    s_waitcnt vmcnt(16)
    s_barrier
    s_mov_b32 s60, 16780032
    s_add_u32 m0, s58, 32768
    s_nop 0
    buffer_load_dwordx4 v30, s[32:35], s60 offen offset:0 sc1 lds
    buffer_load_dwordx4 v31, s[32:35], s60 offen offset:1024 sc1 lds
    s_mov_b32 s61, 3276800
    s_add_u32 m0, s59, 114688
    s_nop 0
    buffer_load_dwordx4 v32, s[44:47], s61 offen offset:0 lds
    buffer_load_dwordx4 v33, s[44:47], s61 offen offset:1024 lds
    buffer_load_dwordx4 v34, s[44:47], s61 offen offset:2048 lds
    buffer_load_dwordx4 v35, s[44:47], s61 offen offset:3072 lds
    s_waitcnt vmcnt(16)
    s_barrier
    s_mov_b32 s60, 16780160
    s_add_u32 m0, s58, 40960
    s_nop 0
    buffer_load_dwordx4 v30, s[32:35], s60 offen offset:0 sc1 lds
    buffer_load_dwordx4 v31, s[32:35], s60 offen offset:1024 sc1 lds
    s_mov_b32 s61, 3407872
    s_add_u32 m0, s59, 131072
    s_nop 0
    buffer_load_dwordx4 v32, s[44:47], s61 offen offset:0 lds
    buffer_load_dwordx4 v33, s[44:47], s61 offen offset:1024 lds
    buffer_load_dwordx4 v34, s[44:47], s61 offen offset:2048 lds
    buffer_load_dwordx4 v35, s[44:47], s61 offen offset:3072 lds
    s_waitcnt vmcnt(16)
    s_barrier
    s_mov_b32 s60, 16780288
    s_add_u32 m0, s58, 16384
    s_nop 0
    buffer_load_dwordx4 v30, s[32:35], s60 offen offset:0 sc1 lds
    buffer_load_dwordx4 v31, s[32:35], s60 offen offset:1024 sc1 lds
    s_mov_b32 s61, 3538944
    s_add_u32 m0, s59, 147456
    s_nop 0
    buffer_load_dwordx4 v32, s[44:47], s61 offen offset:0 lds
    buffer_load_dwordx4 v33, s[44:47], s61 offen offset:1024 lds
    buffer_load_dwordx4 v34, s[44:47], s61 offen offset:2048 lds
    buffer_load_dwordx4 v35, s[44:47], s61 offen offset:3072 lds
    s_waitcnt vmcnt(16)
    s_barrier
    s_mov_b32 s60, 16780416
    s_add_u32 m0, s58, 24576
    s_nop 0
    buffer_load_dwordx4 v30, s[32:35], s60 offen offset:0 sc1 lds
    buffer_load_dwordx4 v31, s[32:35], s60 offen offset:1024 sc1 lds
    s_waitcnt vmcnt(12)
    s_barrier
    s_mov_b32 s60, 16780544
    s_add_u32 m0, s58, 32768
    s_nop 0
    buffer_load_dwordx4 v30, s[32:35], s60 offen offset:0 sc1 lds
    buffer_load_dwordx4 v31, s[32:35], s60 offen offset:1024 sc1 lds
    s_waitcnt vmcnt(8)
    s_barrier
    s_mov_b32 s60, 16780672
    s_add_u32 m0, s58, 40960
    s_nop 0
    buffer_load_dwordx4 v30, s[32:35], s60 offen offset:0 sc1 lds
    buffer_load_dwordx4 v31, s[32:35], s60 offen offset:1024 sc1 lds
    s_waitcnt vmcnt(4)
    s_barrier
    s_waitcnt vmcnt(2)
    s_barrier
    s_waitcnt vmcnt(0)
    s_barrier
    s_barrier
    s_branch mega_fin
mega_fin:
    s_cmp_lg_u32 s30, 4
    s_cbranch_scc1 mega_done
    s_cmp_lg_u32 s2, 0
    s_cbranch_scc1 mega_done
    s_mov_b64 exec, 1
    v_mov_b32 v8, s31
    v_mov_b32 v4, 0
    s_mov_b32 s50, 27525120
    buffer_store_dword v8, v4, s[32:35], s50 offen sc1
mega_done:
    s_endpgm
.section .rodata,"a"
.p2align 6
.amdhsa_kernel mega_kernel
  .amdhsa_next_free_vgpr 256
  .amdhsa_next_free_sgpr 102
  .amdhsa_accum_offset 160
  .amdhsa_group_segment_fixed_size 0
  .amdhsa_kernarg_size 88
  .amdhsa_user_sgpr_count 2
  .amdhsa_user_sgpr_kernarg_segment_ptr 1
  .amdhsa_system_sgpr_workgroup_id_x 1
  .amdhsa_float_denorm_mode_32 3
.end_amdhsa_kernel
```
